```python
import torch

def _softmax(x, axis=-1):
    return torch.softmax(x, dim=axis)
def _gelu(x):
    return torch.nn.functional.gelu(x, approximate="tanh")
def _silu(x):
    return torch.nn.functional.silu(x)
def _sigmoid(x):
    return torch.sigmoid(x)
def _layernorm(x, axis=-1, eps=1e-5):
    m = x.mean(dim=axis, keepdim=True)
    v = x.var(dim=axis, keepdim=True, unbiased=False)
    return (x - m) / torch.sqrt(v + eps)
def _scatter_add(tgt, idx, src, axis=0):
    return tgt.clone().index_add_(axis, idx, src)
def _segment_sum(src, seg, n):
    out = torch.zeros((n,) + src.shape[1:], dtype=src.dtype)
    return out.index_add_(0, seg, src)
def _pad(x, pw):
    flat = tuple(v for pair in reversed(pw) for v in pair)
    return torch.nn.functional.pad(x, flat)

kernel_name = 'concat_heads__gqa_block_cached__mha_block_cached__near_ridge'

def setup_inputs():

    _w = (lambda a: (lambda t: t.to(torch.bfloat16) if t.is_floating_point() else t)(torch.as_tensor(a)))
    def _A_setup():
        B, Sq, D = 8, 96, 640
        Hq, Hkv, Sk, Dh = 32, 32, 1024, 128
        assert Hq % Hkv == 0, (Hq, Hkv)
        return {
            "x": _w((lambda *s: torch.randn(*s, dtype=torch.bfloat16) * 0.8)(B, Sq, D)),
            "k_cache": _w((lambda *s: torch.randn(*s, dtype=torch.bfloat16) * 0.8)(B, Hkv, Sk, Dh)),
            "v_cache": _w((lambda *s: torch.randn(*s, dtype=torch.bfloat16) * 0.05)(B, Hkv, Sk, Dh)),
            "wq": _w((lambda *s: torch.randn(*s, dtype=torch.bfloat16) * 0.8)(D, Hq * Dh) * (D ** -0.5)),
            "wo": _w((lambda *s: torch.randn(*s, dtype=torch.bfloat16) * 0.05)(Hq * Dh, D) * ((Hq * Dh) ** -0.5)),
        }
    _A_in = _A_setup()

    def _B_setup():
        B, Sq, D = 8, 96, 640
        H, Sk, Dh = 32, 1024, 128
        return {
            "x": _w((lambda *s: torch.randn(*s, dtype=torch.bfloat16) * 0.8)(B, Sq, D)),
            "k_cache": _w((lambda *s: torch.randn(*s, dtype=torch.bfloat16) * 0.8)(B, H, Sk, Dh)),
            "v_cache": _w((lambda *s: torch.randn(*s, dtype=torch.bfloat16) * 0.05)(B, H, Sk, Dh)),
            "wq": _w((lambda *s: torch.randn(*s, dtype=torch.bfloat16) * 0.8)(D, H * Dh) * (D ** -0.5)),
            "wo": _w((lambda *s: torch.randn(*s, dtype=torch.bfloat16) * 0.05)(H * Dh, D) * ((H * Dh) ** -0.5)),
        }
    _B_in = _B_setup()

    return {
        "A_x": _A_in["x"],
        "A_k_cache": _A_in["k_cache"],
        "A_v_cache": _A_in["v_cache"],
        "A_wq": _A_in["wq"],
        "A_wo": _A_in["wo"],
        "B_x": _B_in["x"],
        "B_k_cache": _B_in["k_cache"],
        "B_v_cache": _B_in["v_cache"],
        "B_wq": _B_in["wq"],
        "B_wo": _B_in["wo"],
    }

def reference(A_x, A_k_cache, A_v_cache, A_wq, A_wo, B_x, B_k_cache, B_v_cache, B_wq, B_wo):
    def _A_ref(x, k_cache, v_cache, wq, wo):
        B, Sq, D = x.shape
        Hq, Dh = 32, 128
        Hkv = k_cache.shape[1]
        rep = Hq // Hkv
        q = (lambda x, *d: x.permute(*d))((x @ wq).reshape(B, Sq, Hq, Dh), 0, 2, 1, 3)
        k = (lambda x, n, axis: torch.repeat_interleave(x, n, dim=axis))(k_cache, rep, axis=1)
        v = (lambda x, n, axis: torch.repeat_interleave(x, n, dim=axis))(v_cache, rep, axis=1)
        scores = torch.einsum("bhqd,bhkd->bhqk", q, k) * (Dh ** -0.5)
        p = _softmax(scores, axis=-1)
        o = torch.einsum("bhqk,bhkd->bhqd", p, v)
        return (lambda x, *d: x.permute(*d))(o, 0, 2, 1, 3).reshape(B, Sq, Hq * Dh) @ wo

    def _B_ref(x, k_cache, v_cache, wq, wo):
        B, Sq, D = x.shape
        H, Dh = 32, 128
        q = (lambda x, *d: x.permute(*d))((x @ wq).reshape(B, Sq, H, Dh), 0, 2, 1, 3)
        scores = torch.einsum("bhqd,bhkd->bhqk", q, k_cache) * (Dh ** -0.5)
        p = _softmax(scores, axis=-1)
        o = torch.einsum("bhqk,bhkd->bhqd", p, v_cache)
        return (lambda x, *d: x.permute(*d))(o, 0, 2, 1, 3).reshape(B, Sq, H * Dh) @ wo

    a = _A_ref(A_x, A_k_cache, A_v_cache, A_wq, A_wo)
    b = _B_ref(B_x, B_k_cache, B_v_cache, B_wq, B_wo)
    return torch.concatenate([a, b], axis=-1)
```

```asm
; @launch grid=(256,1,1) block=(512,1,1) lds=163840
.amdgcn_target "amdgcn-amd-amdhsa--gfx950"
.text
.globl concat_heads__gqa_block_cached__mha_block_cached__near_ridge_kernel
.p2align 8
.type concat_heads__gqa_block_cached__mha_block_cached__near_ridge_kernel,@function
concat_heads__gqa_block_cached__mha_block_cached__near_ridge_kernel:
    s_cmp_ge_u32 s2, 256
    s_cbranch_scc1 L_end
    s_load_dwordx16 s[16:31], s[0:1], 0
    s_load_dwordx8 s[32:39], s[0:1], 64
    s_load_dwordx2 s[40:41], s[0:1], 96
    v_lshrrev_b32 v1, 6, v0
    v_and_b32 v0, 63, v0
    s_and_b32 s3, s2, 7
    v_readfirstlane_b32 s4, v1
    s_lshr_b32 s10, s2, 3
    s_and_b32 s5, s3, 1
    s_lshr_b32 s3, s3, 1
    s_lshr_b32 s6, s10, 2
    s_add_u32 s7, s10, 0
    s_and_b32 s7, s7, 3
    s_lshl_b32 s12, s3, 3
    s_add_u32 s7, s7, s12
    s_mul_i32 s12, s10, 52
    s_lshr_b32 s12, s12, 8
    s_mul_i32 s13, s12, 5
    s_sub_u32 s9, s10, s13
    s_and_b32 s13, s3, 1
    s_mul_i32 s13, s13, 5
    s_add_u32 s9, s9, s13
    s_lshr_b32 s13, s3, 1
    s_mul_i32 s8, s13, 6
    s_add_u32 s8, s8, s12
    s_mul_i32 s11, s4, 20480
    v_lshlrev_b32 v1, 4, v0
    s_mov_b32 s46, 983040
    s_mov_b32 s47, 0x20000
    s_mov_b32 s50, 5242880
    s_mov_b32 s51, 0x20000
    s_mov_b32 s54, 67108864
    s_mov_b32 s55, 0x20000
    s_mov_b32 s58, 67108864
    s_mov_b32 s59, 0x20000
    s_mov_b32 s62, 5242880
    s_mov_b32 s63, 0x20000
    s_mov_b32 s66, 12779520
    s_mov_b32 s67, 0x20000
    s_mov_b32 s70, 1966080
    s_mov_b32 s71, 0x20000
    s_mov_b32 s74, 256
    s_mov_b32 s75, 0x20000
    s_mul_i32 s89, s5, 12
    s_add_u32 s89, s89, s8
    s_lshl_b32 s89, s89, 19
    s_lshl_b32 s88, s9, 7
    s_waitcnt lgkmcnt(0)
    s_cmp_eq_u32 s5, 0
    s_cselect_b32 s44, s16, s26
    s_cselect_b32 s45, s17, s27
    s_cselect_b32 s52, s18, s28
    s_cselect_b32 s53, s19, s29
    s_cselect_b32 s56, s20, s30
    s_cselect_b32 s57, s21, s31
    s_cselect_b32 s48, s22, s32
    s_cselect_b32 s49, s23, s33
    s_cselect_b32 s60, s24, s34
    s_cselect_b32 s61, s25, s35
    s_mov_b32 s68, s36
    s_mov_b32 s69, s37
    s_mov_b32 s72, s38
    s_mov_b32 s73, s39
    s_mov_b32 s64, s40
    s_mov_b32 s65, s41
    s_cmp_eq_u32 s4, 3
    s_cbranch_scc1 L_ld
    s_cmp_gt_u32 s4, 3
    s_cbranch_scc1 L_g
    s_mov_b32 s12, s4
    v_lshrrev_b32 v6, 4, v0
    v_and_b32 v7, 7, v0
    v_xor_b32 v7, v7, v6
    v_lshlrev_b32 v7, 4, v7
    v_lshrrev_b32 v8, 3, v0
    v_mul_u32_u24 v8, 1280, v8
    v_add_u32 v8, v8, v7
    s_and_b32 s13, s12, 1
    s_lshl_b32 s13, s13, 6
    v_xor_b32 v8, s13, v8
    v_xor_b32 v9, 64, v8
    s_mul_i32 s84, s6, 122880
    s_mul_i32 s13, s12, 30720
    s_add_u32 s84, s84, s13
    s_mul_i32 s15, s12, 3072
    v_lshlrev_b32 v7, 2, v6
    v_and_b32 v10, 15, v0
    v_xor_b32 v7, v7, v10
    v_lshlrev_b32 v7, 4, v7
    v_lshl_add_u32 v10, v6, 13, v7
    s_lshl_b32 s85, s7, 8
    s_lshl_b32 s13, s12, 16
    s_add_u32 s85, s85, s13
    s_lshl_b32 s14, s12, 11
    s_add_u32 m0, s15, 147456
    s_add_u32 s77, s84, 0
    buffer_load_dwordx4 v8, s[44:47], s77 offen offset:0 lds
    s_add_u32 s77, s84, 9216
    buffer_load_dwordx4 v9, s[44:47], s77 offen offset:1024 lds
    s_add_u32 s77, s84, 18432
    buffer_load_dwordx4 v8, s[44:47], s77 offen offset:2048 lds
    s_add_u32 m0, s14, 98304
    s_add_u32 s77, s85, 0
    s_add_u32 s78, s85, 31744
    buffer_load_dwordx4 v10, s[48:51], s77 offen lds
    buffer_load_dwordx4 v10, s[48:51], s78 offen offset:1024 lds
    s_add_u32 m0, s14, 106496
    s_add_u32 s77, s85, 1024
    s_add_u32 s78, s85, 32768
    buffer_load_dwordx4 v10, s[48:51], s77 offen lds
    buffer_load_dwordx4 v10, s[48:51], s78 offen offset:1024 lds
    s_add_u32 m0, s14, 114688
    s_add_u32 s77, s85, 262144
    s_add_u32 s78, s85, 293888
    buffer_load_dwordx4 v10, s[48:51], s77 offen lds
    buffer_load_dwordx4 v10, s[48:51], s78 offen offset:1024 lds
    s_add_u32 m0, s14, 122880
    s_add_u32 s77, s85, 263168
    s_add_u32 s78, s85, 294912
    buffer_load_dwordx4 v10, s[48:51], s77 offen lds
    buffer_load_dwordx4 v10, s[48:51], s78 offen offset:1024 lds
    s_add_u32 m0, s15, 16384
    s_add_u32 s77, s84, 128
    buffer_load_dwordx4 v8, s[44:47], s77 offen offset:0 lds
    s_add_u32 s77, s84, 9344
    buffer_load_dwordx4 v9, s[44:47], s77 offen offset:1024 lds
    s_add_u32 s77, s84, 18560
    buffer_load_dwordx4 v8, s[44:47], s77 offen offset:2048 lds
    s_add_u32 m0, s14, 131072
    s_add_u32 s77, s85, 524288
    s_add_u32 s78, s85, 556032
    buffer_load_dwordx4 v10, s[48:51], s77 offen lds
    buffer_load_dwordx4 v10, s[48:51], s78 offen offset:1024 lds
    s_add_u32 m0, s14, 139264
    s_add_u32 s77, s85, 525312
    s_add_u32 s78, s85, 557056
    buffer_load_dwordx4 v10, s[48:51], s77 offen lds
    buffer_load_dwordx4 v10, s[48:51], s78 offen offset:1024 lds
    s_add_u32 m0, s14, 65536
    s_add_u32 s77, s85, 786432
    s_add_u32 s78, s85, 818176
    buffer_load_dwordx4 v10, s[48:51], s77 offen lds
    buffer_load_dwordx4 v10, s[48:51], s78 offen offset:1024 lds
    s_add_u32 m0, s14, 73728
    s_add_u32 s77, s85, 787456
    s_add_u32 s78, s85, 819200
    buffer_load_dwordx4 v10, s[48:51], s77 offen lds
    buffer_load_dwordx4 v10, s[48:51], s78 offen offset:1024 lds
    s_setprio 2
    s_mov_b32 s81, 0x49800000
    s_mov_b32 s80, 0
    s_mov_b32 s91, s7
    v_and_b32 v2, 31, v0
    v_lshrrev_b32 v3, 5, v0
    v_and_b32 v4, 15, v2
    v_xor_b32 v4, v4, v3
    v_lshlrev_b32 v4, 4, v4
    v_lshl_add_u32 v4, v2, 8, v4
    v_xor_b32 v232, 0, v4
    v_xor_b32 v233, 32, v4
    v_xor_b32 v234, 64, v4
    v_xor_b32 v235, 96, v4
    v_xor_b32 v236, 128, v4
    v_xor_b32 v237, 160, v4
    v_xor_b32 v238, 192, v4
    v_xor_b32 v239, 224, v4
    v_lshrrev_b32 v2, 2, v0
    v_and_b32 v2, 3, v2
    v_lshrrev_b32 v4, 4, v0
    v_and_b32 v4, 1, v4
    v_lshlrev_b32 v4, 5, v4
    v_and_b32 v5, 1, v0
    v_lshl_add_u32 v4, v5, 4, v4
    v_and_b32 v5, 2, v0
    v_lshl_add_u32 v4, v5, 2, v4
    v_lshl_add_u32 v4, v2, 8, v4
    v_lshl_add_u32 v4, v2, 6, v4
    v_lshl_add_u32 v4, v3, 10, v4
    v_xor_b32 v240, 0, v4
    v_xor_b32 v241, 64, v4
    v_xor_b32 v242, 128, v4
    v_xor_b32 v243, 192, v4
    s_waitcnt vmcnt(15)
    s_barrier
    s_add_u32 m0, s15, 49152
    s_add_u32 s77, s84, 256
    buffer_load_dwordx4 v8, s[44:47], s77 offen offset:0 lds
    s_add_u32 s77, s84, 9472
    buffer_load_dwordx4 v9, s[44:47], s77 offen offset:1024 lds
    s_add_u32 s77, s84, 18688
    buffer_load_dwordx4 v8, s[44:47], s77 offen offset:2048 lds
    s_add_u32 m0, s14, 81920
    s_add_u32 s77, s85, 1048576
    s_add_u32 s78, s85, 1080320
    buffer_load_dwordx4 v10, s[48:51], s77 offen lds
    buffer_load_dwordx4 v10, s[48:51], s78 offen offset:1024 lds
    s_add_u32 m0, s14, 90112
    s_add_u32 s77, s85, 1049600
    s_add_u32 s78, s85, 1081344
    buffer_load_dwordx4 v10, s[48:51], s77 offen lds
    buffer_load_dwordx4 v10, s[48:51], s78 offen offset:1024 lds
    s_waitcnt vmcnt(18)
    s_barrier
    s_add_u32 m0, s14, 98304
    s_add_u32 s77, s85, 1310720
    s_add_u32 s78, s85, 1342464
    buffer_load_dwordx4 v10, s[48:51], s77 offen lds
    buffer_load_dwordx4 v10, s[48:51], s78 offen offset:1024 lds
    s_add_u32 m0, s14, 106496
    s_add_u32 s77, s85, 1311744
    s_add_u32 s78, s85, 1343488
    buffer_load_dwordx4 v10, s[48:51], s77 offen lds
    buffer_load_dwordx4 v10, s[48:51], s78 offen offset:1024 lds
    s_waitcnt vmcnt(15)
    s_barrier
    s_add_u32 m0, s15, 147456
    s_add_u32 s77, s84, 384
    buffer_load_dwordx4 v8, s[44:47], s77 offen offset:0 lds
    s_add_u32 s77, s84, 9600
    buffer_load_dwordx4 v9, s[44:47], s77 offen offset:1024 lds
    s_add_u32 s77, s84, 18816
    buffer_load_dwordx4 v8, s[44:47], s77 offen offset:2048 lds
    s_add_u32 m0, s14, 114688
    s_add_u32 s77, s85, 1572864
    s_add_u32 s78, s85, 1604608
    buffer_load_dwordx4 v10, s[48:51], s77 offen lds
    buffer_load_dwordx4 v10, s[48:51], s78 offen offset:1024 lds
    s_add_u32 m0, s14, 122880
    s_add_u32 s77, s85, 1573888
    s_add_u32 s78, s85, 1605632
    buffer_load_dwordx4 v10, s[48:51], s77 offen lds
    buffer_load_dwordx4 v10, s[48:51], s78 offen offset:1024 lds
    s_waitcnt vmcnt(18)
    s_barrier
    s_add_u32 m0, s14, 131072
    s_add_u32 s77, s85, 1835008
    s_add_u32 s78, s85, 1866752
    buffer_load_dwordx4 v10, s[48:51], s77 offen lds
    buffer_load_dwordx4 v10, s[48:51], s78 offen offset:1024 lds
    s_add_u32 m0, s14, 139264
    s_add_u32 s77, s85, 1836032
    s_add_u32 s78, s85, 1867776
    buffer_load_dwordx4 v10, s[48:51], s77 offen lds
    buffer_load_dwordx4 v10, s[48:51], s78 offen offset:1024 lds
    s_waitcnt vmcnt(15)
    s_barrier
    s_add_u32 m0, s15, 16384
    s_add_u32 s77, s84, 512
    buffer_load_dwordx4 v8, s[44:47], s77 offen offset:0 lds
    s_add_u32 s77, s84, 9728
    buffer_load_dwordx4 v9, s[44:47], s77 offen offset:1024 lds
    s_add_u32 s77, s84, 18944
    buffer_load_dwordx4 v8, s[44:47], s77 offen offset:2048 lds
    s_add_u32 m0, s14, 65536
    s_add_u32 s77, s85, 2097152
    s_add_u32 s78, s85, 2128896
    buffer_load_dwordx4 v10, s[48:51], s77 offen lds
    buffer_load_dwordx4 v10, s[48:51], s78 offen offset:1024 lds
    s_add_u32 m0, s14, 73728
    s_add_u32 s77, s85, 2098176
    s_add_u32 s78, s85, 2129920
    buffer_load_dwordx4 v10, s[48:51], s77 offen lds
    buffer_load_dwordx4 v10, s[48:51], s78 offen offset:1024 lds
    s_waitcnt vmcnt(18)
    s_barrier
    s_add_u32 m0, s14, 81920
    s_add_u32 s77, s85, 2359296
    s_add_u32 s78, s85, 2391040
    buffer_load_dwordx4 v10, s[48:51], s77 offen lds
    buffer_load_dwordx4 v10, s[48:51], s78 offen offset:1024 lds
    s_add_u32 m0, s14, 90112
    s_add_u32 s77, s85, 2360320
    s_add_u32 s78, s85, 2392064
    buffer_load_dwordx4 v10, s[48:51], s77 offen lds
    buffer_load_dwordx4 v10, s[48:51], s78 offen offset:1024 lds
    s_waitcnt vmcnt(15)
    s_barrier
    s_add_u32 m0, s15, 49152
    s_add_u32 s77, s84, 640
    buffer_load_dwordx4 v8, s[44:47], s77 offen offset:0 lds
    s_add_u32 s77, s84, 9856
    buffer_load_dwordx4 v9, s[44:47], s77 offen offset:1024 lds
    s_add_u32 s77, s84, 19072
    buffer_load_dwordx4 v8, s[44:47], s77 offen offset:2048 lds
    s_add_u32 m0, s14, 98304
    s_add_u32 s77, s85, 2621440
    s_add_u32 s78, s85, 2653184
    buffer_load_dwordx4 v10, s[48:51], s77 offen lds
    buffer_load_dwordx4 v10, s[48:51], s78 offen offset:1024 lds
    s_add_u32 m0, s14, 106496
    s_add_u32 s77, s85, 2622464
    s_add_u32 s78, s85, 2654208
    buffer_load_dwordx4 v10, s[48:51], s77 offen lds
    buffer_load_dwordx4 v10, s[48:51], s78 offen offset:1024 lds
    s_waitcnt vmcnt(18)
    s_barrier
    s_add_u32 m0, s14, 114688
    s_add_u32 s77, s85, 2883584
    s_add_u32 s78, s85, 2915328
    buffer_load_dwordx4 v10, s[48:51], s77 offen lds
    buffer_load_dwordx4 v10, s[48:51], s78 offen offset:1024 lds
    s_add_u32 m0, s14, 122880
    s_add_u32 s77, s85, 2884608
    s_add_u32 s78, s85, 2916352
    buffer_load_dwordx4 v10, s[48:51], s77 offen lds
    buffer_load_dwordx4 v10, s[48:51], s78 offen offset:1024 lds
    s_waitcnt vmcnt(15)
    s_barrier
    s_add_u32 m0, s15, 147456
    s_add_u32 s77, s84, 768
    buffer_load_dwordx4 v8, s[44:47], s77 offen offset:0 lds
    s_add_u32 s77, s84, 9984
    buffer_load_dwordx4 v9, s[44:47], s77 offen offset:1024 lds
    s_add_u32 s77, s84, 19200
    buffer_load_dwordx4 v8, s[44:47], s77 offen offset:2048 lds
    s_add_u32 m0, s14, 131072
    s_add_u32 s77, s85, 3145728
    s_add_u32 s78, s85, 3177472
    buffer_load_dwordx4 v10, s[48:51], s77 offen lds
    buffer_load_dwordx4 v10, s[48:51], s78 offen offset:1024 lds
    s_add_u32 m0, s14, 139264
    s_add_u32 s77, s85, 3146752
    s_add_u32 s78, s85, 3178496
    buffer_load_dwordx4 v10, s[48:51], s77 offen lds
    buffer_load_dwordx4 v10, s[48:51], s78 offen offset:1024 lds
    s_waitcnt vmcnt(18)
    s_barrier
    s_add_u32 m0, s14, 65536
    s_add_u32 s77, s85, 3407872
    s_add_u32 s78, s85, 3439616
    buffer_load_dwordx4 v10, s[48:51], s77 offen lds
    buffer_load_dwordx4 v10, s[48:51], s78 offen offset:1024 lds
    s_add_u32 m0, s14, 73728
    s_add_u32 s77, s85, 3408896
    s_add_u32 s78, s85, 3440640
    buffer_load_dwordx4 v10, s[48:51], s77 offen lds
    buffer_load_dwordx4 v10, s[48:51], s78 offen offset:1024 lds
    s_waitcnt vmcnt(15)
    s_barrier
    s_add_u32 m0, s15, 16384
    s_add_u32 s77, s84, 896
    buffer_load_dwordx4 v8, s[44:47], s77 offen offset:0 lds
    s_add_u32 s77, s84, 10112
    buffer_load_dwordx4 v9, s[44:47], s77 offen offset:1024 lds
    s_add_u32 s77, s84, 19328
    buffer_load_dwordx4 v8, s[44:47], s77 offen offset:2048 lds
    s_add_u32 m0, s14, 81920
    s_add_u32 s77, s85, 3670016
    s_add_u32 s78, s85, 3701760
    buffer_load_dwordx4 v10, s[48:51], s77 offen lds
    buffer_load_dwordx4 v10, s[48:51], s78 offen offset:1024 lds
    s_add_u32 m0, s14, 90112
    s_add_u32 s77, s85, 3671040
    s_add_u32 s78, s85, 3702784
    buffer_load_dwordx4 v10, s[48:51], s77 offen lds
    buffer_load_dwordx4 v10, s[48:51], s78 offen offset:1024 lds
    s_waitcnt vmcnt(18)
    s_barrier
    s_add_u32 m0, s14, 98304
    s_add_u32 s77, s85, 3932160
    s_add_u32 s78, s85, 3963904
    buffer_load_dwordx4 v10, s[48:51], s77 offen lds
    buffer_load_dwordx4 v10, s[48:51], s78 offen offset:1024 lds
    s_add_u32 m0, s14, 106496
    s_add_u32 s77, s85, 3933184
    s_add_u32 s78, s85, 3964928
    buffer_load_dwordx4 v10, s[48:51], s77 offen lds
    buffer_load_dwordx4 v10, s[48:51], s78 offen offset:1024 lds
    s_waitcnt vmcnt(15)
    s_barrier
    s_add_u32 m0, s15, 49152
    s_add_u32 s77, s84, 1024
    buffer_load_dwordx4 v8, s[44:47], s77 offen offset:0 lds
    s_add_u32 s77, s84, 10240
    buffer_load_dwordx4 v9, s[44:47], s77 offen offset:1024 lds
    s_add_u32 s77, s84, 19456
    buffer_load_dwordx4 v8, s[44:47], s77 offen offset:2048 lds
    s_add_u32 m0, s14, 114688
    s_add_u32 s77, s85, 4194304
    s_add_u32 s78, s85, 4226048
    buffer_load_dwordx4 v10, s[48:51], s77 offen lds
    buffer_load_dwordx4 v10, s[48:51], s78 offen offset:1024 lds
    s_add_u32 m0, s14, 122880
    s_add_u32 s77, s85, 4195328
    s_add_u32 s78, s85, 4227072
    buffer_load_dwordx4 v10, s[48:51], s77 offen lds
    buffer_load_dwordx4 v10, s[48:51], s78 offen offset:1024 lds
    s_waitcnt vmcnt(18)
    s_barrier
    s_add_u32 m0, s14, 131072
    s_add_u32 s77, s85, 4456448
    s_add_u32 s78, s85, 4488192
    buffer_load_dwordx4 v10, s[48:51], s77 offen lds
    buffer_load_dwordx4 v10, s[48:51], s78 offen offset:1024 lds
    s_add_u32 m0, s14, 139264
    s_add_u32 s77, s85, 4457472
    s_add_u32 s78, s85, 4489216
    buffer_load_dwordx4 v10, s[48:51], s77 offen lds
    buffer_load_dwordx4 v10, s[48:51], s78 offen offset:1024 lds
    s_waitcnt vmcnt(15)
    s_barrier
    s_add_u32 m0, s15, 147456
    s_add_u32 s77, s84, 1152
    buffer_load_dwordx4 v8, s[44:47], s77 offen offset:0 lds
    s_add_u32 s77, s84, 10368
    buffer_load_dwordx4 v9, s[44:47], s77 offen offset:1024 lds
    s_add_u32 s77, s84, 19584
    buffer_load_dwordx4 v8, s[44:47], s77 offen offset:2048 lds
    s_add_u32 m0, s14, 65536
    s_add_u32 s77, s85, 4718592
    s_add_u32 s78, s85, 4750336
    buffer_load_dwordx4 v10, s[48:51], s77 offen lds
    buffer_load_dwordx4 v10, s[48:51], s78 offen offset:1024 lds
    s_add_u32 m0, s14, 73728
    s_add_u32 s77, s85, 4719616
    s_add_u32 s78, s85, 4751360
    buffer_load_dwordx4 v10, s[48:51], s77 offen lds
    buffer_load_dwordx4 v10, s[48:51], s78 offen offset:1024 lds
    s_waitcnt vmcnt(18)
    s_barrier
    s_add_u32 m0, s14, 81920
    s_add_u32 s77, s85, 4980736
    s_add_u32 s78, s85, 5012480
    buffer_load_dwordx4 v10, s[48:51], s77 offen lds
    buffer_load_dwordx4 v10, s[48:51], s78 offen offset:1024 lds
    s_add_u32 m0, s14, 90112
    s_add_u32 s77, s85, 4981760
    s_add_u32 s78, s85, 5013504
    buffer_load_dwordx4 v10, s[48:51], s77 offen lds
    buffer_load_dwordx4 v10, s[48:51], s78 offen offset:1024 lds
    s_waitcnt vmcnt(15)
    s_barrier
    s_waitcnt vmcnt(11)
    s_barrier
    s_waitcnt vmcnt(4)
    s_barrier
    s_waitcnt vmcnt(0)
    s_barrier
L_head:
    s_lshl_b32 s77, s4, 13
    s_add_u32 s77, s77, 65536
    s_mov_b32 s78, 2048
    s_cmp_eq_u32 s4, 2
    s_cselect_b32 s77, 98304, s77
    s_cselect_b32 s78, 20480, s78
    v_add_u32 v248, s77, v1
    v_add_u32 v249, s78, v248
    v_add_u32 v250, s78, v249
    v_add_u32 v251, s78, v250
    s_barrier
    ds_read_b128 v[8:11], v248 offset:0
    ds_read_b128 v[152:155], v232 offset:0
    ds_read_b128 v[12:15], v248 offset:1024
    ds_read_b128 v[156:159], v233 offset:0
    ds_read_b128 v[16:19], v249 offset:0
    ds_read_b128 v[160:163], v234 offset:0
    ds_read_b128 v[20:23], v249 offset:1024
    ds_read_b128 v[164:167], v235 offset:0
    ds_read_b128 v[24:27], v250 offset:0
    ds_read_b128 v[168:171], v236 offset:0
    ds_read_b128 v[28:31], v250 offset:1024
    ds_read_b128 v[172:175], v237 offset:0
    ds_read_b128 v[32:35], v251 offset:0
    ds_read_b128 v[176:179], v238 offset:0
    ds_read_b128 v[36:39], v251 offset:1024
    s_waitcnt lgkmcnt(13)
    ds_read_b128 v[180:183], v239 offset:0
    v_mfma_f32_32x32x16_bf16 v[104:119], v[152:155], v[8:11], 0
    v_mov_b32 v40, 0
    v_mov_b32 v41, 0
    v_mov_b32 v42, 0
    v_mov_b32 v43, 0
    v_mov_b32 v44, 0
    v_mov_b32 v45, 0
    v_mov_b32 v46, 0
    v_mov_b32 v47, 0
    s_waitcnt lgkmcnt(12)
    v_mfma_f32_32x32x16_bf16 v[104:119], v[156:159], v[12:15], v[104:119]
    v_mov_b32 v48, 0
    v_mov_b32 v49, 0
    v_mov_b32 v50, 0
    v_mov_b32 v51, 0
    v_mov_b32 v52, 0
    v_mov_b32 v53, 0
    v_mov_b32 v54, 0
    v_mov_b32 v55, 0
    s_waitcnt lgkmcnt(10)
    v_mfma_f32_32x32x16_bf16 v[104:119], v[160:163], v[16:19], v[104:119]
    v_mov_b32 v56, 0
    v_mov_b32 v57, 0
    v_mov_b32 v58, 0
    v_mov_b32 v59, 0
    v_mov_b32 v60, 0
    v_mov_b32 v61, 0
    v_mov_b32 v62, 0
    v_mov_b32 v63, 0
    s_waitcnt lgkmcnt(8)
    v_mfma_f32_32x32x16_bf16 v[104:119], v[164:167], v[20:23], v[104:119]
    v_mov_b32 v64, 0
    v_mov_b32 v65, 0
    v_mov_b32 v66, 0
    v_mov_b32 v67, 0
    v_mov_b32 v68, 0
    v_mov_b32 v69, 0
    v_mov_b32 v70, 0
    v_mov_b32 v71, 0
    s_waitcnt lgkmcnt(6)
    v_mfma_f32_32x32x16_bf16 v[104:119], v[168:171], v[24:27], v[104:119]
    v_mov_b32 v72, 0
    v_mov_b32 v73, 0
    v_mov_b32 v74, 0
    v_mov_b32 v75, 0
    v_mov_b32 v76, 0
    v_mov_b32 v77, 0
    v_mov_b32 v78, 0
    v_mov_b32 v79, 0
    s_waitcnt lgkmcnt(4)
    v_mfma_f32_32x32x16_bf16 v[104:119], v[172:175], v[28:31], v[104:119]
    v_mov_b32 v80, 0
    v_mov_b32 v81, 0
    v_mov_b32 v82, 0
    v_mov_b32 v83, 0
    v_mov_b32 v84, 0
    v_mov_b32 v85, 0
    v_mov_b32 v86, 0
    v_mov_b32 v87, 0
    s_waitcnt lgkmcnt(2)
    v_mfma_f32_32x32x16_bf16 v[104:119], v[176:179], v[32:35], v[104:119]
    v_mov_b32 v88, 0
    v_mov_b32 v89, 0
    v_mov_b32 v90, 0
    v_mov_b32 v91, 0
    v_mov_b32 v92, 0
    v_mov_b32 v93, 0
    v_mov_b32 v94, 0
    v_mov_b32 v95, 0
    s_waitcnt lgkmcnt(0)
    v_mfma_f32_32x32x16_bf16 v[104:119], v[180:183], v[36:39], v[104:119]
    v_mov_b32 v96, 0
    v_mov_b32 v97, 0
    v_mov_b32 v98, 0
    v_mov_b32 v99, 0
    v_mov_b32 v100, 0
    v_mov_b32 v101, 0
    v_mov_b32 v102, 0
    v_mov_b32 v103, 0
    s_barrier
    ds_read_b128 v[152:155], v232 offset:8192
    ds_read_b128 v[156:159], v233 offset:8192
    ds_read_b128 v[160:163], v234 offset:8192
    ds_read_b128 v[164:167], v235 offset:8192
    ds_read_b128 v[168:171], v236 offset:8192
    ds_read_b128 v[172:175], v237 offset:8192
    ds_read_b128 v[176:179], v238 offset:8192
    ds_read_b128 v[180:183], v239 offset:8192
    ds_read_b64_tr_b16 v[184:185], v240 offset:32768
    ds_read_b64_tr_b16 v[186:187], v240 offset:34816
    ds_read_b64_tr_b16 v[188:189], v241 offset:32768
    ds_read_b64_tr_b16 v[190:191], v241 offset:34816
    ds_read_b64_tr_b16 v[192:193], v242 offset:32768
    ds_read_b64_tr_b16 v[194:195], v242 offset:34816
    v_max3_f32 v4, v104, v105, v106
    v_max3_f32 v5, v107, v108, v109
    v_max3_f32 v4, v4, v110, v111
    v_max3_f32 v5, v5, v112, v113
    v_max3_f32 v4, v4, v114, v115
    v_max3_f32 v5, v5, v116, v117
    v_max3_f32 v4, v4, v118, v119
    v_max_f32 v4, v4, v5
    v_mov_b32 v5, v4
    s_nop 1
    v_permlane32_swap_b32 v4, v5
    s_nop 0
    v_max_f32 v3, v4, v5
    v_sub_f32 v216, 0, v3
    v_sub_f32 v217, 0, v3
    v_sub_f32 v218, 0, v3
    v_sub_f32 v219, 0, v3
    v_sub_f32 v220, 0, v3
    v_sub_f32 v221, 0, v3
    v_sub_f32 v222, 0, v3
    v_sub_f32 v223, 0, v3
    v_sub_f32 v224, 0, v3
    v_sub_f32 v225, 0, v3
    v_sub_f32 v226, 0, v3
    v_sub_f32 v227, 0, v3
    v_sub_f32 v228, 0, v3
    v_sub_f32 v229, 0, v3
    v_sub_f32 v230, 0, v3
    v_sub_f32 v231, 0, v3
    s_waitcnt lgkmcnt(6)
    s_nop 0
    v_mfma_f32_32x32x16_bf16 v[120:135], v[152:155], v[8:11], v[216:231]
    ds_read_b64_tr_b16 v[196:197], v243 offset:32768
    ds_read_b64_tr_b16 v[198:199], v243 offset:34816
    v_sub_f32 v104, v104, v3
    v_sub_f32 v105, v105, v3
    v_sub_f32 v106, v106, v3
    v_sub_f32 v107, v107, v3
    v_sub_f32 v108, v108, v3
    v_sub_f32 v109, v109, v3
    v_sub_f32 v110, v110, v3
    v_mfma_f32_32x32x16_bf16 v[120:135], v[156:159], v[12:15], v[120:135]
    ds_read_b64_tr_b16 v[200:201], v240 offset:36864
    ds_read_b64_tr_b16 v[202:203], v240 offset:38912
    ds_read_b64_tr_b16 v[204:205], v241 offset:36864
    ds_read_b64_tr_b16 v[206:207], v241 offset:38912
    v_sub_f32 v111, v111, v3
    v_sub_f32 v112, v112, v3
    v_sub_f32 v113, v113, v3
    v_sub_f32 v114, v114, v3
    v_sub_f32 v115, v115, v3
    v_sub_f32 v116, v116, v3
    v_sub_f32 v117, v117, v3
    v_mfma_f32_32x32x16_bf16 v[120:135], v[160:163], v[16:19], v[120:135]
    ds_read_b64_tr_b16 v[208:209], v242 offset:36864
    ds_read_b64_tr_b16 v[210:211], v242 offset:38912
    ds_read_b64_tr_b16 v[212:213], v243 offset:36864
    ds_read_b64_tr_b16 v[214:215], v243 offset:38912
    v_sub_f32 v118, v118, v3
    v_sub_f32 v119, v119, v3
    v_exp_f32 v248, v104
    v_exp_f32 v249, v105
    v_exp_f32 v250, v106
    v_mov_b32 v244, v248
    v_exp_f32 v251, v107
    v_mfma_f32_32x32x16_bf16 v[120:135], v[164:167], v[20:23], v[120:135]
    v_mov_b32 v245, v249
    v_cvt_pk_bf16_f32 v136, v248, v249
    v_exp_f32 v252, v108
    v_add_f32 v244, v244, v250
    v_exp_f32 v253, v109
    v_add_f32 v245, v245, v251
    v_cvt_pk_bf16_f32 v137, v250, v251
    v_mfma_f32_32x32x16_bf16 v[120:135], v[168:171], v[24:27], v[120:135]
    v_exp_f32 v254, v110
    v_add_f32 v244, v244, v252
    v_exp_f32 v255, v111
    v_add_f32 v245, v245, v253
    v_cvt_pk_bf16_f32 v138, v252, v253
    v_exp_f32 v248, v112
    v_add_f32 v244, v244, v254
    v_mfma_f32_32x32x16_bf16 v[120:135], v[172:175], v[28:31], v[120:135]
    v_exp_f32 v249, v113
    v_add_f32 v245, v245, v255
    v_cvt_pk_bf16_f32 v139, v254, v255
    v_exp_f32 v250, v114
    v_add_f32 v244, v244, v248
    v_exp_f32 v251, v115
    v_add_f32 v245, v245, v249
    v_mfma_f32_32x32x16_bf16 v[120:135], v[176:179], v[32:35], v[120:135]
    v_cvt_pk_bf16_f32 v140, v248, v249
    v_exp_f32 v252, v116
    v_add_f32 v244, v244, v250
    v_exp_f32 v253, v117
    v_add_f32 v245, v245, v251
    v_cvt_pk_bf16_f32 v141, v250, v251
    v_exp_f32 v254, v118
    v_mfma_f32_32x32x16_bf16 v[120:135], v[180:183], v[36:39], v[120:135]
    v_add_f32 v244, v244, v252
    v_exp_f32 v255, v119
    v_add_f32 v245, v245, v253
    v_cvt_pk_bf16_f32 v142, v252, v253
    v_add_f32 v244, v244, v254
    v_add_f32 v245, v245, v255
    v_cvt_pk_bf16_f32 v143, v254, v255
    s_waitcnt lgkmcnt(0)
    s_cmp_eq_u32 s80, 0
    s_cbranch_scc1 L_noflag
    v_readfirstlane_b32 s76, v7
    s_waitcnt vmcnt(0)
    s_lshr_b32 s77, s86, 6
    s_add_u32 s77, s77, 12582912
    v_mov_b32 v248, s76
    v_mov_b32 v249, 0
    s_mov_b64 exec, 1
    buffer_store_dword v248, v249, s[64:67], s77 offen sc1
    s_mov_b64 exec, -1
L_noflag:
    s_mov_b32 s79, 8
    s_branch L_a2
L_aloop:
    s_barrier
    ds_read_b128 v[152:155], v232 offset:0
    ds_read_b128 v[156:159], v233 offset:0
    v_mfma_f32_32x32x16_bf16 v[40:55], v[184:187], v[136:139], v[40:55]
    ds_read_b128 v[160:163], v234 offset:0
    ds_read_b128 v[164:167], v235 offset:0
    v_mfma_f32_32x32x16_bf16 v[56:71], v[188:191], v[136:139], v[56:71]
    ds_read_b128 v[168:171], v236 offset:0
    ds_read_b128 v[172:175], v237 offset:0
    v_mfma_f32_32x32x16_bf16 v[72:87], v[192:195], v[136:139], v[72:87]
    ds_read_b128 v[176:179], v238 offset:0
    ds_read_b128 v[180:183], v239 offset:0
    v_exp_f32 v248, v120
    v_exp_f32 v249, v121
    v_exp_f32 v250, v122
    v_mfma_f32_32x32x16_bf16 v[88:103], v[196:199], v[136:139], v[88:103]
    v_add_f32 v246, v244, v248
    v_exp_f32 v251, v123
    v_add_f32 v247, v245, v249
    v_mfma_f32_32x32x16_bf16 v[40:55], v[200:203], v[140:143], v[40:55]
    v_cvt_pk_bf16_f32 v144, v248, v249
    v_exp_f32 v252, v124
    v_add_f32 v246, v246, v250
    ds_read_b64_tr_b16 v[184:185], v240 offset:57344
    ds_read_b64_tr_b16 v[186:187], v240 offset:59392
    v_mfma_f32_32x32x16_bf16 v[56:71], v[204:207], v[140:143], v[56:71]
    v_exp_f32 v253, v125
    v_add_f32 v247, v247, v251
    v_cvt_pk_bf16_f32 v145, v250, v251
    ds_read_b64_tr_b16 v[188:189], v241 offset:57344
    ds_read_b64_tr_b16 v[190:191], v241 offset:59392
    v_mfma_f32_32x32x16_bf16 v[72:87], v[208:211], v[140:143], v[72:87]
    v_exp_f32 v254, v126
    v_add_f32 v246, v246, v252
    v_exp_f32 v255, v127
    ds_read_b64_tr_b16 v[192:193], v242 offset:57344
    ds_read_b64_tr_b16 v[194:195], v242 offset:59392
    v_mfma_f32_32x32x16_bf16 v[88:103], v[212:215], v[140:143], v[88:103]
    v_add_f32 v247, v247, v253
    v_cvt_pk_bf16_f32 v146, v252, v253
    v_exp_f32 v248, v128
    ds_read_b64_tr_b16 v[196:197], v243 offset:57344
    ds_read_b64_tr_b16 v[198:199], v243 offset:59392
    s_waitcnt lgkmcnt(8)
    v_mfma_f32_32x32x16_bf16 v[104:119], v[152:155], v[8:11], v[216:231]
    v_add_f32 v246, v246, v254
    v_exp_f32 v249, v129
    v_add_f32 v247, v247, v255
    ds_read_b64_tr_b16 v[200:201], v240 offset:61440
    ds_read_b64_tr_b16 v[202:203], v240 offset:63488
    v_mfma_f32_32x32x16_bf16 v[104:119], v[156:159], v[12:15], v[104:119]
    v_cvt_pk_bf16_f32 v147, v254, v255
    v_exp_f32 v250, v130
    v_add_f32 v246, v246, v248
    ds_read_b64_tr_b16 v[204:205], v241 offset:61440
    ds_read_b64_tr_b16 v[206:207], v241 offset:63488
    v_mfma_f32_32x32x16_bf16 v[104:119], v[160:163], v[16:19], v[104:119]
    v_exp_f32 v251, v131
    v_add_f32 v247, v247, v249
    v_cvt_pk_bf16_f32 v148, v248, v249
    ds_read_b64_tr_b16 v[208:209], v242 offset:61440
    ds_read_b64_tr_b16 v[210:211], v242 offset:63488
    v_mfma_f32_32x32x16_bf16 v[104:119], v[164:167], v[20:23], v[104:119]
    v_exp_f32 v252, v132
    v_add_f32 v246, v246, v250
    v_exp_f32 v253, v133
    ds_read_b64_tr_b16 v[212:213], v243 offset:61440
    ds_read_b64_tr_b16 v[214:215], v243 offset:63488
    v_mfma_f32_32x32x16_bf16 v[104:119], v[168:171], v[24:27], v[104:119]
    v_add_f32 v247, v247, v251
    v_cvt_pk_bf16_f32 v149, v250, v251
    v_exp_f32 v254, v134
    v_mfma_f32_32x32x16_bf16 v[104:119], v[172:175], v[28:31], v[104:119]
    v_add_f32 v246, v246, v252
    v_exp_f32 v255, v135
    v_add_f32 v247, v247, v253
    v_mfma_f32_32x32x16_bf16 v[104:119], v[176:179], v[32:35], v[104:119]
    v_cvt_pk_bf16_f32 v150, v252, v253
    v_add_f32 v246, v246, v254
    v_add_f32 v247, v247, v255
    v_cvt_pk_bf16_f32 v151, v254, v255
    v_mfma_f32_32x32x16_bf16 v[104:119], v[180:183], v[36:39], v[104:119]
    v_max_f32 v4, v246, v247
    v_cmp_lt_f32 vcc, s81, v4
    s_cbranch_vccnz L_rare0
L_back0:
    s_waitcnt lgkmcnt(0)
    s_barrier
    ds_read_b128 v[152:155], v232 offset:8192
    ds_read_b128 v[156:159], v233 offset:8192
    v_mfma_f32_32x32x16_bf16 v[40:55], v[184:187], v[144:147], v[40:55]
    ds_read_b128 v[160:163], v234 offset:8192
    ds_read_b128 v[164:167], v235 offset:8192
    v_mfma_f32_32x32x16_bf16 v[56:71], v[188:191], v[144:147], v[56:71]
    ds_read_b128 v[168:171], v236 offset:8192
    ds_read_b128 v[172:175], v237 offset:8192
    v_mfma_f32_32x32x16_bf16 v[72:87], v[192:195], v[144:147], v[72:87]
    ds_read_b128 v[176:179], v238 offset:8192
    ds_read_b128 v[180:183], v239 offset:8192
    v_exp_f32 v248, v104
    v_exp_f32 v249, v105
    v_exp_f32 v250, v106
    v_mfma_f32_32x32x16_bf16 v[88:103], v[196:199], v[144:147], v[88:103]
    v_add_f32 v244, v246, v248
    v_exp_f32 v251, v107
    v_add_f32 v245, v247, v249
    v_mfma_f32_32x32x16_bf16 v[40:55], v[200:203], v[148:151], v[40:55]
    v_cvt_pk_bf16_f32 v136, v248, v249
    v_exp_f32 v252, v108
    v_add_f32 v244, v244, v250
    ds_read_b64_tr_b16 v[184:185], v240 offset:32768
    ds_read_b64_tr_b16 v[186:187], v240 offset:34816
    v_mfma_f32_32x32x16_bf16 v[56:71], v[204:207], v[148:151], v[56:71]
    v_exp_f32 v253, v109
    v_add_f32 v245, v245, v251
    v_cvt_pk_bf16_f32 v137, v250, v251
    ds_read_b64_tr_b16 v[188:189], v241 offset:32768
    ds_read_b64_tr_b16 v[190:191], v241 offset:34816
    v_mfma_f32_32x32x16_bf16 v[72:87], v[208:211], v[148:151], v[72:87]
    v_exp_f32 v254, v110
    v_add_f32 v244, v244, v252
    v_exp_f32 v255, v111
    ds_read_b64_tr_b16 v[192:193], v242 offset:32768
    ds_read_b64_tr_b16 v[194:195], v242 offset:34816
    v_mfma_f32_32x32x16_bf16 v[88:103], v[212:215], v[148:151], v[88:103]
    v_add_f32 v245, v245, v253
    v_cvt_pk_bf16_f32 v138, v252, v253
    v_exp_f32 v248, v112
    ds_read_b64_tr_b16 v[196:197], v243 offset:32768
    ds_read_b64_tr_b16 v[198:199], v243 offset:34816
    s_waitcnt lgkmcnt(8)
    v_mfma_f32_32x32x16_bf16 v[120:135], v[152:155], v[8:11], v[216:231]
    v_add_f32 v244, v244, v254
    v_exp_f32 v249, v113
    v_add_f32 v245, v245, v255
    ds_read_b64_tr_b16 v[200:201], v240 offset:36864
    ds_read_b64_tr_b16 v[202:203], v240 offset:38912
    v_mfma_f32_32x32x16_bf16 v[120:135], v[156:159], v[12:15], v[120:135]
    v_cvt_pk_bf16_f32 v139, v254, v255
    v_exp_f32 v250, v114
    v_add_f32 v244, v244, v248
    ds_read_b64_tr_b16 v[204:205], v241 offset:36864
    ds_read_b64_tr_b16 v[206:207], v241 offset:38912
    v_mfma_f32_32x32x16_bf16 v[120:135], v[160:163], v[16:19], v[120:135]
    v_exp_f32 v251, v115
    v_add_f32 v245, v245, v249
    v_cvt_pk_bf16_f32 v140, v248, v249
    ds_read_b64_tr_b16 v[208:209], v242 offset:36864
    ds_read_b64_tr_b16 v[210:211], v242 offset:38912
    v_mfma_f32_32x32x16_bf16 v[120:135], v[164:167], v[20:23], v[120:135]
    v_exp_f32 v252, v116
    v_add_f32 v244, v244, v250
    v_exp_f32 v253, v117
    ds_read_b64_tr_b16 v[212:213], v243 offset:36864
    ds_read_b64_tr_b16 v[214:215], v243 offset:38912
    v_mfma_f32_32x32x16_bf16 v[120:135], v[168:171], v[24:27], v[120:135]
    v_add_f32 v245, v245, v251
    v_cvt_pk_bf16_f32 v141, v250, v251
    v_exp_f32 v254, v118
    v_mfma_f32_32x32x16_bf16 v[120:135], v[172:175], v[28:31], v[120:135]
    v_add_f32 v244, v244, v252
    v_exp_f32 v255, v119
    v_add_f32 v245, v245, v253
    v_mfma_f32_32x32x16_bf16 v[120:135], v[176:179], v[32:35], v[120:135]
    v_cvt_pk_bf16_f32 v142, v252, v253
    v_add_f32 v244, v244, v254
    v_add_f32 v245, v245, v255
    v_cvt_pk_bf16_f32 v143, v254, v255
    v_mfma_f32_32x32x16_bf16 v[120:135], v[180:183], v[36:39], v[120:135]
    v_max_f32 v4, v244, v245
    v_cmp_lt_f32 vcc, s81, v4
    s_cbranch_vccnz L_rare1
L_back1:
    s_waitcnt lgkmcnt(0)
L_a2:
    s_barrier
    ds_read_b128 v[152:155], v232 offset:16384
    ds_read_b128 v[156:159], v233 offset:16384
    v_mfma_f32_32x32x16_bf16 v[40:55], v[184:187], v[136:139], v[40:55]
    ds_read_b128 v[160:163], v234 offset:16384
    ds_read_b128 v[164:167], v235 offset:16384
    v_mfma_f32_32x32x16_bf16 v[56:71], v[188:191], v[136:139], v[56:71]
    ds_read_b128 v[168:171], v236 offset:16384
    ds_read_b128 v[172:175], v237 offset:16384
    v_mfma_f32_32x32x16_bf16 v[72:87], v[192:195], v[136:139], v[72:87]
    ds_read_b128 v[176:179], v238 offset:16384
    ds_read_b128 v[180:183], v239 offset:16384
    v_exp_f32 v248, v120
    v_exp_f32 v249, v121
    v_exp_f32 v250, v122
    v_mfma_f32_32x32x16_bf16 v[88:103], v[196:199], v[136:139], v[88:103]
    v_add_f32 v246, v244, v248
    v_exp_f32 v251, v123
    v_add_f32 v247, v245, v249
    v_mfma_f32_32x32x16_bf16 v[40:55], v[200:203], v[140:143], v[40:55]
    v_cvt_pk_bf16_f32 v144, v248, v249
    v_exp_f32 v252, v124
    v_add_f32 v246, v246, v250
    ds_read_b64_tr_b16 v[184:185], v240 offset:40960
    ds_read_b64_tr_b16 v[186:187], v240 offset:43008
    v_mfma_f32_32x32x16_bf16 v[56:71], v[204:207], v[140:143], v[56:71]
    v_exp_f32 v253, v125
    v_add_f32 v247, v247, v251
    v_cvt_pk_bf16_f32 v145, v250, v251
    ds_read_b64_tr_b16 v[188:189], v241 offset:40960
    ds_read_b64_tr_b16 v[190:191], v241 offset:43008
    v_mfma_f32_32x32x16_bf16 v[72:87], v[208:211], v[140:143], v[72:87]
    v_exp_f32 v254, v126
    v_add_f32 v246, v246, v252
    v_exp_f32 v255, v127
    ds_read_b64_tr_b16 v[192:193], v242 offset:40960
    ds_read_b64_tr_b16 v[194:195], v242 offset:43008
    v_mfma_f32_32x32x16_bf16 v[88:103], v[212:215], v[140:143], v[88:103]
    v_add_f32 v247, v247, v253
    v_cvt_pk_bf16_f32 v146, v252, v253
    v_exp_f32 v248, v128
    ds_read_b64_tr_b16 v[196:197], v243 offset:40960
    ds_read_b64_tr_b16 v[198:199], v243 offset:43008
    s_waitcnt lgkmcnt(8)
    v_mfma_f32_32x32x16_bf16 v[104:119], v[152:155], v[8:11], v[216:231]
    v_add_f32 v246, v246, v254
    v_exp_f32 v249, v129
    v_add_f32 v247, v247, v255
    ds_read_b64_tr_b16 v[200:201], v240 offset:45056
    ds_read_b64_tr_b16 v[202:203], v240 offset:47104
    v_mfma_f32_32x32x16_bf16 v[104:119], v[156:159], v[12:15], v[104:119]
    v_cvt_pk_bf16_f32 v147, v254, v255
    v_exp_f32 v250, v130
    v_add_f32 v246, v246, v248
    ds_read_b64_tr_b16 v[204:205], v241 offset:45056
    ds_read_b64_tr_b16 v[206:207], v241 offset:47104
    v_mfma_f32_32x32x16_bf16 v[104:119], v[160:163], v[16:19], v[104:119]
    v_exp_f32 v251, v131
    v_add_f32 v247, v247, v249
    v_cvt_pk_bf16_f32 v148, v248, v249
    ds_read_b64_tr_b16 v[208:209], v242 offset:45056
    ds_read_b64_tr_b16 v[210:211], v242 offset:47104
    v_mfma_f32_32x32x16_bf16 v[104:119], v[164:167], v[20:23], v[104:119]
    v_exp_f32 v252, v132
    v_add_f32 v246, v246, v250
    v_exp_f32 v253, v133
    ds_read_b64_tr_b16 v[212:213], v243 offset:45056
    ds_read_b64_tr_b16 v[214:215], v243 offset:47104
    v_mfma_f32_32x32x16_bf16 v[104:119], v[168:171], v[24:27], v[104:119]
    v_add_f32 v247, v247, v251
    v_cvt_pk_bf16_f32 v149, v250, v251
    v_exp_f32 v254, v134
    v_mfma_f32_32x32x16_bf16 v[104:119], v[172:175], v[28:31], v[104:119]
    v_add_f32 v246, v246, v252
    v_exp_f32 v255, v135
    v_add_f32 v247, v247, v253
    v_mfma_f32_32x32x16_bf16 v[104:119], v[176:179], v[32:35], v[104:119]
    v_cvt_pk_bf16_f32 v150, v252, v253
    v_add_f32 v246, v246, v254
    v_add_f32 v247, v247, v255
    v_cvt_pk_bf16_f32 v151, v254, v255
    v_mfma_f32_32x32x16_bf16 v[104:119], v[180:183], v[36:39], v[104:119]
    v_max_f32 v4, v246, v247
    v_cmp_lt_f32 vcc, s81, v4
    s_cbranch_vccnz L_rare2
L_back2:
    s_waitcnt lgkmcnt(0)
    s_barrier
    ds_read_b128 v[152:155], v232 offset:24576
    ds_read_b128 v[156:159], v233 offset:24576
    v_mfma_f32_32x32x16_bf16 v[40:55], v[184:187], v[144:147], v[40:55]
    ds_read_b128 v[160:163], v234 offset:24576
    ds_read_b128 v[164:167], v235 offset:24576
    v_mfma_f32_32x32x16_bf16 v[56:71], v[188:191], v[144:147], v[56:71]
    ds_read_b128 v[168:171], v236 offset:24576
    ds_read_b128 v[172:175], v237 offset:24576
    v_mfma_f32_32x32x16_bf16 v[72:87], v[192:195], v[144:147], v[72:87]
    ds_read_b128 v[176:179], v238 offset:24576
    ds_read_b128 v[180:183], v239 offset:24576
    v_exp_f32 v248, v104
    v_exp_f32 v249, v105
    v_exp_f32 v250, v106
    v_mfma_f32_32x32x16_bf16 v[88:103], v[196:199], v[144:147], v[88:103]
    v_add_f32 v244, v246, v248
    v_exp_f32 v251, v107
    v_add_f32 v245, v247, v249
    v_mfma_f32_32x32x16_bf16 v[40:55], v[200:203], v[148:151], v[40:55]
    v_cvt_pk_bf16_f32 v136, v248, v249
    v_exp_f32 v252, v108
    v_add_f32 v244, v244, v250
    ds_read_b64_tr_b16 v[184:185], v240 offset:49152
    ds_read_b64_tr_b16 v[186:187], v240 offset:51200
    v_mfma_f32_32x32x16_bf16 v[56:71], v[204:207], v[148:151], v[56:71]
    v_exp_f32 v253, v109
    v_add_f32 v245, v245, v251
    v_cvt_pk_bf16_f32 v137, v250, v251
    ds_read_b64_tr_b16 v[188:189], v241 offset:49152
    ds_read_b64_tr_b16 v[190:191], v241 offset:51200
    v_mfma_f32_32x32x16_bf16 v[72:87], v[208:211], v[148:151], v[72:87]
    v_exp_f32 v254, v110
    v_add_f32 v244, v244, v252
    v_exp_f32 v255, v111
    ds_read_b64_tr_b16 v[192:193], v242 offset:49152
    ds_read_b64_tr_b16 v[194:195], v242 offset:51200
    v_mfma_f32_32x32x16_bf16 v[88:103], v[212:215], v[148:151], v[88:103]
    v_add_f32 v245, v245, v253
    v_cvt_pk_bf16_f32 v138, v252, v253
    v_exp_f32 v248, v112
    ds_read_b64_tr_b16 v[196:197], v243 offset:49152
    ds_read_b64_tr_b16 v[198:199], v243 offset:51200
    s_waitcnt lgkmcnt(8)
    v_mfma_f32_32x32x16_bf16 v[120:135], v[152:155], v[8:11], v[216:231]
    v_add_f32 v244, v244, v254
    v_exp_f32 v249, v113
    v_add_f32 v245, v245, v255
    ds_read_b64_tr_b16 v[200:201], v240 offset:53248
    ds_read_b64_tr_b16 v[202:203], v240 offset:55296
    v_mfma_f32_32x32x16_bf16 v[120:135], v[156:159], v[12:15], v[120:135]
    v_cvt_pk_bf16_f32 v139, v254, v255
    v_exp_f32 v250, v114
    v_add_f32 v244, v244, v248
    ds_read_b64_tr_b16 v[204:205], v241 offset:53248
    ds_read_b64_tr_b16 v[206:207], v241 offset:55296
    v_mfma_f32_32x32x16_bf16 v[120:135], v[160:163], v[16:19], v[120:135]
    v_exp_f32 v251, v115
    v_add_f32 v245, v245, v249
    v_cvt_pk_bf16_f32 v140, v248, v249
    ds_read_b64_tr_b16 v[208:209], v242 offset:53248
    ds_read_b64_tr_b16 v[210:211], v242 offset:55296
    v_mfma_f32_32x32x16_bf16 v[120:135], v[164:167], v[20:23], v[120:135]
    v_exp_f32 v252, v116
    v_add_f32 v244, v244, v250
    v_exp_f32 v253, v117
    ds_read_b64_tr_b16 v[212:213], v243 offset:53248
    ds_read_b64_tr_b16 v[214:215], v243 offset:55296
    v_mfma_f32_32x32x16_bf16 v[120:135], v[168:171], v[24:27], v[120:135]
    v_add_f32 v245, v245, v251
    v_cvt_pk_bf16_f32 v141, v250, v251
    v_exp_f32 v254, v118
    v_mfma_f32_32x32x16_bf16 v[120:135], v[172:175], v[28:31], v[120:135]
    v_add_f32 v244, v244, v252
    v_exp_f32 v255, v119
    v_add_f32 v245, v245, v253
    v_mfma_f32_32x32x16_bf16 v[120:135], v[176:179], v[32:35], v[120:135]
    v_cvt_pk_bf16_f32 v142, v252, v253
    v_add_f32 v244, v244, v254
    v_add_f32 v245, v245, v255
    v_cvt_pk_bf16_f32 v143, v254, v255
    v_mfma_f32_32x32x16_bf16 v[120:135], v[180:183], v[36:39], v[120:135]
    v_max_f32 v4, v244, v245
    v_cmp_lt_f32 vcc, s81, v4
    s_sub_u32 s79, s79, 1
    s_cbranch_vccnz L_rare3
L_back3:
    s_waitcnt lgkmcnt(0)
    s_cmp_lg_u32 s79, 0
    s_cbranch_scc1 L_aloop
    s_barrier
    s_nop 5
    v_mfma_f32_32x32x16_bf16 v[40:55], v[184:187], v[136:139], v[40:55]
    v_mfma_f32_32x32x16_bf16 v[56:71], v[188:191], v[136:139], v[56:71]
    v_mfma_f32_32x32x16_bf16 v[72:87], v[192:195], v[136:139], v[72:87]
    v_exp_f32 v248, v120
    v_exp_f32 v249, v121
    v_exp_f32 v250, v122
    v_add_f32 v246, v244, v248
    v_exp_f32 v251, v123
    v_add_f32 v247, v245, v249
    v_mfma_f32_32x32x16_bf16 v[88:103], v[196:199], v[136:139], v[88:103]
    v_cvt_pk_bf16_f32 v144, v248, v249
    v_exp_f32 v252, v124
    v_add_f32 v246, v246, v250
    v_exp_f32 v253, v125
    v_add_f32 v247, v247, v251
    v_cvt_pk_bf16_f32 v145, v250, v251
    v_exp_f32 v254, v126
    v_mfma_f32_32x32x16_bf16 v[40:55], v[200:203], v[140:143], v[40:55]
    v_add_f32 v246, v246, v252
    v_exp_f32 v255, v127
    v_add_f32 v247, v247, v253
    v_cvt_pk_bf16_f32 v146, v252, v253
    v_exp_f32 v248, v128
    v_add_f32 v246, v246, v254
    v_exp_f32 v249, v129
    ds_read_b64_tr_b16 v[184:185], v240 offset:57344
    ds_read_b64_tr_b16 v[186:187], v240 offset:59392
    v_mfma_f32_32x32x16_bf16 v[56:71], v[204:207], v[140:143], v[56:71]
    v_add_f32 v247, v247, v255
    v_cvt_pk_bf16_f32 v147, v254, v255
    v_exp_f32 v250, v130
    v_add_f32 v246, v246, v248
    v_exp_f32 v251, v131
    v_add_f32 v247, v247, v249
    ds_read_b64_tr_b16 v[188:189], v241 offset:57344
    ds_read_b64_tr_b16 v[190:191], v241 offset:59392
    ds_read_b64_tr_b16 v[192:193], v242 offset:57344
    v_mfma_f32_32x32x16_bf16 v[72:87], v[208:211], v[140:143], v[72:87]
    v_cvt_pk_bf16_f32 v148, v248, v249
    v_exp_f32 v252, v132
    v_add_f32 v246, v246, v250
    v_exp_f32 v253, v133
    v_add_f32 v247, v247, v251
    v_cvt_pk_bf16_f32 v149, v250, v251
    v_exp_f32 v254, v134
    ds_read_b64_tr_b16 v[194:195], v242 offset:59392
    ds_read_b64_tr_b16 v[196:197], v243 offset:57344
    ds_read_b64_tr_b16 v[198:199], v243 offset:59392
    v_mfma_f32_32x32x16_bf16 v[88:103], v[212:215], v[140:143], v[88:103]
    ds_read_b64_tr_b16 v[200:201], v240 offset:61440
    ds_read_b64_tr_b16 v[202:203], v240 offset:63488
    ds_read_b64_tr_b16 v[204:205], v241 offset:61440
    ds_read_b64_tr_b16 v[206:207], v241 offset:63488
    ds_read_b64_tr_b16 v[208:209], v242 offset:61440
    ds_read_b64_tr_b16 v[210:211], v242 offset:63488
    ds_read_b64_tr_b16 v[212:213], v243 offset:61440
    ds_read_b64_tr_b16 v[214:215], v243 offset:63488
    v_add_f32 v246, v246, v252
    v_exp_f32 v255, v135
    v_add_f32 v247, v247, v253
    v_cvt_pk_bf16_f32 v150, v252, v253
    v_add_f32 v246, v246, v254
    v_add_f32 v247, v247, v255
    v_cvt_pk_bf16_f32 v151, v254, v255
    v_max_f32 v4, v246, v247
    v_cmp_lt_f32 vcc, s81, v4
    s_cbranch_vccnz L_rare4
L_back4:
    s_waitcnt lgkmcnt(0)
    s_barrier
    v_mov_b32 v7, 161792
    ds_read_b32 v7, v7
    v_mfma_f32_32x32x16_bf16 v[40:55], v[184:187], v[144:147], v[40:55]
    v_mfma_f32_32x32x16_bf16 v[56:71], v[188:191], v[144:147], v[56:71]
    v_mfma_f32_32x32x16_bf16 v[72:87], v[192:195], v[144:147], v[72:87]
    v_mfma_f32_32x32x16_bf16 v[88:103], v[196:199], v[144:147], v[88:103]
    v_mfma_f32_32x32x16_bf16 v[40:55], v[200:203], v[148:151], v[40:55]
    v_mfma_f32_32x32x16_bf16 v[56:71], v[204:207], v[148:151], v[56:71]
    v_mfma_f32_32x32x16_bf16 v[72:87], v[208:211], v[148:151], v[72:87]
    v_mfma_f32_32x32x16_bf16 v[88:103], v[212:215], v[148:151], v[88:103]
    v_add_f32 v246, v246, v247
    v_mov_b32 v247, v246
    s_nop 1
    v_permlane32_swap_b32 v246, v247
    s_nop 0
    v_add_f32 v246, v246, v247
    v_rcp_f32 v246, v246
    s_mul_i32 s86, s5, 24
    s_mul_i32 s87, s6, 3
    s_add_u32 s86, s86, s87
    s_add_u32 s86, s86, s4
    s_lshl_b32 s86, s86, 5
    s_add_u32 s86, s86, s91
    s_lshl_b32 s86, s86, 13
    s_add_u32 s87, s86, 4096
    s_nop 1
    v_mul_f32 v40, v40, v246
    v_mul_f32 v41, v41, v246
    v_mul_f32 v42, v42, v246
    v_mul_f32 v43, v43, v246
    v_mul_f32 v44, v44, v246
    v_mul_f32 v45, v45, v246
    v_mul_f32 v46, v46, v246
    v_mul_f32 v47, v47, v246
    v_cvt_pk_bf16_f32 v184, v40, v41
    v_cvt_pk_bf16_f32 v185, v42, v43
    v_cvt_pk_bf16_f32 v186, v44, v45
    v_cvt_pk_bf16_f32 v187, v46, v47
    buffer_store_dwordx4 v[184:187], v1, s[64:67], s86 offen offset:0 sc1
    v_mul_f32 v48, v48, v246
    v_mul_f32 v49, v49, v246
    v_mul_f32 v50, v50, v246
    v_mul_f32 v51, v51, v246
    v_mul_f32 v52, v52, v246
    v_mul_f32 v53, v53, v246
    v_mul_f32 v54, v54, v246
    v_mul_f32 v55, v55, v246
    v_cvt_pk_bf16_f32 v188, v48, v49
    v_cvt_pk_bf16_f32 v189, v50, v51
    v_cvt_pk_bf16_f32 v190, v52, v53
    v_cvt_pk_bf16_f32 v191, v54, v55
    buffer_store_dwordx4 v[188:191], v1, s[64:67], s86 offen offset:1024 sc1
    v_mul_f32 v56, v56, v246
    v_mul_f32 v57, v57, v246
    v_mul_f32 v58, v58, v246
    v_mul_f32 v59, v59, v246
    v_mul_f32 v60, v60, v246
    v_mul_f32 v61, v61, v246
    v_mul_f32 v62, v62, v246
    v_mul_f32 v63, v63, v246
    v_cvt_pk_bf16_f32 v192, v56, v57
    v_cvt_pk_bf16_f32 v193, v58, v59
    v_cvt_pk_bf16_f32 v194, v60, v61
    v_cvt_pk_bf16_f32 v195, v62, v63
    buffer_store_dwordx4 v[192:195], v1, s[64:67], s86 offen offset:2048 sc1
    v_mul_f32 v64, v64, v246
    v_mul_f32 v65, v65, v246
    v_mul_f32 v66, v66, v246
    v_mul_f32 v67, v67, v246
    v_mul_f32 v68, v68, v246
    v_mul_f32 v69, v69, v246
    v_mul_f32 v70, v70, v246
    v_mul_f32 v71, v71, v246
    v_cvt_pk_bf16_f32 v196, v64, v65
    v_cvt_pk_bf16_f32 v197, v66, v67
    v_cvt_pk_bf16_f32 v198, v68, v69
    v_cvt_pk_bf16_f32 v199, v70, v71
    buffer_store_dwordx4 v[196:199], v1, s[64:67], s86 offen offset:3072 sc1
    v_mul_f32 v72, v72, v246
    v_mul_f32 v73, v73, v246
    v_mul_f32 v74, v74, v246
    v_mul_f32 v75, v75, v246
    v_mul_f32 v76, v76, v246
    v_mul_f32 v77, v77, v246
    v_mul_f32 v78, v78, v246
    v_mul_f32 v79, v79, v246
    v_cvt_pk_bf16_f32 v200, v72, v73
    v_cvt_pk_bf16_f32 v201, v74, v75
    v_cvt_pk_bf16_f32 v202, v76, v77
    v_cvt_pk_bf16_f32 v203, v78, v79
    buffer_store_dwordx4 v[200:203], v1, s[64:67], s87 offen offset:0 sc1
    v_mul_f32 v80, v80, v246
    v_mul_f32 v81, v81, v246
    v_mul_f32 v82, v82, v246
    v_mul_f32 v83, v83, v246
    v_mul_f32 v84, v84, v246
    v_mul_f32 v85, v85, v246
    v_mul_f32 v86, v86, v246
    v_mul_f32 v87, v87, v246
    v_cvt_pk_bf16_f32 v204, v80, v81
    v_cvt_pk_bf16_f32 v205, v82, v83
    v_cvt_pk_bf16_f32 v206, v84, v85
    v_cvt_pk_bf16_f32 v207, v86, v87
    buffer_store_dwordx4 v[204:207], v1, s[64:67], s87 offen offset:1024 sc1
    v_mul_f32 v88, v88, v246
    v_mul_f32 v89, v89, v246
    v_mul_f32 v90, v90, v246
    v_mul_f32 v91, v91, v246
    v_mul_f32 v92, v92, v246
    v_mul_f32 v93, v93, v246
    v_mul_f32 v94, v94, v246
    v_mul_f32 v95, v95, v246
    v_cvt_pk_bf16_f32 v208, v88, v89
    v_cvt_pk_bf16_f32 v209, v90, v91
    v_cvt_pk_bf16_f32 v210, v92, v93
    v_cvt_pk_bf16_f32 v211, v94, v95
    buffer_store_dwordx4 v[208:211], v1, s[64:67], s87 offen offset:2048 sc1
    v_mul_f32 v96, v96, v246
    v_mul_f32 v97, v97, v246
    v_mul_f32 v98, v98, v246
    v_mul_f32 v99, v99, v246
    v_mul_f32 v100, v100, v246
    v_mul_f32 v101, v101, v246
    v_mul_f32 v102, v102, v246
    v_mul_f32 v103, v103, v246
    v_cvt_pk_bf16_f32 v212, v96, v97
    v_cvt_pk_bf16_f32 v213, v98, v99
    v_cvt_pk_bf16_f32 v214, v100, v101
    v_cvt_pk_bf16_f32 v215, v102, v103
    buffer_store_dwordx4 v[212:215], v1, s[64:67], s87 offen offset:3072 sc1
    s_waitcnt lgkmcnt(0)
    s_add_u32 s91, s91, 4
    s_add_u32 s80, s80, 1
    s_cmp_lt_u32 s80, 2
    s_cbranch_scc1 L_head
    s_cmp_ge_u32 s10, 30
    s_cbranch_scc1 L_cfin
    v_lshrrev_b32 v250, 3, v0
    v_lshrrev_b32 v251, 2, v0
    v_and_b32 v251, 4, v251
    v_and_b32 v2, 7, v0
    v_xor_b32 v251, v251, v2
    v_mul_u32_u24 v2, 1280, v250
    v_lshl_add_u32 v2, v251, 4, v2
    v_lshrrev_b32 v250, 2, v0
    v_and_b32 v250, 3, v250
    v_lshrrev_b32 v3, 4, v0
    v_and_b32 v3, 1, v3
    v_lshlrev_b32 v3, 5, v3
    v_and_b32 v251, 1, v0
    v_lshl_add_u32 v3, v251, 4, v3
    v_and_b32 v251, 2, v0
    v_lshl_add_u32 v3, v251, 2, v3
    v_lshl_add_u32 v3, v250, 7, v3
    v_lshrrev_b32 v250, 1, v250
    v_lshl_add_u32 v3, v250, 6, v3
    v_lshrrev_b32 v251, 5, v0
    v_lshl_add_u32 v3, v251, 10, v3
    v_add_u32 v3, s11, v3
    v_xor_b32 v4, 64, v3
    s_mul_i32 s77, s9, 3
    s_add_u32 s77, s77, s4
    s_and_b32 s77, s77, 7
    s_and_b32 s91, s77, 6
    s_add_u32 s91, s91, s77
    s_lshl_b32 s91, s91, 1
    s_add_u32 s91, s91, 4
    s_mul_i32 s85, s91, 163840
    s_add_u32 s85, s85, s88
    s_lshl_b32 s84, s91, 13
    s_add_u32 s84, s84, s89
    s_lshr_b32 s77, s89, 6
    s_lshl_b32 s78, s91, 7
    s_add_u32 s77, s77, s78
    s_add_u32 s77, s77, 12582912
    v_and_b32 v5, 1, v0
    v_lshlrev_b32 v5, 12, v5
    v_lshrrev_b32 v250, 1, v0
    v_and_b32 v250, 1, v250
    v_lshl_add_u32 v5, v250, 7, v5
    v_add_u32 v5, s77, v5
    v_mov_b32 v8, 0
    v_mov_b32 v9, 0
    v_mov_b32 v10, 0
    v_mov_b32 v11, 0
    v_mov_b32 v12, 0
    v_mov_b32 v13, 0
    v_mov_b32 v14, 0
    v_mov_b32 v15, 0
    v_mov_b32 v16, 0
    v_mov_b32 v17, 0
    v_mov_b32 v18, 0
    v_mov_b32 v19, 0
    v_mov_b32 v20, 0
    v_mov_b32 v21, 0
    v_mov_b32 v22, 0
    v_mov_b32 v23, 0
    v_mov_b32 v24, 0
    v_mov_b32 v25, 0
    v_mov_b32 v26, 0
    v_mov_b32 v27, 0
    v_mov_b32 v28, 0
    v_mov_b32 v29, 0
    v_mov_b32 v30, 0
    v_mov_b32 v31, 0
    v_mov_b32 v32, 0
    v_mov_b32 v33, 0
    v_mov_b32 v34, 0
    v_mov_b32 v35, 0
    v_mov_b32 v36, 0
    v_mov_b32 v37, 0
    v_mov_b32 v38, 0
    v_mov_b32 v39, 0
    v_mov_b32 v40, 0
    v_mov_b32 v41, 0
    v_mov_b32 v42, 0
    v_mov_b32 v43, 0
    v_mov_b32 v44, 0
    v_mov_b32 v45, 0
    v_mov_b32 v46, 0
    v_mov_b32 v47, 0
    v_mov_b32 v48, 0
    v_mov_b32 v49, 0
    v_mov_b32 v50, 0
    v_mov_b32 v51, 0
    v_mov_b32 v52, 0
    v_mov_b32 v53, 0
    v_mov_b32 v54, 0
    v_mov_b32 v55, 0
    v_mov_b32 v56, 0
    v_mov_b32 v57, 0
    v_mov_b32 v58, 0
    v_mov_b32 v59, 0
    v_mov_b32 v60, 0
    v_mov_b32 v61, 0
    v_mov_b32 v62, 0
    v_mov_b32 v63, 0
    v_mov_b32 v64, 0
    v_mov_b32 v65, 0
    v_mov_b32 v66, 0
    v_mov_b32 v67, 0
    v_mov_b32 v68, 0
    v_mov_b32 v69, 0
    v_mov_b32 v70, 0
    v_mov_b32 v71, 0
    s_barrier
    ds_read_b64_tr_b16 v[72:73], v3 offset:0
    ds_read_b64_tr_b16 v[74:75], v3 offset:512
    ds_read_b64_tr_b16 v[76:77], v4 offset:0
    ds_read_b64_tr_b16 v[78:79], v4 offset:512
    ds_read_b64_tr_b16 v[80:81], v3 offset:2048
    ds_read_b64_tr_b16 v[82:83], v3 offset:2560
    ds_read_b64_tr_b16 v[84:85], v4 offset:2048
    ds_read_b64_tr_b16 v[86:87], v4 offset:2560
    ds_read_b64_tr_b16 v[88:89], v3 offset:4096
    ds_read_b64_tr_b16 v[90:91], v3 offset:4608
    ds_read_b64_tr_b16 v[92:93], v4 offset:4096
    ds_read_b64_tr_b16 v[94:95], v4 offset:4608
    ds_read_b64_tr_b16 v[96:97], v3 offset:6144
    ds_read_b64_tr_b16 v[98:99], v3 offset:6656
    ds_read_b64_tr_b16 v[100:101], v4 offset:6144
    s_waitcnt lgkmcnt(7)
    ds_read_b64_tr_b16 v[102:103], v4 offset:6656
    ds_read_b64_tr_b16 v[104:105], v3 offset:8192
    ds_read_b64_tr_b16 v[106:107], v3 offset:8704
    ds_read_b64_tr_b16 v[108:109], v4 offset:8192
    ds_read_b64_tr_b16 v[110:111], v4 offset:8704
    ds_read_b64_tr_b16 v[112:113], v3 offset:10240
    ds_read_b64_tr_b16 v[114:115], v3 offset:10752
    ds_read_b64_tr_b16 v[116:117], v4 offset:10240
    s_waitcnt lgkmcnt(7)
    ds_read_b64_tr_b16 v[118:119], v4 offset:10752
    s_waitcnt lgkmcnt(0)
    s_waitcnt vmcnt(0)
    s_lshr_b32 s77, s86, 6
    s_add_u32 s77, s77, 12582912
    v_mov_b32 v248, s76
    v_mov_b32 v249, 0
    s_mov_b64 exec, 1
    buffer_store_dword v248, v249, s[64:67], s77 offen sc1
    s_mov_b64 exec, -1
    s_add_u32 m0, s11, 0
    s_add_u32 s77, s85, 204800
    buffer_load_dwordx4 v2, s[60:63], s77 offen offset:0 lds
    s_add_u32 s77, s85, 214016
    buffer_load_dwordx4 v2, s[60:63], s77 offen offset:1024 lds
    s_add_u32 s77, s85, 223232
    buffer_load_dwordx4 v2, s[60:63], s77 offen offset:2048 lds
    s_add_u32 s77, s85, 232448
    buffer_load_dwordx4 v2, s[60:63], s77 offen offset:3072 lds
    s_add_u32 m0, s11, 4096
    s_add_u32 s77, s85, 245760
    buffer_load_dwordx4 v2, s[60:63], s77 offen offset:0 lds
    s_add_u32 s77, s85, 254976
    buffer_load_dwordx4 v2, s[60:63], s77 offen offset:1024 lds
    s_add_u32 s77, s85, 264192
    buffer_load_dwordx4 v2, s[60:63], s77 offen offset:2048 lds
    s_add_u32 s77, s85, 273408
    buffer_load_dwordx4 v2, s[60:63], s77 offen offset:3072 lds
    s_add_u32 m0, s11, 8192
    s_add_u32 s77, s85, 286720
    buffer_load_dwordx4 v2, s[60:63], s77 offen offset:0 lds
    s_add_u32 s77, s85, 295936
    buffer_load_dwordx4 v2, s[60:63], s77 offen offset:1024 lds
    s_add_u32 s77, s85, 305152
    buffer_load_dwordx4 v2, s[60:63], s77 offen offset:2048 lds
    s_add_u32 s77, s85, 314368
    buffer_load_dwordx4 v2, s[60:63], s77 offen offset:3072 lds
    s_branch L_tail
L_cfin:
    s_waitcnt vmcnt(0)
    s_lshr_b32 s77, s86, 6
    s_add_u32 s77, s77, 12582912
    v_mov_b32 v248, s76
    v_mov_b32 v249, 0
    s_mov_b64 exec, 1
    buffer_store_dword v248, v249, s[64:67], s77 offen sc1
    s_mov_b64 exec, -1
    s_endpgm
L_rare0:
    v_max3_f32 v4, v120, v121, v122
    v_max3_f32 v5, v123, v124, v125
    v_max3_f32 v4, v4, v126, v127
    v_max3_f32 v5, v5, v128, v129
    v_max3_f32 v4, v4, v130, v131
    v_max3_f32 v5, v5, v132, v133
    v_max3_f32 v4, v4, v134, v135
    v_max_f32 v4, v4, v5
    v_mov_b32 v5, v4
    s_nop 1
    v_permlane32_swap_b32 v4, v5
    s_nop 0
    v_max_f32 v3, v4, v5
    v_max_f32 v3, 0, v3
    v_exp_f32 v2, -v3
    v_sub_f32 v120, v120, v3
    v_sub_f32 v121, v121, v3
    v_sub_f32 v122, v122, v3
    v_sub_f32 v123, v123, v3
    v_sub_f32 v124, v124, v3
    v_sub_f32 v125, v125, v3
    v_sub_f32 v126, v126, v3
    v_sub_f32 v127, v127, v3
    v_sub_f32 v128, v128, v3
    v_sub_f32 v129, v129, v3
    v_sub_f32 v130, v130, v3
    v_sub_f32 v131, v131, v3
    v_sub_f32 v132, v132, v3
    v_sub_f32 v133, v133, v3
    v_sub_f32 v134, v134, v3
    v_sub_f32 v135, v135, v3
    v_mul_f32 v244, v244, v2
    v_mul_f32 v245, v245, v2
    v_exp_f32 v248, v120
    v_exp_f32 v249, v121
    v_exp_f32 v250, v122
    v_add_f32 v246, v244, v248
    v_exp_f32 v251, v123
    v_add_f32 v247, v245, v249
    v_cvt_pk_bf16_f32 v144, v248, v249
    v_exp_f32 v252, v124
    v_add_f32 v246, v246, v250
    v_exp_f32 v253, v125
    v_add_f32 v247, v247, v251
    v_cvt_pk_bf16_f32 v145, v250, v251
    v_exp_f32 v254, v126
    v_add_f32 v246, v246, v252
    v_exp_f32 v255, v127
    v_add_f32 v247, v247, v253
    v_cvt_pk_bf16_f32 v146, v252, v253
    v_exp_f32 v248, v128
    v_add_f32 v246, v246, v254
    v_exp_f32 v249, v129
    v_add_f32 v247, v247, v255
    v_cvt_pk_bf16_f32 v147, v254, v255
    v_exp_f32 v250, v130
    v_add_f32 v246, v246, v248
    v_exp_f32 v251, v131
    v_add_f32 v247, v247, v249
    v_cvt_pk_bf16_f32 v148, v248, v249
    v_exp_f32 v252, v132
    v_add_f32 v246, v246, v250
    v_exp_f32 v253, v133
    v_add_f32 v247, v247, v251
    v_cvt_pk_bf16_f32 v149, v250, v251
    v_exp_f32 v254, v134
    v_add_f32 v246, v246, v252
    v_exp_f32 v255, v135
    v_add_f32 v247, v247, v253
    v_cvt_pk_bf16_f32 v150, v252, v253
    v_add_f32 v246, v246, v254
    v_add_f32 v247, v247, v255
    v_cvt_pk_bf16_f32 v151, v254, v255
    v_sub_f32 v104, v104, v3
    v_sub_f32 v105, v105, v3
    v_sub_f32 v106, v106, v3
    v_sub_f32 v107, v107, v3
    v_sub_f32 v108, v108, v3
    v_sub_f32 v109, v109, v3
    v_sub_f32 v110, v110, v3
    v_sub_f32 v111, v111, v3
    v_sub_f32 v112, v112, v3
    v_sub_f32 v113, v113, v3
    v_sub_f32 v114, v114, v3
    v_sub_f32 v115, v115, v3
    v_sub_f32 v116, v116, v3
    v_sub_f32 v117, v117, v3
    v_sub_f32 v118, v118, v3
    v_sub_f32 v119, v119, v3
    v_sub_f32 v216, v216, v3
    v_sub_f32 v217, v217, v3
    v_sub_f32 v218, v218, v3
    v_sub_f32 v219, v219, v3
    v_sub_f32 v220, v220, v3
    v_sub_f32 v221, v221, v3
    v_sub_f32 v222, v222, v3
    v_sub_f32 v223, v223, v3
    v_sub_f32 v224, v224, v3
    v_sub_f32 v225, v225, v3
    v_sub_f32 v226, v226, v3
    v_sub_f32 v227, v227, v3
    v_sub_f32 v228, v228, v3
    v_sub_f32 v229, v229, v3
    v_sub_f32 v230, v230, v3
    v_sub_f32 v231, v231, v3
    v_mul_f32 v40, v40, v2
    v_mul_f32 v41, v41, v2
    v_mul_f32 v42, v42, v2
    v_mul_f32 v43, v43, v2
    v_mul_f32 v44, v44, v2
    v_mul_f32 v45, v45, v2
    v_mul_f32 v46, v46, v2
    v_mul_f32 v47, v47, v2
    v_mul_f32 v48, v48, v2
    v_mul_f32 v49, v49, v2
    v_mul_f32 v50, v50, v2
    v_mul_f32 v51, v51, v2
    v_mul_f32 v52, v52, v2
    v_mul_f32 v53, v53, v2
    v_mul_f32 v54, v54, v2
    v_mul_f32 v55, v55, v2
    v_mul_f32 v56, v56, v2
    v_mul_f32 v57, v57, v2
    v_mul_f32 v58, v58, v2
    v_mul_f32 v59, v59, v2
    v_mul_f32 v60, v60, v2
    v_mul_f32 v61, v61, v2
    v_mul_f32 v62, v62, v2
    v_mul_f32 v63, v63, v2
    v_mul_f32 v64, v64, v2
    v_mul_f32 v65, v65, v2
    v_mul_f32 v66, v66, v2
    v_mul_f32 v67, v67, v2
    v_mul_f32 v68, v68, v2
    v_mul_f32 v69, v69, v2
    v_mul_f32 v70, v70, v2
    v_mul_f32 v71, v71, v2
    v_mul_f32 v72, v72, v2
    v_mul_f32 v73, v73, v2
    v_mul_f32 v74, v74, v2
    v_mul_f32 v75, v75, v2
    v_mul_f32 v76, v76, v2
    v_mul_f32 v77, v77, v2
    v_mul_f32 v78, v78, v2
    v_mul_f32 v79, v79, v2
    v_mul_f32 v80, v80, v2
    v_mul_f32 v81, v81, v2
    v_mul_f32 v82, v82, v2
    v_mul_f32 v83, v83, v2
    v_mul_f32 v84, v84, v2
    v_mul_f32 v85, v85, v2
    v_mul_f32 v86, v86, v2
    v_mul_f32 v87, v87, v2
    v_mul_f32 v88, v88, v2
    v_mul_f32 v89, v89, v2
    v_mul_f32 v90, v90, v2
    v_mul_f32 v91, v91, v2
    v_mul_f32 v92, v92, v2
    v_mul_f32 v93, v93, v2
    v_mul_f32 v94, v94, v2
    v_mul_f32 v95, v95, v2
    v_mul_f32 v96, v96, v2
    v_mul_f32 v97, v97, v2
    v_mul_f32 v98, v98, v2
    v_mul_f32 v99, v99, v2
    v_mul_f32 v100, v100, v2
    v_mul_f32 v101, v101, v2
    v_mul_f32 v102, v102, v2
    v_mul_f32 v103, v103, v2
    s_branch L_back0
L_rare1:
    v_max3_f32 v4, v104, v105, v106
    v_max3_f32 v5, v107, v108, v109
    v_max3_f32 v4, v4, v110, v111
    v_max3_f32 v5, v5, v112, v113
    v_max3_f32 v4, v4, v114, v115
    v_max3_f32 v5, v5, v116, v117
    v_max3_f32 v4, v4, v118, v119
    v_max_f32 v4, v4, v5
    v_mov_b32 v5, v4
    s_nop 1
    v_permlane32_swap_b32 v4, v5
    s_nop 0
    v_max_f32 v3, v4, v5
    v_max_f32 v3, 0, v3
    v_exp_f32 v2, -v3
    v_sub_f32 v104, v104, v3
    v_sub_f32 v105, v105, v3
    v_sub_f32 v106, v106, v3
    v_sub_f32 v107, v107, v3
    v_sub_f32 v108, v108, v3
    v_sub_f32 v109, v109, v3
    v_sub_f32 v110, v110, v3
    v_sub_f32 v111, v111, v3
    v_sub_f32 v112, v112, v3
    v_sub_f32 v113, v113, v3
    v_sub_f32 v114, v114, v3
    v_sub_f32 v115, v115, v3
    v_sub_f32 v116, v116, v3
    v_sub_f32 v117, v117, v3
    v_sub_f32 v118, v118, v3
    v_sub_f32 v119, v119, v3
    v_mul_f32 v246, v246, v2
    v_mul_f32 v247, v247, v2
    v_exp_f32 v248, v104
    v_exp_f32 v249, v105
    v_exp_f32 v250, v106
    v_add_f32 v244, v246, v248
    v_exp_f32 v251, v107
    v_add_f32 v245, v247, v249
    v_cvt_pk_bf16_f32 v136, v248, v249
    v_exp_f32 v252, v108
    v_add_f32 v244, v244, v250
    v_exp_f32 v253, v109
    v_add_f32 v245, v245, v251
    v_cvt_pk_bf16_f32 v137, v250, v251
    v_exp_f32 v254, v110
    v_add_f32 v244, v244, v252
    v_exp_f32 v255, v111
    v_add_f32 v245, v245, v253
    v_cvt_pk_bf16_f32 v138, v252, v253
    v_exp_f32 v248, v112
    v_add_f32 v244, v244, v254
    v_exp_f32 v249, v113
    v_add_f32 v245, v245, v255
    v_cvt_pk_bf16_f32 v139, v254, v255
    v_exp_f32 v250, v114
    v_add_f32 v244, v244, v248
    v_exp_f32 v251, v115
    v_add_f32 v245, v245, v249
    v_cvt_pk_bf16_f32 v140, v248, v249
    v_exp_f32 v252, v116
    v_add_f32 v244, v244, v250
    v_exp_f32 v253, v117
    v_add_f32 v245, v245, v251
    v_cvt_pk_bf16_f32 v141, v250, v251
    v_exp_f32 v254, v118
    v_add_f32 v244, v244, v252
    v_exp_f32 v255, v119
    v_add_f32 v245, v245, v253
    v_cvt_pk_bf16_f32 v142, v252, v253
    v_add_f32 v244, v244, v254
    v_add_f32 v245, v245, v255
    v_cvt_pk_bf16_f32 v143, v254, v255
    v_sub_f32 v120, v120, v3
    v_sub_f32 v121, v121, v3
    v_sub_f32 v122, v122, v3
    v_sub_f32 v123, v123, v3
    v_sub_f32 v124, v124, v3
    v_sub_f32 v125, v125, v3
    v_sub_f32 v126, v126, v3
    v_sub_f32 v127, v127, v3
    v_sub_f32 v128, v128, v3
    v_sub_f32 v129, v129, v3
    v_sub_f32 v130, v130, v3
    v_sub_f32 v131, v131, v3
    v_sub_f32 v132, v132, v3
    v_sub_f32 v133, v133, v3
    v_sub_f32 v134, v134, v3
    v_sub_f32 v135, v135, v3
    v_sub_f32 v216, v216, v3
    v_sub_f32 v217, v217, v3
    v_sub_f32 v218, v218, v3
    v_sub_f32 v219, v219, v3
    v_sub_f32 v220, v220, v3
    v_sub_f32 v221, v221, v3
    v_sub_f32 v222, v222, v3
    v_sub_f32 v223, v223, v3
    v_sub_f32 v224, v224, v3
    v_sub_f32 v225, v225, v3
    v_sub_f32 v226, v226, v3
    v_sub_f32 v227, v227, v3
    v_sub_f32 v228, v228, v3
    v_sub_f32 v229, v229, v3
    v_sub_f32 v230, v230, v3
    v_sub_f32 v231, v231, v3
    v_mul_f32 v40, v40, v2
    v_mul_f32 v41, v41, v2
    v_mul_f32 v42, v42, v2
    v_mul_f32 v43, v43, v2
    v_mul_f32 v44, v44, v2
    v_mul_f32 v45, v45, v2
    v_mul_f32 v46, v46, v2
    v_mul_f32 v47, v47, v2
    v_mul_f32 v48, v48, v2
    v_mul_f32 v49, v49, v2
    v_mul_f32 v50, v50, v2
    v_mul_f32 v51, v51, v2
    v_mul_f32 v52, v52, v2
    v_mul_f32 v53, v53, v2
    v_mul_f32 v54, v54, v2
    v_mul_f32 v55, v55, v2
    v_mul_f32 v56, v56, v2
    v_mul_f32 v57, v57, v2
    v_mul_f32 v58, v58, v2
    v_mul_f32 v59, v59, v2
    v_mul_f32 v60, v60, v2
    v_mul_f32 v61, v61, v2
    v_mul_f32 v62, v62, v2
    v_mul_f32 v63, v63, v2
    v_mul_f32 v64, v64, v2
    v_mul_f32 v65, v65, v2
    v_mul_f32 v66, v66, v2
    v_mul_f32 v67, v67, v2
    v_mul_f32 v68, v68, v2
    v_mul_f32 v69, v69, v2
    v_mul_f32 v70, v70, v2
    v_mul_f32 v71, v71, v2
    v_mul_f32 v72, v72, v2
    v_mul_f32 v73, v73, v2
    v_mul_f32 v74, v74, v2
    v_mul_f32 v75, v75, v2
    v_mul_f32 v76, v76, v2
    v_mul_f32 v77, v77, v2
    v_mul_f32 v78, v78, v2
    v_mul_f32 v79, v79, v2
    v_mul_f32 v80, v80, v2
    v_mul_f32 v81, v81, v2
    v_mul_f32 v82, v82, v2
    v_mul_f32 v83, v83, v2
    v_mul_f32 v84, v84, v2
    v_mul_f32 v85, v85, v2
    v_mul_f32 v86, v86, v2
    v_mul_f32 v87, v87, v2
    v_mul_f32 v88, v88, v2
    v_mul_f32 v89, v89, v2
    v_mul_f32 v90, v90, v2
    v_mul_f32 v91, v91, v2
    v_mul_f32 v92, v92, v2
    v_mul_f32 v93, v93, v2
    v_mul_f32 v94, v94, v2
    v_mul_f32 v95, v95, v2
    v_mul_f32 v96, v96, v2
    v_mul_f32 v97, v97, v2
    v_mul_f32 v98, v98, v2
    v_mul_f32 v99, v99, v2
    v_mul_f32 v100, v100, v2
    v_mul_f32 v101, v101, v2
    v_mul_f32 v102, v102, v2
    v_mul_f32 v103, v103, v2
    s_branch L_back1
L_rare2:
    v_max3_f32 v4, v120, v121, v122
    v_max3_f32 v5, v123, v124, v125
    v_max3_f32 v4, v4, v126, v127
    v_max3_f32 v5, v5, v128, v129
    v_max3_f32 v4, v4, v130, v131
    v_max3_f32 v5, v5, v132, v133
    v_max3_f32 v4, v4, v134, v135
    v_max_f32 v4, v4, v5
    v_mov_b32 v5, v4
    s_nop 1
    v_permlane32_swap_b32 v4, v5
    s_nop 0
    v_max_f32 v3, v4, v5
    v_max_f32 v3, 0, v3
    v_exp_f32 v2, -v3
    v_sub_f32 v120, v120, v3
    v_sub_f32 v121, v121, v3
    v_sub_f32 v122, v122, v3
    v_sub_f32 v123, v123, v3
    v_sub_f32 v124, v124, v3
    v_sub_f32 v125, v125, v3
    v_sub_f32 v126, v126, v3
    v_sub_f32 v127, v127, v3
    v_sub_f32 v128, v128, v3
    v_sub_f32 v129, v129, v3
    v_sub_f32 v130, v130, v3
    v_sub_f32 v131, v131, v3
    v_sub_f32 v132, v132, v3
    v_sub_f32 v133, v133, v3
    v_sub_f32 v134, v134, v3
    v_sub_f32 v135, v135, v3
    v_mul_f32 v244, v244, v2
    v_mul_f32 v245, v245, v2
    v_exp_f32 v248, v120
    v_exp_f32 v249, v121
    v_exp_f32 v250, v122
    v_add_f32 v246, v244, v248
    v_exp_f32 v251, v123
    v_add_f32 v247, v245, v249
    v_cvt_pk_bf16_f32 v144, v248, v249
    v_exp_f32 v252, v124
    v_add_f32 v246, v246, v250
    v_exp_f32 v253, v125
    v_add_f32 v247, v247, v251
    v_cvt_pk_bf16_f32 v145, v250, v251
    v_exp_f32 v254, v126
    v_add_f32 v246, v246, v252
    v_exp_f32 v255, v127
    v_add_f32 v247, v247, v253
    v_cvt_pk_bf16_f32 v146, v252, v253
    v_exp_f32 v248, v128
    v_add_f32 v246, v246, v254
    v_exp_f32 v249, v129
    v_add_f32 v247, v247, v255
    v_cvt_pk_bf16_f32 v147, v254, v255
    v_exp_f32 v250, v130
    v_add_f32 v246, v246, v248
    v_exp_f32 v251, v131
    v_add_f32 v247, v247, v249
    v_cvt_pk_bf16_f32 v148, v248, v249
    v_exp_f32 v252, v132
    v_add_f32 v246, v246, v250
    v_exp_f32 v253, v133
    v_add_f32 v247, v247, v251
    v_cvt_pk_bf16_f32 v149, v250, v251
    v_exp_f32 v254, v134
    v_add_f32 v246, v246, v252
    v_exp_f32 v255, v135
    v_add_f32 v247, v247, v253
    v_cvt_pk_bf16_f32 v150, v252, v253
    v_add_f32 v246, v246, v254
    v_add_f32 v247, v247, v255
    v_cvt_pk_bf16_f32 v151, v254, v255
    v_sub_f32 v104, v104, v3
    v_sub_f32 v105, v105, v3
    v_sub_f32 v106, v106, v3
    v_sub_f32 v107, v107, v3
    v_sub_f32 v108, v108, v3
    v_sub_f32 v109, v109, v3
    v_sub_f32 v110, v110, v3
    v_sub_f32 v111, v111, v3
    v_sub_f32 v112, v112, v3
    v_sub_f32 v113, v113, v3
    v_sub_f32 v114, v114, v3
    v_sub_f32 v115, v115, v3
    v_sub_f32 v116, v116, v3
    v_sub_f32 v117, v117, v3
    v_sub_f32 v118, v118, v3
    v_sub_f32 v119, v119, v3
    v_sub_f32 v216, v216, v3
    v_sub_f32 v217, v217, v3
    v_sub_f32 v218, v218, v3
    v_sub_f32 v219, v219, v3
    v_sub_f32 v220, v220, v3
    v_sub_f32 v221, v221, v3
    v_sub_f32 v222, v222, v3
    v_sub_f32 v223, v223, v3
    v_sub_f32 v224, v224, v3
    v_sub_f32 v225, v225, v3
    v_sub_f32 v226, v226, v3
    v_sub_f32 v227, v227, v3
    v_sub_f32 v228, v228, v3
    v_sub_f32 v229, v229, v3
    v_sub_f32 v230, v230, v3
    v_sub_f32 v231, v231, v3
    v_mul_f32 v40, v40, v2
    v_mul_f32 v41, v41, v2
    v_mul_f32 v42, v42, v2
    v_mul_f32 v43, v43, v2
    v_mul_f32 v44, v44, v2
    v_mul_f32 v45, v45, v2
    v_mul_f32 v46, v46, v2
    v_mul_f32 v47, v47, v2
    v_mul_f32 v48, v48, v2
    v_mul_f32 v49, v49, v2
    v_mul_f32 v50, v50, v2
    v_mul_f32 v51, v51, v2
    v_mul_f32 v52, v52, v2
    v_mul_f32 v53, v53, v2
    v_mul_f32 v54, v54, v2
    v_mul_f32 v55, v55, v2
    v_mul_f32 v56, v56, v2
    v_mul_f32 v57, v57, v2
    v_mul_f32 v58, v58, v2
    v_mul_f32 v59, v59, v2
    v_mul_f32 v60, v60, v2
    v_mul_f32 v61, v61, v2
    v_mul_f32 v62, v62, v2
    v_mul_f32 v63, v63, v2
    v_mul_f32 v64, v64, v2
    v_mul_f32 v65, v65, v2
    v_mul_f32 v66, v66, v2
    v_mul_f32 v67, v67, v2
    v_mul_f32 v68, v68, v2
    v_mul_f32 v69, v69, v2
    v_mul_f32 v70, v70, v2
    v_mul_f32 v71, v71, v2
    v_mul_f32 v72, v72, v2
    v_mul_f32 v73, v73, v2
    v_mul_f32 v74, v74, v2
    v_mul_f32 v75, v75, v2
    v_mul_f32 v76, v76, v2
    v_mul_f32 v77, v77, v2
    v_mul_f32 v78, v78, v2
    v_mul_f32 v79, v79, v2
    v_mul_f32 v80, v80, v2
    v_mul_f32 v81, v81, v2
    v_mul_f32 v82, v82, v2
    v_mul_f32 v83, v83, v2
    v_mul_f32 v84, v84, v2
    v_mul_f32 v85, v85, v2
    v_mul_f32 v86, v86, v2
    v_mul_f32 v87, v87, v2
    v_mul_f32 v88, v88, v2
    v_mul_f32 v89, v89, v2
    v_mul_f32 v90, v90, v2
    v_mul_f32 v91, v91, v2
    v_mul_f32 v92, v92, v2
    v_mul_f32 v93, v93, v2
    v_mul_f32 v94, v94, v2
    v_mul_f32 v95, v95, v2
    v_mul_f32 v96, v96, v2
    v_mul_f32 v97, v97, v2
    v_mul_f32 v98, v98, v2
    v_mul_f32 v99, v99, v2
    v_mul_f32 v100, v100, v2
    v_mul_f32 v101, v101, v2
    v_mul_f32 v102, v102, v2
    v_mul_f32 v103, v103, v2
    s_branch L_back2
L_rare3:
    v_max3_f32 v4, v104, v105, v106
    v_max3_f32 v5, v107, v108, v109
    v_max3_f32 v4, v4, v110, v111
    v_max3_f32 v5, v5, v112, v113
    v_max3_f32 v4, v4, v114, v115
    v_max3_f32 v5, v5, v116, v117
    v_max3_f32 v4, v4, v118, v119
    v_max_f32 v4, v4, v5
    v_mov_b32 v5, v4
    s_nop 1
    v_permlane32_swap_b32 v4, v5
    s_nop 0
    v_max_f32 v3, v4, v5
    v_max_f32 v3, 0, v3
    v_exp_f32 v2, -v3
    v_sub_f32 v104, v104, v3
    v_sub_f32 v105, v105, v3
    v_sub_f32 v106, v106, v3
    v_sub_f32 v107, v107, v3
    v_sub_f32 v108, v108, v3
    v_sub_f32 v109, v109, v3
    v_sub_f32 v110, v110, v3
    v_sub_f32 v111, v111, v3
    v_sub_f32 v112, v112, v3
    v_sub_f32 v113, v113, v3
    v_sub_f32 v114, v114, v3
    v_sub_f32 v115, v115, v3
    v_sub_f32 v116, v116, v3
    v_sub_f32 v117, v117, v3
    v_sub_f32 v118, v118, v3
    v_sub_f32 v119, v119, v3
    v_mul_f32 v246, v246, v2
    v_mul_f32 v247, v247, v2
    v_exp_f32 v248, v104
    v_exp_f32 v249, v105
    v_exp_f32 v250, v106
    v_add_f32 v244, v246, v248
    v_exp_f32 v251, v107
    v_add_f32 v245, v247, v249
    v_cvt_pk_bf16_f32 v136, v248, v249
    v_exp_f32 v252, v108
    v_add_f32 v244, v244, v250
    v_exp_f32 v253, v109
    v_add_f32 v245, v245, v251
    v_cvt_pk_bf16_f32 v137, v250, v251
    v_exp_f32 v254, v110
    v_add_f32 v244, v244, v252
    v_exp_f32 v255, v111
    v_add_f32 v245, v245, v253
    v_cvt_pk_bf16_f32 v138, v252, v253
    v_exp_f32 v248, v112
    v_add_f32 v244, v244, v254
    v_exp_f32 v249, v113
    v_add_f32 v245, v245, v255
    v_cvt_pk_bf16_f32 v139, v254, v255
    v_exp_f32 v250, v114
    v_add_f32 v244, v244, v248
    v_exp_f32 v251, v115
    v_add_f32 v245, v245, v249
    v_cvt_pk_bf16_f32 v140, v248, v249
    v_exp_f32 v252, v116
    v_add_f32 v244, v244, v250
    v_exp_f32 v253, v117
    v_add_f32 v245, v245, v251
    v_cvt_pk_bf16_f32 v141, v250, v251
    v_exp_f32 v254, v118
    v_add_f32 v244, v244, v252
    v_exp_f32 v255, v119
    v_add_f32 v245, v245, v253
    v_cvt_pk_bf16_f32 v142, v252, v253
    v_add_f32 v244, v244, v254
    v_add_f32 v245, v245, v255
    v_cvt_pk_bf16_f32 v143, v254, v255
    v_sub_f32 v120, v120, v3
    v_sub_f32 v121, v121, v3
    v_sub_f32 v122, v122, v3
    v_sub_f32 v123, v123, v3
    v_sub_f32 v124, v124, v3
    v_sub_f32 v125, v125, v3
    v_sub_f32 v126, v126, v3
    v_sub_f32 v127, v127, v3
    v_sub_f32 v128, v128, v3
    v_sub_f32 v129, v129, v3
    v_sub_f32 v130, v130, v3
    v_sub_f32 v131, v131, v3
    v_sub_f32 v132, v132, v3
    v_sub_f32 v133, v133, v3
    v_sub_f32 v134, v134, v3
    v_sub_f32 v135, v135, v3
    v_sub_f32 v216, v216, v3
    v_sub_f32 v217, v217, v3
    v_sub_f32 v218, v218, v3
    v_sub_f32 v219, v219, v3
    v_sub_f32 v220, v220, v3
    v_sub_f32 v221, v221, v3
    v_sub_f32 v222, v222, v3
    v_sub_f32 v223, v223, v3
    v_sub_f32 v224, v224, v3
    v_sub_f32 v225, v225, v3
    v_sub_f32 v226, v226, v3
    v_sub_f32 v227, v227, v3
    v_sub_f32 v228, v228, v3
    v_sub_f32 v229, v229, v3
    v_sub_f32 v230, v230, v3
    v_sub_f32 v231, v231, v3
    v_mul_f32 v40, v40, v2
    v_mul_f32 v41, v41, v2
    v_mul_f32 v42, v42, v2
    v_mul_f32 v43, v43, v2
    v_mul_f32 v44, v44, v2
    v_mul_f32 v45, v45, v2
    v_mul_f32 v46, v46, v2
    v_mul_f32 v47, v47, v2
    v_mul_f32 v48, v48, v2
    v_mul_f32 v49, v49, v2
    v_mul_f32 v50, v50, v2
    v_mul_f32 v51, v51, v2
    v_mul_f32 v52, v52, v2
    v_mul_f32 v53, v53, v2
    v_mul_f32 v54, v54, v2
    v_mul_f32 v55, v55, v2
    v_mul_f32 v56, v56, v2
    v_mul_f32 v57, v57, v2
    v_mul_f32 v58, v58, v2
    v_mul_f32 v59, v59, v2
    v_mul_f32 v60, v60, v2
    v_mul_f32 v61, v61, v2
    v_mul_f32 v62, v62, v2
    v_mul_f32 v63, v63, v2
    v_mul_f32 v64, v64, v2
    v_mul_f32 v65, v65, v2
    v_mul_f32 v66, v66, v2
    v_mul_f32 v67, v67, v2
    v_mul_f32 v68, v68, v2
    v_mul_f32 v69, v69, v2
    v_mul_f32 v70, v70, v2
    v_mul_f32 v71, v71, v2
    v_mul_f32 v72, v72, v2
    v_mul_f32 v73, v73, v2
    v_mul_f32 v74, v74, v2
    v_mul_f32 v75, v75, v2
    v_mul_f32 v76, v76, v2
    v_mul_f32 v77, v77, v2
    v_mul_f32 v78, v78, v2
    v_mul_f32 v79, v79, v2
    v_mul_f32 v80, v80, v2
    v_mul_f32 v81, v81, v2
    v_mul_f32 v82, v82, v2
    v_mul_f32 v83, v83, v2
    v_mul_f32 v84, v84, v2
    v_mul_f32 v85, v85, v2
    v_mul_f32 v86, v86, v2
    v_mul_f32 v87, v87, v2
    v_mul_f32 v88, v88, v2
    v_mul_f32 v89, v89, v2
    v_mul_f32 v90, v90, v2
    v_mul_f32 v91, v91, v2
    v_mul_f32 v92, v92, v2
    v_mul_f32 v93, v93, v2
    v_mul_f32 v94, v94, v2
    v_mul_f32 v95, v95, v2
    v_mul_f32 v96, v96, v2
    v_mul_f32 v97, v97, v2
    v_mul_f32 v98, v98, v2
    v_mul_f32 v99, v99, v2
    v_mul_f32 v100, v100, v2
    v_mul_f32 v101, v101, v2
    v_mul_f32 v102, v102, v2
    v_mul_f32 v103, v103, v2
    s_branch L_back3
L_rare4:
    v_max3_f32 v4, v120, v121, v122
    v_max3_f32 v5, v123, v124, v125
    v_max3_f32 v4, v4, v126, v127
    v_max3_f32 v5, v5, v128, v129
    v_max3_f32 v4, v4, v130, v131
    v_max3_f32 v5, v5, v132, v133
    v_max3_f32 v4, v4, v134, v135
    v_max_f32 v4, v4, v5
    v_mov_b32 v5, v4
    s_nop 1
    v_permlane32_swap_b32 v4, v5
    s_nop 0
    v_max_f32 v3, v4, v5
    v_max_f32 v3, 0, v3
    v_exp_f32 v2, -v3
    v_sub_f32 v120, v120, v3
    v_sub_f32 v121, v121, v3
    v_sub_f32 v122, v122, v3
    v_sub_f32 v123, v123, v3
    v_sub_f32 v124, v124, v3
    v_sub_f32 v125, v125, v3
    v_sub_f32 v126, v126, v3
    v_sub_f32 v127, v127, v3
    v_sub_f32 v128, v128, v3
    v_sub_f32 v129, v129, v3
    v_sub_f32 v130, v130, v3
    v_sub_f32 v131, v131, v3
    v_sub_f32 v132, v132, v3
    v_sub_f32 v133, v133, v3
    v_sub_f32 v134, v134, v3
    v_sub_f32 v135, v135, v3
    v_mul_f32 v244, v244, v2
    v_mul_f32 v245, v245, v2
    v_exp_f32 v248, v120
    v_exp_f32 v249, v121
    v_exp_f32 v250, v122
    v_add_f32 v246, v244, v248
    v_exp_f32 v251, v123
    v_add_f32 v247, v245, v249
    v_cvt_pk_bf16_f32 v144, v248, v249
    v_exp_f32 v252, v124
    v_add_f32 v246, v246, v250
    v_exp_f32 v253, v125
    v_add_f32 v247, v247, v251
    v_cvt_pk_bf16_f32 v145, v250, v251
    v_exp_f32 v254, v126
    v_add_f32 v246, v246, v252
    v_exp_f32 v255, v127
    v_add_f32 v247, v247, v253
    v_cvt_pk_bf16_f32 v146, v252, v253
    v_exp_f32 v248, v128
    v_add_f32 v246, v246, v254
    v_exp_f32 v249, v129
    v_add_f32 v247, v247, v255
    v_cvt_pk_bf16_f32 v147, v254, v255
    v_exp_f32 v250, v130
    v_add_f32 v246, v246, v248
    v_exp_f32 v251, v131
    v_add_f32 v247, v247, v249
    v_cvt_pk_bf16_f32 v148, v248, v249
    v_exp_f32 v252, v132
    v_add_f32 v246, v246, v250
    v_exp_f32 v253, v133
    v_add_f32 v247, v247, v251
    v_cvt_pk_bf16_f32 v149, v250, v251
    v_exp_f32 v254, v134
    v_add_f32 v246, v246, v252
    v_exp_f32 v255, v135
    v_add_f32 v247, v247, v253
    v_cvt_pk_bf16_f32 v150, v252, v253
    v_add_f32 v246, v246, v254
    v_add_f32 v247, v247, v255
    v_cvt_pk_bf16_f32 v151, v254, v255
    v_sub_f32 v216, v216, v3
    v_sub_f32 v217, v217, v3
    v_sub_f32 v218, v218, v3
    v_sub_f32 v219, v219, v3
    v_sub_f32 v220, v220, v3
    v_sub_f32 v221, v221, v3
    v_sub_f32 v222, v222, v3
    v_sub_f32 v223, v223, v3
    v_sub_f32 v224, v224, v3
    v_sub_f32 v225, v225, v3
    v_sub_f32 v226, v226, v3
    v_sub_f32 v227, v227, v3
    v_sub_f32 v228, v228, v3
    v_sub_f32 v229, v229, v3
    v_sub_f32 v230, v230, v3
    v_sub_f32 v231, v231, v3
    v_mul_f32 v40, v40, v2
    v_mul_f32 v41, v41, v2
    v_mul_f32 v42, v42, v2
    v_mul_f32 v43, v43, v2
    v_mul_f32 v44, v44, v2
    v_mul_f32 v45, v45, v2
    v_mul_f32 v46, v46, v2
    v_mul_f32 v47, v47, v2
    v_mul_f32 v48, v48, v2
    v_mul_f32 v49, v49, v2
    v_mul_f32 v50, v50, v2
    v_mul_f32 v51, v51, v2
    v_mul_f32 v52, v52, v2
    v_mul_f32 v53, v53, v2
    v_mul_f32 v54, v54, v2
    v_mul_f32 v55, v55, v2
    v_mul_f32 v56, v56, v2
    v_mul_f32 v57, v57, v2
    v_mul_f32 v58, v58, v2
    v_mul_f32 v59, v59, v2
    v_mul_f32 v60, v60, v2
    v_mul_f32 v61, v61, v2
    v_mul_f32 v62, v62, v2
    v_mul_f32 v63, v63, v2
    v_mul_f32 v64, v64, v2
    v_mul_f32 v65, v65, v2
    v_mul_f32 v66, v66, v2
    v_mul_f32 v67, v67, v2
    v_mul_f32 v68, v68, v2
    v_mul_f32 v69, v69, v2
    v_mul_f32 v70, v70, v2
    v_mul_f32 v71, v71, v2
    v_mul_f32 v72, v72, v2
    v_mul_f32 v73, v73, v2
    v_mul_f32 v74, v74, v2
    v_mul_f32 v75, v75, v2
    v_mul_f32 v76, v76, v2
    v_mul_f32 v77, v77, v2
    v_mul_f32 v78, v78, v2
    v_mul_f32 v79, v79, v2
    v_mul_f32 v80, v80, v2
    v_mul_f32 v81, v81, v2
    v_mul_f32 v82, v82, v2
    v_mul_f32 v83, v83, v2
    v_mul_f32 v84, v84, v2
    v_mul_f32 v85, v85, v2
    v_mul_f32 v86, v86, v2
    v_mul_f32 v87, v87, v2
    v_mul_f32 v88, v88, v2
    v_mul_f32 v89, v89, v2
    v_mul_f32 v90, v90, v2
    v_mul_f32 v91, v91, v2
    v_mul_f32 v92, v92, v2
    v_mul_f32 v93, v93, v2
    v_mul_f32 v94, v94, v2
    v_mul_f32 v95, v95, v2
    v_mul_f32 v96, v96, v2
    v_mul_f32 v97, v97, v2
    v_mul_f32 v98, v98, v2
    v_mul_f32 v99, v99, v2
    v_mul_f32 v100, v100, v2
    v_mul_f32 v101, v101, v2
    v_mul_f32 v102, v102, v2
    v_mul_f32 v103, v103, v2
    s_branch L_back4
L_g:
    s_setprio 0
    s_sub_u32 s12, s4, 4
    s_lshl_b32 s14, s12, 11
    s_mov_b32 s15, s12
    s_cmp_lg_u32 s15, 3
    s_cbranch_scc1 L_nocas
    s_mov_b64 exec, 1
    v_mov_b32 v231, 0
    s_load_dword s18, s[38:39], 128
    buffer_load_dword v221, off, s[72:75], 0 offset:128
    s_mul_i32 s16, s5, 24
    s_mul_i32 s17, s6, 3
    s_add_u32 s16, s16, s17
    s_lshl_b32 s16, s16, 5
    s_add_u32 s16, s16, s7
    s_lshl_b32 s16, s16, 13
    s_lshr_b32 s17, s16, 6
    s_add_u32 s17, s17, 12582912
    buffer_store_dword v231, off, s[64:67], s16 sc1
    buffer_store_dword v231, off, s[64:67], s17 sc1
    s_min_u32 s16, s8, 11
    s_mul_i32 s16, s16, 163840
    s_mul_i32 s17, s5, 1280
    s_add_u32 s16, s16, s17
    s_add_u32 s16, s16, s88
    buffer_load_dword v222, off, s[68:71], s16
    s_lshl_b32 s16, s6, 5
    s_add_u32 s16, s16, s7
    s_lshl_b32 s16, s16, 18
    s_add_u32 s17, s16, 1048576
    buffer_load_dword v223, off, s[52:55], s16
    buffer_load_dword v224, off, s[56:59], s16
    buffer_load_dword v225, off, s[52:55], s17
    buffer_load_dword v226, off, s[56:59], s17
    s_mov_b64 exec, -1
    s_waitcnt lgkmcnt(0)
    s_cmp_ge_u32 s2, 256
    s_cbranch_scc1 L_pfd
    s_memrealtime s[16:17]
    s_waitcnt lgkmcnt(0)
    s_or_b32 s16, s16, 1
    v_mov_b32 v230, s16
    s_mov_b64 exec, 1
    buffer_atomic_cmpswap v[230:231], off, s[72:75], 0 sc1
    s_mov_b64 exec, -1
    s_branch L_pfd
L_nocas:
    s_cmp_eq_u32 s15, 1
    s_cbranch_scc1 L_pfx
    s_mul_i32 s16, s6, 655360
    s_lshl_b32 s17, s7, 8
    s_add_u32 s16, s16, s17
    s_lshl_b32 s17, s15, 9
    s_add_u32 s16, s16, s17
    v_lshrrev_b32 v2, 2, v0
    v_lshlrev_b32 v2, 13, v2
    v_and_b32 v3, 3, v0
    v_lshl_add_u32 v2, v3, 6, v2
    buffer_load_dword v220, v2, s[48:51], s16 offen
    s_add_u32 s16, s16, 131072
    buffer_load_dword v221, v2, s[48:51], s16 offen
    s_add_u32 s16, s16, 131072
    buffer_load_dword v222, v2, s[48:51], s16 offen
    s_add_u32 s16, s16, 131072
    buffer_load_dword v223, v2, s[48:51], s16 offen
    s_add_u32 s16, s16, 131072
    buffer_load_dword v224, v2, s[48:51], s16 offen
    s_add_u32 s16, s16, 131072
    s_branch L_pfd
L_pfx:
    s_mul_i32 s16, s6, 122880
    s_and_b32 s17, s10, 3
    s_mul_i32 s17, s17, 30720
    s_add_u32 s16, s16, s17
    v_lshlrev_b32 v2, 6, v0
    buffer_load_dword v220, v2, s[44:47], s16 offen
    s_add_u32 s16, s16, 4096
    buffer_load_dword v221, v2, s[44:47], s16 offen
    s_add_u32 s16, s16, 4096
    buffer_load_dword v222, v2, s[44:47], s16 offen
    s_add_u32 s16, s16, 4096
    buffer_load_dword v223, v2, s[44:47], s16 offen
    s_add_u32 s16, s16, 4096
    buffer_load_dword v224, v2, s[44:47], s16 offen
    s_add_u32 s16, s16, 4096
    buffer_load_dword v225, v2, s[44:47], s16 offen
    s_add_u32 s16, s16, 4096
    buffer_load_dword v226, v2, s[44:47], s16 offen
    s_add_u32 s16, s16, 4096
    buffer_load_dword v227, v2, s[44:47], s16 offen
    s_add_u32 s16, s16, 4096
L_pfd:
    v_and_b32 v6, 31, v0
    v_lshrrev_b32 v7, 5, v0
    v_lshrrev_b32 v8, 1, v6
    v_and_b32 v8, 7, v8
    v_xor_b32 v8, v8, v7
    v_lshlrev_b32 v8, 4, v8
    v_lshl_add_u32 v208, v6, 7, v8
    v_xor_b32 v209, 32, v208
    v_xor_b32 v210, 64, v208
    v_xor_b32 v211, 96, v208
    v_add_u32 v212, 147456, v208
    v_add_u32 v213, 147456, v209
    v_add_u32 v214, 147456, v210
    v_add_u32 v215, 147456, v211
    v_lshrrev_b32 v6, 2, v0
    v_and_b32 v6, 3, v6
    v_lshrrev_b32 v8, 4, v0
    v_and_b32 v8, 1, v8
    v_lshlrev_b32 v8, 5, v8
    v_and_b32 v5, 1, v0
    v_lshl_add_u32 v8, v5, 4, v8
    v_and_b32 v5, 2, v0
    v_lshl_add_u32 v8, v5, 2, v8
    v_lshl_add_u32 v8, v6, 8, v8
    v_lshl_add_u32 v8, v6, 6, v8
    v_lshl_add_u32 v8, v7, 11, v8
    s_lshl_b32 s13, s12, 6
    v_xor_b32 v8, s13, v8
    v_add_u32 v216, 65536, v8
    v_add_u32 v217, 49152, v216
    s_mov_b32 s80, 0
    s_barrier
    ds_read_b64_tr_b16 v[152:153], v216 offset:32768
    ds_read_b64_tr_b16 v[154:155], v216 offset:33792
    ds_read_b128 v[104:107], v212 offset:0
    ds_read_b128 v[108:111], v212 offset:4096
    ds_read_b128 v[112:115], v212 offset:8192
    ds_read_b64_tr_b16 v[156:157], v216 offset:36864
    ds_read_b64_tr_b16 v[158:159], v216 offset:37888
    ds_read_b128 v[116:119], v213 offset:0
    ds_read_b128 v[120:123], v213 offset:4096
    ds_read_b128 v[124:127], v213 offset:8192
    ds_read_b64_tr_b16 v[160:161], v216 offset:40960
    ds_read_b64_tr_b16 v[162:163], v216 offset:41984
    ds_read_b64_tr_b16 v[164:165], v216 offset:45056
    ds_read_b64_tr_b16 v[166:167], v216 offset:46080
    s_waitcnt lgkmcnt(0)
    s_barrier
    ds_read_b64_tr_b16 v[168:169], v217 offset:0
    ds_read_b64_tr_b16 v[170:171], v217 offset:1024
    v_mfma_f32_32x32x16_bf16 v[8:23], v[152:155], v[104:107], 0
    ds_read_b128 v[128:131], v214 offset:0
    ds_read_b128 v[132:135], v214 offset:4096
    v_mfma_f32_32x32x16_bf16 v[24:39], v[152:155], v[108:111], 0
    ds_read_b128 v[136:139], v214 offset:8192
    ds_read_b64_tr_b16 v[172:173], v217 offset:4096
    v_mfma_f32_32x32x16_bf16 v[40:55], v[152:155], v[112:115], 0
    ds_read_b64_tr_b16 v[174:175], v217 offset:5120
    ds_read_b128 v[140:143], v215 offset:0
    v_mfma_f32_32x32x16_bf16 v[8:23], v[156:159], v[116:119], v[8:23]
    ds_read_b128 v[144:147], v215 offset:4096
    ds_read_b128 v[148:151], v215 offset:8192
    v_mfma_f32_32x32x16_bf16 v[24:39], v[156:159], v[120:123], v[24:39]
    ds_read_b64_tr_b16 v[176:177], v217 offset:8192
    ds_read_b64_tr_b16 v[178:179], v217 offset:9216
    v_mfma_f32_32x32x16_bf16 v[40:55], v[156:159], v[124:127], v[40:55]
    ds_read_b64_tr_b16 v[180:181], v217 offset:12288
    ds_read_b64_tr_b16 v[182:183], v217 offset:13312
    v_mfma_f32_32x32x16_bf16 v[56:71], v[160:163], v[104:107], 0
    v_mfma_f32_32x32x16_bf16 v[72:87], v[160:163], v[108:111], 0
    v_mfma_f32_32x32x16_bf16 v[88:103], v[160:163], v[112:115], 0
    v_mfma_f32_32x32x16_bf16 v[56:71], v[164:167], v[116:119], v[56:71]
    v_mfma_f32_32x32x16_bf16 v[72:87], v[164:167], v[120:123], v[72:87]
    v_mfma_f32_32x32x16_bf16 v[88:103], v[164:167], v[124:127], v[88:103]
    s_waitcnt lgkmcnt(0)
    s_barrier
    ds_read_b64_tr_b16 v[152:153], v217 offset:16384
    ds_read_b64_tr_b16 v[154:155], v217 offset:17408
    v_mfma_f32_32x32x16_bf16 v[8:23], v[168:171], v[128:131], v[8:23]
    ds_read_b128 v[104:107], v208 offset:16384
    ds_read_b128 v[108:111], v208 offset:20480
    v_mfma_f32_32x32x16_bf16 v[24:39], v[168:171], v[132:135], v[24:39]
    ds_read_b128 v[112:115], v208 offset:24576
    ds_read_b64_tr_b16 v[156:157], v217 offset:20480
    v_mfma_f32_32x32x16_bf16 v[40:55], v[168:171], v[136:139], v[40:55]
    ds_read_b64_tr_b16 v[158:159], v217 offset:21504
    ds_read_b128 v[116:119], v209 offset:16384
    v_mfma_f32_32x32x16_bf16 v[8:23], v[172:175], v[140:143], v[8:23]
    ds_read_b128 v[120:123], v209 offset:20480
    ds_read_b128 v[124:127], v209 offset:24576
    v_mfma_f32_32x32x16_bf16 v[24:39], v[172:175], v[144:147], v[24:39]
    ds_read_b64_tr_b16 v[160:161], v217 offset:24576
    ds_read_b64_tr_b16 v[162:163], v217 offset:25600
    v_mfma_f32_32x32x16_bf16 v[40:55], v[172:175], v[148:151], v[40:55]
    ds_read_b64_tr_b16 v[164:165], v217 offset:28672
    ds_read_b64_tr_b16 v[166:167], v217 offset:29696
    v_mfma_f32_32x32x16_bf16 v[56:71], v[176:179], v[128:131], v[56:71]
    v_mfma_f32_32x32x16_bf16 v[72:87], v[176:179], v[132:135], v[72:87]
    v_mfma_f32_32x32x16_bf16 v[88:103], v[176:179], v[136:139], v[88:103]
    v_mfma_f32_32x32x16_bf16 v[56:71], v[180:183], v[140:143], v[56:71]
    v_mfma_f32_32x32x16_bf16 v[72:87], v[180:183], v[144:147], v[72:87]
    v_mfma_f32_32x32x16_bf16 v[88:103], v[180:183], v[148:151], v[88:103]
    s_waitcnt lgkmcnt(0)
    s_barrier
    ds_read_b64_tr_b16 v[168:169], v216 offset:0
    ds_read_b64_tr_b16 v[170:171], v216 offset:1024
    v_mfma_f32_32x32x16_bf16 v[8:23], v[152:155], v[104:107], v[8:23]
    ds_read_b128 v[128:131], v210 offset:16384
    ds_read_b128 v[132:135], v210 offset:20480
    v_mfma_f32_32x32x16_bf16 v[24:39], v[152:155], v[108:111], v[24:39]
    ds_read_b128 v[136:139], v210 offset:24576
    ds_read_b64_tr_b16 v[172:173], v216 offset:4096
    v_mfma_f32_32x32x16_bf16 v[40:55], v[152:155], v[112:115], v[40:55]
    ds_read_b64_tr_b16 v[174:175], v216 offset:5120
    ds_read_b128 v[140:143], v211 offset:16384
    v_mfma_f32_32x32x16_bf16 v[8:23], v[156:159], v[116:119], v[8:23]
    ds_read_b128 v[144:147], v211 offset:20480
    ds_read_b128 v[148:151], v211 offset:24576
    v_mfma_f32_32x32x16_bf16 v[24:39], v[156:159], v[120:123], v[24:39]
    ds_read_b64_tr_b16 v[176:177], v216 offset:8192
    ds_read_b64_tr_b16 v[178:179], v216 offset:9216
    v_mfma_f32_32x32x16_bf16 v[40:55], v[156:159], v[124:127], v[40:55]
    ds_read_b64_tr_b16 v[180:181], v216 offset:12288
    ds_read_b64_tr_b16 v[182:183], v216 offset:13312
    v_mfma_f32_32x32x16_bf16 v[56:71], v[160:163], v[104:107], v[56:71]
    v_mfma_f32_32x32x16_bf16 v[72:87], v[160:163], v[108:111], v[72:87]
    v_mfma_f32_32x32x16_bf16 v[88:103], v[160:163], v[112:115], v[88:103]
    v_mfma_f32_32x32x16_bf16 v[56:71], v[164:167], v[116:119], v[56:71]
    v_mfma_f32_32x32x16_bf16 v[72:87], v[164:167], v[120:123], v[72:87]
    v_mfma_f32_32x32x16_bf16 v[88:103], v[164:167], v[124:127], v[88:103]
    s_waitcnt lgkmcnt(0)
    s_barrier
    ds_read_b64_tr_b16 v[152:153], v216 offset:16384
    ds_read_b64_tr_b16 v[154:155], v216 offset:17408
    v_mfma_f32_32x32x16_bf16 v[8:23], v[168:171], v[128:131], v[8:23]
    ds_read_b128 v[104:107], v208 offset:49152
    ds_read_b128 v[108:111], v208 offset:53248
    v_mfma_f32_32x32x16_bf16 v[24:39], v[168:171], v[132:135], v[24:39]
    ds_read_b128 v[112:115], v208 offset:57344
    ds_read_b64_tr_b16 v[156:157], v216 offset:20480
    v_mfma_f32_32x32x16_bf16 v[40:55], v[168:171], v[136:139], v[40:55]
    ds_read_b64_tr_b16 v[158:159], v216 offset:21504
    ds_read_b128 v[116:119], v209 offset:49152
    v_mfma_f32_32x32x16_bf16 v[8:23], v[172:175], v[140:143], v[8:23]
    ds_read_b128 v[120:123], v209 offset:53248
    ds_read_b128 v[124:127], v209 offset:57344
    v_mfma_f32_32x32x16_bf16 v[24:39], v[172:175], v[144:147], v[24:39]
    ds_read_b64_tr_b16 v[160:161], v216 offset:24576
    ds_read_b64_tr_b16 v[162:163], v216 offset:25600
    v_mfma_f32_32x32x16_bf16 v[40:55], v[172:175], v[148:151], v[40:55]
    ds_read_b64_tr_b16 v[164:165], v216 offset:28672
    ds_read_b64_tr_b16 v[166:167], v216 offset:29696
    v_mfma_f32_32x32x16_bf16 v[56:71], v[176:179], v[128:131], v[56:71]
    v_mfma_f32_32x32x16_bf16 v[72:87], v[176:179], v[132:135], v[72:87]
    v_mfma_f32_32x32x16_bf16 v[88:103], v[176:179], v[136:139], v[88:103]
    v_mfma_f32_32x32x16_bf16 v[56:71], v[180:183], v[140:143], v[56:71]
    v_mfma_f32_32x32x16_bf16 v[72:87], v[180:183], v[144:147], v[72:87]
    v_mfma_f32_32x32x16_bf16 v[88:103], v[180:183], v[148:151], v[88:103]
    s_waitcnt lgkmcnt(0)
    s_barrier
    ds_read_b64_tr_b16 v[168:169], v216 offset:32768
    ds_read_b64_tr_b16 v[170:171], v216 offset:33792
    v_mfma_f32_32x32x16_bf16 v[8:23], v[152:155], v[104:107], v[8:23]
    ds_read_b128 v[128:131], v210 offset:49152
    ds_read_b128 v[132:135], v210 offset:53248
    v_mfma_f32_32x32x16_bf16 v[24:39], v[152:155], v[108:111], v[24:39]
    ds_read_b128 v[136:139], v210 offset:57344
    ds_read_b64_tr_b16 v[172:173], v216 offset:36864
    v_mfma_f32_32x32x16_bf16 v[40:55], v[152:155], v[112:115], v[40:55]
    ds_read_b64_tr_b16 v[174:175], v216 offset:37888
    ds_read_b128 v[140:143], v211 offset:49152
    v_mfma_f32_32x32x16_bf16 v[8:23], v[156:159], v[116:119], v[8:23]
    ds_read_b128 v[144:147], v211 offset:53248
    ds_read_b128 v[148:151], v211 offset:57344
    v_mfma_f32_32x32x16_bf16 v[24:39], v[156:159], v[120:123], v[24:39]
    ds_read_b64_tr_b16 v[176:177], v216 offset:40960
    ds_read_b64_tr_b16 v[178:179], v216 offset:41984
    v_mfma_f32_32x32x16_bf16 v[40:55], v[156:159], v[124:127], v[40:55]
    ds_read_b64_tr_b16 v[180:181], v216 offset:45056
    ds_read_b64_tr_b16 v[182:183], v216 offset:46080
    v_mfma_f32_32x32x16_bf16 v[56:71], v[160:163], v[104:107], v[56:71]
    v_mfma_f32_32x32x16_bf16 v[72:87], v[160:163], v[108:111], v[72:87]
    v_mfma_f32_32x32x16_bf16 v[88:103], v[160:163], v[112:115], v[88:103]
    v_mfma_f32_32x32x16_bf16 v[56:71], v[164:167], v[116:119], v[56:71]
    v_mfma_f32_32x32x16_bf16 v[72:87], v[164:167], v[120:123], v[72:87]
    v_mfma_f32_32x32x16_bf16 v[88:103], v[164:167], v[124:127], v[88:103]
    s_waitcnt lgkmcnt(0)
    s_barrier
    ds_read_b64_tr_b16 v[152:153], v217 offset:0
    ds_read_b64_tr_b16 v[154:155], v217 offset:1024
    v_mfma_f32_32x32x16_bf16 v[8:23], v[168:171], v[128:131], v[8:23]
    ds_read_b128 v[104:107], v212 offset:0
    ds_read_b128 v[108:111], v212 offset:4096
    v_mfma_f32_32x32x16_bf16 v[24:39], v[168:171], v[132:135], v[24:39]
    ds_read_b128 v[112:115], v212 offset:8192
    ds_read_b64_tr_b16 v[156:157], v217 offset:4096
    v_mfma_f32_32x32x16_bf16 v[40:55], v[168:171], v[136:139], v[40:55]
    ds_read_b64_tr_b16 v[158:159], v217 offset:5120
    ds_read_b128 v[116:119], v213 offset:0
    v_mfma_f32_32x32x16_bf16 v[8:23], v[172:175], v[140:143], v[8:23]
    ds_read_b128 v[120:123], v213 offset:4096
    ds_read_b128 v[124:127], v213 offset:8192
    v_mfma_f32_32x32x16_bf16 v[24:39], v[172:175], v[144:147], v[24:39]
    ds_read_b64_tr_b16 v[160:161], v217 offset:8192
    ds_read_b64_tr_b16 v[162:163], v217 offset:9216
    v_mfma_f32_32x32x16_bf16 v[40:55], v[172:175], v[148:151], v[40:55]
    ds_read_b64_tr_b16 v[164:165], v217 offset:12288
    ds_read_b64_tr_b16 v[166:167], v217 offset:13312
    v_mfma_f32_32x32x16_bf16 v[56:71], v[176:179], v[128:131], v[56:71]
    v_mfma_f32_32x32x16_bf16 v[72:87], v[176:179], v[132:135], v[72:87]
    v_mfma_f32_32x32x16_bf16 v[88:103], v[176:179], v[136:139], v[88:103]
    v_mfma_f32_32x32x16_bf16 v[56:71], v[180:183], v[140:143], v[56:71]
    v_mfma_f32_32x32x16_bf16 v[72:87], v[180:183], v[144:147], v[72:87]
    v_mfma_f32_32x32x16_bf16 v[88:103], v[180:183], v[148:151], v[88:103]
    s_waitcnt lgkmcnt(0)
    s_barrier
    ds_read_b64_tr_b16 v[168:169], v217 offset:16384
    ds_read_b64_tr_b16 v[170:171], v217 offset:17408
    v_mfma_f32_32x32x16_bf16 v[8:23], v[152:155], v[104:107], v[8:23]
    ds_read_b128 v[128:131], v214 offset:0
    ds_read_b128 v[132:135], v214 offset:4096
    v_mfma_f32_32x32x16_bf16 v[24:39], v[152:155], v[108:111], v[24:39]
    ds_read_b128 v[136:139], v214 offset:8192
    ds_read_b64_tr_b16 v[172:173], v217 offset:20480
    v_mfma_f32_32x32x16_bf16 v[40:55], v[152:155], v[112:115], v[40:55]
    ds_read_b64_tr_b16 v[174:175], v217 offset:21504
    ds_read_b128 v[140:143], v215 offset:0
    v_mfma_f32_32x32x16_bf16 v[8:23], v[156:159], v[116:119], v[8:23]
    ds_read_b128 v[144:147], v215 offset:4096
    ds_read_b128 v[148:151], v215 offset:8192
    v_mfma_f32_32x32x16_bf16 v[24:39], v[156:159], v[120:123], v[24:39]
    ds_read_b64_tr_b16 v[176:177], v217 offset:24576
    ds_read_b64_tr_b16 v[178:179], v217 offset:25600
    v_mfma_f32_32x32x16_bf16 v[40:55], v[156:159], v[124:127], v[40:55]
    ds_read_b64_tr_b16 v[180:181], v217 offset:28672
    ds_read_b64_tr_b16 v[182:183], v217 offset:29696
    v_mfma_f32_32x32x16_bf16 v[56:71], v[160:163], v[104:107], v[56:71]
    v_mfma_f32_32x32x16_bf16 v[72:87], v[160:163], v[108:111], v[72:87]
    v_mfma_f32_32x32x16_bf16 v[88:103], v[160:163], v[112:115], v[88:103]
    v_mfma_f32_32x32x16_bf16 v[56:71], v[164:167], v[116:119], v[56:71]
    v_mfma_f32_32x32x16_bf16 v[72:87], v[164:167], v[120:123], v[72:87]
    v_mfma_f32_32x32x16_bf16 v[88:103], v[164:167], v[124:127], v[88:103]
    s_waitcnt lgkmcnt(0)
    s_barrier
    ds_read_b64_tr_b16 v[152:153], v216 offset:0
    ds_read_b64_tr_b16 v[154:155], v216 offset:1024
    v_mfma_f32_32x32x16_bf16 v[8:23], v[168:171], v[128:131], v[8:23]
    ds_read_b128 v[104:107], v208 offset:16384
    ds_read_b128 v[108:111], v208 offset:20480
    v_mfma_f32_32x32x16_bf16 v[24:39], v[168:171], v[132:135], v[24:39]
    ds_read_b128 v[112:115], v208 offset:24576
    ds_read_b64_tr_b16 v[156:157], v216 offset:4096
    v_mfma_f32_32x32x16_bf16 v[40:55], v[168:171], v[136:139], v[40:55]
    ds_read_b64_tr_b16 v[158:159], v216 offset:5120
    ds_read_b128 v[116:119], v209 offset:16384
    v_mfma_f32_32x32x16_bf16 v[8:23], v[172:175], v[140:143], v[8:23]
    ds_read_b128 v[120:123], v209 offset:20480
    ds_read_b128 v[124:127], v209 offset:24576
    v_mfma_f32_32x32x16_bf16 v[24:39], v[172:175], v[144:147], v[24:39]
    ds_read_b64_tr_b16 v[160:161], v216 offset:8192
    ds_read_b64_tr_b16 v[162:163], v216 offset:9216
    v_mfma_f32_32x32x16_bf16 v[40:55], v[172:175], v[148:151], v[40:55]
    ds_read_b64_tr_b16 v[164:165], v216 offset:12288
    ds_read_b64_tr_b16 v[166:167], v216 offset:13312
    v_mfma_f32_32x32x16_bf16 v[56:71], v[176:179], v[128:131], v[56:71]
    v_mfma_f32_32x32x16_bf16 v[72:87], v[176:179], v[132:135], v[72:87]
    v_mfma_f32_32x32x16_bf16 v[88:103], v[176:179], v[136:139], v[88:103]
    v_mfma_f32_32x32x16_bf16 v[56:71], v[180:183], v[140:143], v[56:71]
    v_mfma_f32_32x32x16_bf16 v[72:87], v[180:183], v[144:147], v[72:87]
    v_mfma_f32_32x32x16_bf16 v[88:103], v[180:183], v[148:151], v[88:103]
    s_waitcnt lgkmcnt(0)
    s_barrier
    ds_read_b64_tr_b16 v[168:169], v216 offset:16384
    ds_read_b64_tr_b16 v[170:171], v216 offset:17408
    v_mfma_f32_32x32x16_bf16 v[8:23], v[152:155], v[104:107], v[8:23]
    ds_read_b128 v[128:131], v210 offset:16384
    ds_read_b128 v[132:135], v210 offset:20480
    v_mfma_f32_32x32x16_bf16 v[24:39], v[152:155], v[108:111], v[24:39]
    ds_read_b128 v[136:139], v210 offset:24576
    ds_read_b64_tr_b16 v[172:173], v216 offset:20480
    v_mfma_f32_32x32x16_bf16 v[40:55], v[152:155], v[112:115], v[40:55]
    ds_read_b64_tr_b16 v[174:175], v216 offset:21504
    ds_read_b128 v[140:143], v211 offset:16384
    v_mfma_f32_32x32x16_bf16 v[8:23], v[156:159], v[116:119], v[8:23]
    ds_read_b128 v[144:147], v211 offset:20480
    ds_read_b128 v[148:151], v211 offset:24576
    v_mfma_f32_32x32x16_bf16 v[24:39], v[156:159], v[120:123], v[24:39]
    ds_read_b64_tr_b16 v[176:177], v216 offset:24576
    ds_read_b64_tr_b16 v[178:179], v216 offset:25600
    v_mfma_f32_32x32x16_bf16 v[40:55], v[156:159], v[124:127], v[40:55]
    ds_read_b64_tr_b16 v[180:181], v216 offset:28672
    ds_read_b64_tr_b16 v[182:183], v216 offset:29696
    v_mfma_f32_32x32x16_bf16 v[56:71], v[160:163], v[104:107], v[56:71]
    v_mfma_f32_32x32x16_bf16 v[72:87], v[160:163], v[108:111], v[72:87]
    v_mfma_f32_32x32x16_bf16 v[88:103], v[160:163], v[112:115], v[88:103]
    v_mfma_f32_32x32x16_bf16 v[56:71], v[164:167], v[116:119], v[56:71]
    v_mfma_f32_32x32x16_bf16 v[72:87], v[164:167], v[120:123], v[72:87]
    v_mfma_f32_32x32x16_bf16 v[88:103], v[164:167], v[124:127], v[88:103]
    s_waitcnt lgkmcnt(0)
    s_barrier
    ds_read_b64_tr_b16 v[152:153], v216 offset:32768
    ds_read_b64_tr_b16 v[154:155], v216 offset:33792
    v_mfma_f32_32x32x16_bf16 v[8:23], v[168:171], v[128:131], v[8:23]
    ds_read_b128 v[104:107], v208 offset:49152
    ds_read_b128 v[108:111], v208 offset:53248
    v_mfma_f32_32x32x16_bf16 v[24:39], v[168:171], v[132:135], v[24:39]
    ds_read_b128 v[112:115], v208 offset:57344
    ds_read_b64_tr_b16 v[156:157], v216 offset:36864
    v_mfma_f32_32x32x16_bf16 v[40:55], v[168:171], v[136:139], v[40:55]
    ds_read_b64_tr_b16 v[158:159], v216 offset:37888
    ds_read_b128 v[116:119], v209 offset:49152
    v_mfma_f32_32x32x16_bf16 v[8:23], v[172:175], v[140:143], v[8:23]
    ds_read_b128 v[120:123], v209 offset:53248
    ds_read_b128 v[124:127], v209 offset:57344
    v_mfma_f32_32x32x16_bf16 v[24:39], v[172:175], v[144:147], v[24:39]
    ds_read_b64_tr_b16 v[160:161], v216 offset:40960
    ds_read_b64_tr_b16 v[162:163], v216 offset:41984
    v_mfma_f32_32x32x16_bf16 v[40:55], v[172:175], v[148:151], v[40:55]
    ds_read_b64_tr_b16 v[164:165], v216 offset:45056
    ds_read_b64_tr_b16 v[166:167], v216 offset:46080
    v_mfma_f32_32x32x16_bf16 v[56:71], v[176:179], v[128:131], v[56:71]
    v_mfma_f32_32x32x16_bf16 v[72:87], v[176:179], v[132:135], v[72:87]
    v_mfma_f32_32x32x16_bf16 v[88:103], v[176:179], v[136:139], v[88:103]
    v_mfma_f32_32x32x16_bf16 v[56:71], v[180:183], v[140:143], v[56:71]
    v_mfma_f32_32x32x16_bf16 v[72:87], v[180:183], v[144:147], v[72:87]
    v_mfma_f32_32x32x16_bf16 v[88:103], v[180:183], v[148:151], v[88:103]
    s_waitcnt lgkmcnt(0)
    s_barrier
    ds_read_b64_tr_b16 v[168:169], v217 offset:0
    ds_read_b64_tr_b16 v[170:171], v217 offset:1024
    v_mfma_f32_32x32x16_bf16 v[8:23], v[152:155], v[104:107], v[8:23]
    ds_read_b128 v[128:131], v210 offset:49152
    ds_read_b128 v[132:135], v210 offset:53248
    v_mfma_f32_32x32x16_bf16 v[24:39], v[152:155], v[108:111], v[24:39]
    ds_read_b128 v[136:139], v210 offset:57344
    ds_read_b64_tr_b16 v[172:173], v217 offset:4096
    v_mfma_f32_32x32x16_bf16 v[40:55], v[152:155], v[112:115], v[40:55]
    ds_read_b64_tr_b16 v[174:175], v217 offset:5120
    ds_read_b128 v[140:143], v211 offset:49152
    v_mfma_f32_32x32x16_bf16 v[8:23], v[156:159], v[116:119], v[8:23]
    ds_read_b128 v[144:147], v211 offset:53248
    ds_read_b128 v[148:151], v211 offset:57344
    v_mfma_f32_32x32x16_bf16 v[24:39], v[156:159], v[120:123], v[24:39]
    ds_read_b64_tr_b16 v[176:177], v217 offset:8192
    ds_read_b64_tr_b16 v[178:179], v217 offset:9216
    v_mfma_f32_32x32x16_bf16 v[40:55], v[156:159], v[124:127], v[40:55]
    ds_read_b64_tr_b16 v[180:181], v217 offset:12288
    ds_read_b64_tr_b16 v[182:183], v217 offset:13312
    v_mfma_f32_32x32x16_bf16 v[56:71], v[160:163], v[104:107], v[56:71]
    v_mfma_f32_32x32x16_bf16 v[72:87], v[160:163], v[108:111], v[72:87]
    v_mfma_f32_32x32x16_bf16 v[88:103], v[160:163], v[112:115], v[88:103]
    v_mfma_f32_32x32x16_bf16 v[56:71], v[164:167], v[116:119], v[56:71]
    v_mfma_f32_32x32x16_bf16 v[72:87], v[164:167], v[120:123], v[72:87]
    v_mfma_f32_32x32x16_bf16 v[88:103], v[164:167], v[124:127], v[88:103]
    s_waitcnt lgkmcnt(0)
    s_barrier
    ds_read_b64_tr_b16 v[152:153], v217 offset:16384
    ds_read_b64_tr_b16 v[154:155], v217 offset:17408
    v_mfma_f32_32x32x16_bf16 v[8:23], v[168:171], v[128:131], v[8:23]
    ds_read_b128 v[104:107], v212 offset:0
    ds_read_b128 v[108:111], v212 offset:4096
    v_mfma_f32_32x32x16_bf16 v[24:39], v[168:171], v[132:135], v[24:39]
    ds_read_b128 v[112:115], v212 offset:8192
    ds_read_b64_tr_b16 v[156:157], v217 offset:20480
    v_mfma_f32_32x32x16_bf16 v[40:55], v[168:171], v[136:139], v[40:55]
    ds_read_b64_tr_b16 v[158:159], v217 offset:21504
    ds_read_b128 v[116:119], v213 offset:0
    v_mfma_f32_32x32x16_bf16 v[8:23], v[172:175], v[140:143], v[8:23]
    ds_read_b128 v[120:123], v213 offset:4096
    ds_read_b128 v[124:127], v213 offset:8192
    v_mfma_f32_32x32x16_bf16 v[24:39], v[172:175], v[144:147], v[24:39]
    ds_read_b64_tr_b16 v[160:161], v217 offset:24576
    ds_read_b64_tr_b16 v[162:163], v217 offset:25600
    v_mfma_f32_32x32x16_bf16 v[40:55], v[172:175], v[148:151], v[40:55]
    ds_read_b64_tr_b16 v[164:165], v217 offset:28672
    ds_read_b64_tr_b16 v[166:167], v217 offset:29696
    v_mfma_f32_32x32x16_bf16 v[56:71], v[176:179], v[128:131], v[56:71]
    v_mfma_f32_32x32x16_bf16 v[72:87], v[176:179], v[132:135], v[72:87]
    v_mfma_f32_32x32x16_bf16 v[88:103], v[176:179], v[136:139], v[88:103]
    v_mfma_f32_32x32x16_bf16 v[56:71], v[180:183], v[140:143], v[56:71]
    v_mfma_f32_32x32x16_bf16 v[72:87], v[180:183], v[144:147], v[72:87]
    v_mfma_f32_32x32x16_bf16 v[88:103], v[180:183], v[148:151], v[88:103]
    s_waitcnt lgkmcnt(0)
    s_barrier
    ds_read_b64_tr_b16 v[168:169], v216 offset:0
    ds_read_b64_tr_b16 v[170:171], v216 offset:1024
    v_mfma_f32_32x32x16_bf16 v[8:23], v[152:155], v[104:107], v[8:23]
    ds_read_b128 v[128:131], v214 offset:0
    ds_read_b128 v[132:135], v214 offset:4096
    v_mfma_f32_32x32x16_bf16 v[24:39], v[152:155], v[108:111], v[24:39]
    ds_read_b128 v[136:139], v214 offset:8192
    ds_read_b64_tr_b16 v[172:173], v216 offset:4096
    v_mfma_f32_32x32x16_bf16 v[40:55], v[152:155], v[112:115], v[40:55]
    ds_read_b64_tr_b16 v[174:175], v216 offset:5120
    ds_read_b128 v[140:143], v215 offset:0
    v_mfma_f32_32x32x16_bf16 v[8:23], v[156:159], v[116:119], v[8:23]
    ds_read_b128 v[144:147], v215 offset:4096
    ds_read_b128 v[148:151], v215 offset:8192
    v_mfma_f32_32x32x16_bf16 v[24:39], v[156:159], v[120:123], v[24:39]
    ds_read_b64_tr_b16 v[176:177], v216 offset:8192
    ds_read_b64_tr_b16 v[178:179], v216 offset:9216
    v_mfma_f32_32x32x16_bf16 v[40:55], v[156:159], v[124:127], v[40:55]
    ds_read_b64_tr_b16 v[180:181], v216 offset:12288
    ds_read_b64_tr_b16 v[182:183], v216 offset:13312
    v_mfma_f32_32x32x16_bf16 v[56:71], v[160:163], v[104:107], v[56:71]
    v_mfma_f32_32x32x16_bf16 v[72:87], v[160:163], v[108:111], v[72:87]
    v_mfma_f32_32x32x16_bf16 v[88:103], v[160:163], v[112:115], v[88:103]
    v_mfma_f32_32x32x16_bf16 v[56:71], v[164:167], v[116:119], v[56:71]
    v_mfma_f32_32x32x16_bf16 v[72:87], v[164:167], v[120:123], v[72:87]
    v_mfma_f32_32x32x16_bf16 v[88:103], v[164:167], v[124:127], v[88:103]
    s_waitcnt lgkmcnt(0)
    s_barrier
    ds_read_b64_tr_b16 v[152:153], v216 offset:16384
    ds_read_b64_tr_b16 v[154:155], v216 offset:17408
    v_mfma_f32_32x32x16_bf16 v[8:23], v[168:171], v[128:131], v[8:23]
    ds_read_b128 v[104:107], v208 offset:16384
    ds_read_b128 v[108:111], v208 offset:20480
    v_mfma_f32_32x32x16_bf16 v[24:39], v[168:171], v[132:135], v[24:39]
    ds_read_b128 v[112:115], v208 offset:24576
    ds_read_b64_tr_b16 v[156:157], v216 offset:20480
    v_mfma_f32_32x32x16_bf16 v[40:55], v[168:171], v[136:139], v[40:55]
    ds_read_b64_tr_b16 v[158:159], v216 offset:21504
    ds_read_b128 v[116:119], v209 offset:16384
    v_mfma_f32_32x32x16_bf16 v[8:23], v[172:175], v[140:143], v[8:23]
    ds_read_b128 v[120:123], v209 offset:20480
    ds_read_b128 v[124:127], v209 offset:24576
    v_mfma_f32_32x32x16_bf16 v[24:39], v[172:175], v[144:147], v[24:39]
    ds_read_b64_tr_b16 v[160:161], v216 offset:24576
    ds_read_b64_tr_b16 v[162:163], v216 offset:25600
    v_mfma_f32_32x32x16_bf16 v[40:55], v[172:175], v[148:151], v[40:55]
    ds_read_b64_tr_b16 v[164:165], v216 offset:28672
    ds_read_b64_tr_b16 v[166:167], v216 offset:29696
    v_mfma_f32_32x32x16_bf16 v[56:71], v[176:179], v[128:131], v[56:71]
    v_mfma_f32_32x32x16_bf16 v[72:87], v[176:179], v[132:135], v[72:87]
    v_mfma_f32_32x32x16_bf16 v[88:103], v[176:179], v[136:139], v[88:103]
    v_mfma_f32_32x32x16_bf16 v[56:71], v[180:183], v[140:143], v[56:71]
    v_mfma_f32_32x32x16_bf16 v[72:87], v[180:183], v[144:147], v[72:87]
    v_mfma_f32_32x32x16_bf16 v[88:103], v[180:183], v[148:151], v[88:103]
    s_waitcnt lgkmcnt(0)
    s_barrier
    ds_read_b64_tr_b16 v[168:169], v216 offset:32768
    ds_read_b64_tr_b16 v[170:171], v216 offset:33792
    v_mfma_f32_32x32x16_bf16 v[8:23], v[152:155], v[104:107], v[8:23]
    ds_read_b128 v[128:131], v210 offset:16384
    ds_read_b128 v[132:135], v210 offset:20480
    v_mfma_f32_32x32x16_bf16 v[24:39], v[152:155], v[108:111], v[24:39]
    ds_read_b128 v[136:139], v210 offset:24576
    ds_read_b64_tr_b16 v[172:173], v216 offset:36864
    v_mfma_f32_32x32x16_bf16 v[40:55], v[152:155], v[112:115], v[40:55]
    ds_read_b64_tr_b16 v[174:175], v216 offset:37888
    ds_read_b128 v[140:143], v211 offset:16384
    v_mfma_f32_32x32x16_bf16 v[8:23], v[156:159], v[116:119], v[8:23]
    ds_read_b128 v[144:147], v211 offset:20480
    ds_read_b128 v[148:151], v211 offset:24576
    v_mfma_f32_32x32x16_bf16 v[24:39], v[156:159], v[120:123], v[24:39]
    ds_read_b64_tr_b16 v[176:177], v216 offset:40960
    ds_read_b64_tr_b16 v[178:179], v216 offset:41984
    v_mfma_f32_32x32x16_bf16 v[40:55], v[156:159], v[124:127], v[40:55]
    ds_read_b64_tr_b16 v[180:181], v216 offset:45056
    ds_read_b64_tr_b16 v[182:183], v216 offset:46080
    v_mfma_f32_32x32x16_bf16 v[56:71], v[160:163], v[104:107], v[56:71]
    v_mfma_f32_32x32x16_bf16 v[72:87], v[160:163], v[108:111], v[72:87]
    v_mfma_f32_32x32x16_bf16 v[88:103], v[160:163], v[112:115], v[88:103]
    v_mfma_f32_32x32x16_bf16 v[56:71], v[164:167], v[116:119], v[56:71]
    v_mfma_f32_32x32x16_bf16 v[72:87], v[164:167], v[120:123], v[72:87]
    v_mfma_f32_32x32x16_bf16 v[88:103], v[164:167], v[124:127], v[88:103]
    s_waitcnt lgkmcnt(0)
    s_barrier
    ds_read_b64_tr_b16 v[152:153], v217 offset:0
    ds_read_b64_tr_b16 v[154:155], v217 offset:1024
    v_mfma_f32_32x32x16_bf16 v[8:23], v[168:171], v[128:131], v[8:23]
    ds_read_b128 v[104:107], v208 offset:49152
    ds_read_b128 v[108:111], v208 offset:53248
    v_mfma_f32_32x32x16_bf16 v[24:39], v[168:171], v[132:135], v[24:39]
    ds_read_b128 v[112:115], v208 offset:57344
    ds_read_b64_tr_b16 v[156:157], v217 offset:4096
    v_mfma_f32_32x32x16_bf16 v[40:55], v[168:171], v[136:139], v[40:55]
    ds_read_b64_tr_b16 v[158:159], v217 offset:5120
    ds_read_b128 v[116:119], v209 offset:49152
    v_mfma_f32_32x32x16_bf16 v[8:23], v[172:175], v[140:143], v[8:23]
    ds_read_b128 v[120:123], v209 offset:53248
    ds_read_b128 v[124:127], v209 offset:57344
    v_mfma_f32_32x32x16_bf16 v[24:39], v[172:175], v[144:147], v[24:39]
    ds_read_b64_tr_b16 v[160:161], v217 offset:8192
    ds_read_b64_tr_b16 v[162:163], v217 offset:9216
    v_mfma_f32_32x32x16_bf16 v[40:55], v[172:175], v[148:151], v[40:55]
    ds_read_b64_tr_b16 v[164:165], v217 offset:12288
    ds_read_b64_tr_b16 v[166:167], v217 offset:13312
    v_mfma_f32_32x32x16_bf16 v[56:71], v[176:179], v[128:131], v[56:71]
    v_mfma_f32_32x32x16_bf16 v[72:87], v[176:179], v[132:135], v[72:87]
    v_mfma_f32_32x32x16_bf16 v[88:103], v[176:179], v[136:139], v[88:103]
    v_mfma_f32_32x32x16_bf16 v[56:71], v[180:183], v[140:143], v[56:71]
    v_mfma_f32_32x32x16_bf16 v[72:87], v[180:183], v[144:147], v[72:87]
    v_mfma_f32_32x32x16_bf16 v[88:103], v[180:183], v[148:151], v[88:103]
    s_waitcnt lgkmcnt(0)
    s_barrier
    ds_read_b64_tr_b16 v[168:169], v217 offset:16384
    ds_read_b64_tr_b16 v[170:171], v217 offset:17408
    v_mfma_f32_32x32x16_bf16 v[8:23], v[152:155], v[104:107], v[8:23]
    ds_read_b128 v[128:131], v210 offset:49152
    ds_read_b128 v[132:135], v210 offset:53248
    v_mfma_f32_32x32x16_bf16 v[24:39], v[152:155], v[108:111], v[24:39]
    ds_read_b128 v[136:139], v210 offset:57344
    ds_read_b64_tr_b16 v[172:173], v217 offset:20480
    v_mfma_f32_32x32x16_bf16 v[40:55], v[152:155], v[112:115], v[40:55]
    ds_read_b64_tr_b16 v[174:175], v217 offset:21504
    ds_read_b128 v[140:143], v211 offset:49152
    v_mfma_f32_32x32x16_bf16 v[8:23], v[156:159], v[116:119], v[8:23]
    ds_read_b128 v[144:147], v211 offset:53248
    ds_read_b128 v[148:151], v211 offset:57344
    v_mfma_f32_32x32x16_bf16 v[24:39], v[156:159], v[120:123], v[24:39]
    ds_read_b64_tr_b16 v[176:177], v217 offset:24576
    ds_read_b64_tr_b16 v[178:179], v217 offset:25600
    v_mfma_f32_32x32x16_bf16 v[40:55], v[156:159], v[124:127], v[40:55]
    ds_read_b64_tr_b16 v[180:181], v217 offset:28672
    ds_read_b64_tr_b16 v[182:183], v217 offset:29696
    v_mfma_f32_32x32x16_bf16 v[56:71], v[160:163], v[104:107], v[56:71]
    v_mfma_f32_32x32x16_bf16 v[72:87], v[160:163], v[108:111], v[72:87]
    v_mfma_f32_32x32x16_bf16 v[88:103], v[160:163], v[112:115], v[88:103]
    v_mfma_f32_32x32x16_bf16 v[56:71], v[164:167], v[116:119], v[56:71]
    v_mfma_f32_32x32x16_bf16 v[72:87], v[164:167], v[120:123], v[72:87]
    v_mfma_f32_32x32x16_bf16 v[88:103], v[164:167], v[124:127], v[88:103]
    s_waitcnt lgkmcnt(0)
    s_barrier
    ds_read_b64_tr_b16 v[152:153], v216 offset:0
    ds_read_b64_tr_b16 v[154:155], v216 offset:1024
    v_mfma_f32_32x32x16_bf16 v[8:23], v[168:171], v[128:131], v[8:23]
    ds_read_b128 v[104:107], v212 offset:0
    ds_read_b128 v[108:111], v212 offset:4096
    v_mfma_f32_32x32x16_bf16 v[24:39], v[168:171], v[132:135], v[24:39]
    ds_read_b128 v[112:115], v212 offset:8192
    ds_read_b64_tr_b16 v[156:157], v216 offset:4096
    v_mfma_f32_32x32x16_bf16 v[40:55], v[168:171], v[136:139], v[40:55]
    ds_read_b64_tr_b16 v[158:159], v216 offset:5120
    ds_read_b128 v[116:119], v213 offset:0
    v_mfma_f32_32x32x16_bf16 v[8:23], v[172:175], v[140:143], v[8:23]
    ds_read_b128 v[120:123], v213 offset:4096
    ds_read_b128 v[124:127], v213 offset:8192
    v_mfma_f32_32x32x16_bf16 v[24:39], v[172:175], v[144:147], v[24:39]
    ds_read_b64_tr_b16 v[160:161], v216 offset:8192
    ds_read_b64_tr_b16 v[162:163], v216 offset:9216
    v_mfma_f32_32x32x16_bf16 v[40:55], v[172:175], v[148:151], v[40:55]
    ds_read_b64_tr_b16 v[164:165], v216 offset:12288
    ds_read_b64_tr_b16 v[166:167], v216 offset:13312
    v_mfma_f32_32x32x16_bf16 v[56:71], v[176:179], v[128:131], v[56:71]
    v_mfma_f32_32x32x16_bf16 v[72:87], v[176:179], v[132:135], v[72:87]
    v_mfma_f32_32x32x16_bf16 v[88:103], v[176:179], v[136:139], v[88:103]
    v_mfma_f32_32x32x16_bf16 v[56:71], v[180:183], v[140:143], v[56:71]
    v_mfma_f32_32x32x16_bf16 v[72:87], v[180:183], v[144:147], v[72:87]
    v_mfma_f32_32x32x16_bf16 v[88:103], v[180:183], v[148:151], v[88:103]
    s_waitcnt lgkmcnt(0)
    s_barrier
    ds_read_b64_tr_b16 v[168:169], v216 offset:16384
    ds_read_b64_tr_b16 v[170:171], v216 offset:17408
    v_mfma_f32_32x32x16_bf16 v[8:23], v[152:155], v[104:107], v[8:23]
    ds_read_b128 v[128:131], v214 offset:0
    ds_read_b128 v[132:135], v214 offset:4096
    v_mfma_f32_32x32x16_bf16 v[24:39], v[152:155], v[108:111], v[24:39]
    ds_read_b128 v[136:139], v214 offset:8192
    ds_read_b64_tr_b16 v[172:173], v216 offset:20480
    v_mfma_f32_32x32x16_bf16 v[40:55], v[152:155], v[112:115], v[40:55]
    ds_read_b64_tr_b16 v[174:175], v216 offset:21504
    ds_read_b128 v[140:143], v215 offset:0
    v_mfma_f32_32x32x16_bf16 v[8:23], v[156:159], v[116:119], v[8:23]
    ds_read_b128 v[144:147], v215 offset:4096
    ds_read_b128 v[148:151], v215 offset:8192
    v_mfma_f32_32x32x16_bf16 v[24:39], v[156:159], v[120:123], v[24:39]
    ds_read_b64_tr_b16 v[176:177], v216 offset:24576
    ds_read_b64_tr_b16 v[178:179], v216 offset:25600
    v_mfma_f32_32x32x16_bf16 v[40:55], v[156:159], v[124:127], v[40:55]
    ds_read_b64_tr_b16 v[180:181], v216 offset:28672
    ds_read_b64_tr_b16 v[182:183], v216 offset:29696
    v_mfma_f32_32x32x16_bf16 v[56:71], v[160:163], v[104:107], v[56:71]
    v_mfma_f32_32x32x16_bf16 v[72:87], v[160:163], v[108:111], v[72:87]
    v_mfma_f32_32x32x16_bf16 v[88:103], v[160:163], v[112:115], v[88:103]
    v_mfma_f32_32x32x16_bf16 v[56:71], v[164:167], v[116:119], v[56:71]
    v_mfma_f32_32x32x16_bf16 v[72:87], v[164:167], v[120:123], v[72:87]
    v_mfma_f32_32x32x16_bf16 v[88:103], v[164:167], v[124:127], v[88:103]
    s_waitcnt lgkmcnt(0)
    v_mfma_f32_32x32x16_bf16 v[8:23], v[168:171], v[128:131], v[8:23]
    v_mfma_f32_32x32x16_bf16 v[24:39], v[168:171], v[132:135], v[24:39]
    v_mfma_f32_32x32x16_bf16 v[40:55], v[168:171], v[136:139], v[40:55]
    v_mfma_f32_32x32x16_bf16 v[8:23], v[172:175], v[140:143], v[8:23]
    v_mfma_f32_32x32x16_bf16 v[24:39], v[172:175], v[144:147], v[24:39]
    v_mfma_f32_32x32x16_bf16 v[40:55], v[172:175], v[148:151], v[40:55]
    s_mov_b32 s77, 0x3e0293ee
    s_add_u32 s78, s14, 65536
    v_add_u32 v6, s78, v1
    v_add_u32 v7, s11, v1
    v_mfma_f32_32x32x16_bf16 v[56:71], v[176:179], v[128:131], v[56:71]
    s_nop 5
    v_mfma_f32_32x32x16_bf16 v[72:87], v[176:179], v[132:135], v[72:87]
    v_mul_f32 v8, s77, v8
    v_mul_f32 v9, s77, v9
    v_mul_f32 v10, s77, v10
    v_mul_f32 v11, s77, v11
    v_mul_f32 v12, s77, v12
    v_mul_f32 v13, s77, v13
    v_mul_f32 v14, s77, v14
    v_mul_f32 v15, s77, v15
    v_cvt_pk_bf16_f32 v184, v8, v9
    v_cvt_pk_bf16_f32 v185, v10, v11
    v_cvt_pk_bf16_f32 v186, v12, v13
    v_cvt_pk_bf16_f32 v187, v14, v15
    ds_write_b128 v6, v[184:187] offset:0
    v_mul_f32 v16, s77, v16
    v_mul_f32 v17, s77, v17
    v_mfma_f32_32x32x16_bf16 v[88:103], v[176:179], v[136:139], v[88:103]
    v_mul_f32 v18, s77, v18
    v_mul_f32 v19, s77, v19
    v_mul_f32 v20, s77, v20
    v_mul_f32 v21, s77, v21
    v_mul_f32 v22, s77, v22
    v_mul_f32 v23, s77, v23
    v_cvt_pk_bf16_f32 v188, v16, v17
    v_cvt_pk_bf16_f32 v189, v18, v19
    v_cvt_pk_bf16_f32 v190, v20, v21
    v_cvt_pk_bf16_f32 v191, v22, v23
    ds_write_b128 v6, v[188:191] offset:1024
    v_mul_f32 v24, s77, v24
    v_mul_f32 v25, s77, v25
    v_mul_f32 v26, s77, v26
    v_mul_f32 v27, s77, v27
    v_mul_f32 v28, s77, v28
    v_mfma_f32_32x32x16_bf16 v[56:71], v[180:183], v[140:143], v[56:71]
    v_mul_f32 v29, s77, v29
    v_mul_f32 v30, s77, v30
    v_mul_f32 v31, s77, v31
    v_cvt_pk_bf16_f32 v192, v24, v25
    v_cvt_pk_bf16_f32 v193, v26, v27
    v_cvt_pk_bf16_f32 v194, v28, v29
    v_cvt_pk_bf16_f32 v195, v30, v31
    ds_write_b128 v6, v[192:195] offset:8192
    v_mul_f32 v32, s77, v32
    v_mul_f32 v33, s77, v33
    v_mul_f32 v34, s77, v34
    v_mul_f32 v35, s77, v35
    v_mul_f32 v36, s77, v36
    v_mul_f32 v37, s77, v37
    v_mul_f32 v38, s77, v38
    v_mfma_f32_32x32x16_bf16 v[72:87], v[180:183], v[144:147], v[72:87]
    v_mul_f32 v39, s77, v39
    v_cvt_pk_bf16_f32 v196, v32, v33
    v_cvt_pk_bf16_f32 v197, v34, v35
    v_cvt_pk_bf16_f32 v198, v36, v37
    v_cvt_pk_bf16_f32 v199, v38, v39
    ds_write_b128 v6, v[196:199] offset:9216
    v_mul_f32 v40, s77, v40
    v_mul_f32 v41, s77, v41
    v_mul_f32 v42, s77, v42
    v_mul_f32 v43, s77, v43
    v_mul_f32 v44, s77, v44
    v_mul_f32 v45, s77, v45
    v_mul_f32 v46, s77, v46
    v_mul_f32 v47, s77, v47
    v_cvt_pk_bf16_f32 v200, v40, v41
    v_cvt_pk_bf16_f32 v201, v42, v43
    v_mfma_f32_32x32x16_bf16 v[88:103], v[180:183], v[148:151], v[88:103]
    v_cvt_pk_bf16_f32 v202, v44, v45
    v_cvt_pk_bf16_f32 v203, v46, v47
    ds_write_b128 v7, v[200:203] offset:16384
    v_mul_f32 v48, s77, v48
    v_mul_f32 v49, s77, v49
    v_mul_f32 v50, s77, v50
    v_mul_f32 v51, s77, v51
    v_mul_f32 v52, s77, v52
    v_mul_f32 v53, s77, v53
    v_mul_f32 v54, s77, v54
    v_mul_f32 v55, s77, v55
    v_cvt_pk_bf16_f32 v204, v48, v49
    v_cvt_pk_bf16_f32 v205, v50, v51
    v_cvt_pk_bf16_f32 v206, v52, v53
    v_cvt_pk_bf16_f32 v207, v54, v55
    ds_write_b128 v7, v[204:207] offset:17408
    s_waitcnt vmcnt(0) lgkmcnt(0)
    s_barrier
    s_barrier
    v_mul_f32 v56, s77, v56
    v_mul_f32 v57, s77, v57
    v_mul_f32 v58, s77, v58
    v_mul_f32 v59, s77, v59
    v_mul_f32 v60, s77, v60
    v_mul_f32 v61, s77, v61
    v_mul_f32 v62, s77, v62
    v_mul_f32 v63, s77, v63
    v_cvt_pk_bf16_f32 v184, v56, v57
    v_cvt_pk_bf16_f32 v185, v58, v59
    v_cvt_pk_bf16_f32 v186, v60, v61
    v_cvt_pk_bf16_f32 v187, v62, v63
    ds_write_b128 v6, v[184:187] offset:0
    v_mul_f32 v64, s77, v64
    v_mul_f32 v65, s77, v65
    v_mul_f32 v66, s77, v66
    v_mul_f32 v67, s77, v67
    v_mul_f32 v68, s77, v68
    v_mul_f32 v69, s77, v69
    v_mul_f32 v70, s77, v70
    v_mul_f32 v71, s77, v71
    v_cvt_pk_bf16_f32 v188, v64, v65
    v_cvt_pk_bf16_f32 v189, v66, v67
    v_cvt_pk_bf16_f32 v190, v68, v69
    v_cvt_pk_bf16_f32 v191, v70, v71
    ds_write_b128 v6, v[188:191] offset:1024
    v_mul_f32 v72, s77, v72
    v_mul_f32 v73, s77, v73
    v_mul_f32 v74, s77, v74
    v_mul_f32 v75, s77, v75
    v_mul_f32 v76, s77, v76
    v_mul_f32 v77, s77, v77
    v_mul_f32 v78, s77, v78
    v_mul_f32 v79, s77, v79
    v_cvt_pk_bf16_f32 v192, v72, v73
    v_cvt_pk_bf16_f32 v193, v74, v75
    v_cvt_pk_bf16_f32 v194, v76, v77
    v_cvt_pk_bf16_f32 v195, v78, v79
    ds_write_b128 v6, v[192:195] offset:8192
    v_mul_f32 v80, s77, v80
    v_mul_f32 v81, s77, v81
    v_mul_f32 v82, s77, v82
    v_mul_f32 v83, s77, v83
    v_mul_f32 v84, s77, v84
    v_mul_f32 v85, s77, v85
    v_mul_f32 v86, s77, v86
    v_mul_f32 v87, s77, v87
    v_cvt_pk_bf16_f32 v196, v80, v81
    v_cvt_pk_bf16_f32 v197, v82, v83
    v_cvt_pk_bf16_f32 v198, v84, v85
    v_cvt_pk_bf16_f32 v199, v86, v87
    ds_write_b128 v6, v[196:199] offset:9216
    v_mul_f32 v88, s77, v88
    v_mul_f32 v89, s77, v89
    v_mul_f32 v90, s77, v90
    v_mul_f32 v91, s77, v91
    v_mul_f32 v92, s77, v92
    v_mul_f32 v93, s77, v93
    v_mul_f32 v94, s77, v94
    v_mul_f32 v95, s77, v95
    v_cvt_pk_bf16_f32 v200, v88, v89
    v_cvt_pk_bf16_f32 v201, v90, v91
    v_cvt_pk_bf16_f32 v202, v92, v93
    v_cvt_pk_bf16_f32 v203, v94, v95
    ds_write_b128 v7, v[200:203] offset:16384
    v_mul_f32 v96, s77, v96
    v_mul_f32 v97, s77, v97
    v_mul_f32 v98, s77, v98
    v_mul_f32 v99, s77, v99
    v_mul_f32 v100, s77, v100
    v_mul_f32 v101, s77, v101
    v_mul_f32 v102, s77, v102
    v_mul_f32 v103, s77, v103
    v_cvt_pk_bf16_f32 v204, v96, v97
    v_cvt_pk_bf16_f32 v205, v98, v99
    v_cvt_pk_bf16_f32 v206, v100, v101
    v_cvt_pk_bf16_f32 v207, v102, v103
    ds_write_b128 v7, v[204:207] offset:17408
    s_waitcnt lgkmcnt(0)
L_go:
    s_cmp_ge_u32 s10, 30
    s_cbranch_scc1 L_end
    v_lshrrev_b32 v6, 3, v0
    v_lshrrev_b32 v7, 2, v0
    v_and_b32 v7, 4, v7
    v_and_b32 v2, 7, v0
    v_xor_b32 v7, v7, v2
    v_mul_u32_u24 v2, 1280, v6
    v_lshl_add_u32 v2, v7, 4, v2
    v_lshrrev_b32 v6, 2, v0
    v_and_b32 v6, 3, v6
    v_lshrrev_b32 v3, 4, v0
    v_and_b32 v3, 1, v3
    v_lshlrev_b32 v3, 5, v3
    v_and_b32 v7, 1, v0
    v_lshl_add_u32 v3, v7, 4, v3
    v_and_b32 v7, 2, v0
    v_lshl_add_u32 v3, v7, 2, v3
    v_lshl_add_u32 v3, v6, 7, v3
    v_lshrrev_b32 v6, 1, v6
    v_lshl_add_u32 v3, v6, 6, v3
    v_lshrrev_b32 v7, 5, v0
    v_lshl_add_u32 v3, v7, 10, v3
    v_add_u32 v3, s11, v3
    v_xor_b32 v4, 64, v3
    s_mul_i32 s85, s12, 1310720
    s_add_u32 s85, s85, s88
    s_lshl_b32 s84, s12, 16
    s_add_u32 s84, s84, s89
    s_lshl_b32 s91, s12, 3
    s_mul_i32 s24, s8, 0
    s_mul_i32 s77, s9, 1
    s_add_u32 s24, s24, s77
    s_add_u32 s77, s24, 0
    s_and_b32 s77, s77, 3
    s_lshl_b32 s16, s77, 13
    s_add_u32 s16, s16, s84
    s_mul_i32 s20, s77, 163840
    s_add_u32 s20, s20, s85
    s_add_u32 s77, s24, 1
    s_and_b32 s77, s77, 3
    s_lshl_b32 s17, s77, 13
    s_add_u32 s17, s17, s84
    s_mul_i32 s21, s77, 163840
    s_add_u32 s21, s21, s85
    s_add_u32 s77, s24, 2
    s_and_b32 s77, s77, 3
    s_lshl_b32 s18, s77, 13
    s_add_u32 s18, s18, s84
    s_mul_i32 s22, s77, 163840
    s_add_u32 s22, s22, s85
    s_add_u32 s77, s24, 3
    s_and_b32 s77, s77, 3
    s_lshl_b32 s19, s77, 13
    s_add_u32 s19, s19, s84
    s_mul_i32 s23, s77, 163840
    s_add_u32 s23, s23, s85
    s_lshr_b32 s77, s89, 6
    s_lshl_b32 s78, s91, 7
    s_add_u32 s77, s77, s78
    s_add_u32 s77, s77, 12582912
    v_and_b32 v5, 1, v0
    v_lshlrev_b32 v5, 12, v5
    v_lshrrev_b32 v6, 1, v0
    v_add_u32 v6, s24, v6
    v_and_b32 v6, 3, v6
    v_lshl_add_u32 v5, v6, 7, v5
    v_add_u32 v5, s77, v5
    s_mul_i32 s77, s9, 3
    s_add_u32 s77, s77, s4
    s_and_b32 s77, s77, 7
    s_and_b32 s86, s77, 6
    s_add_u32 s86, s86, s77
    s_lshl_b32 s86, s86, 1
    s_add_u32 s86, s86, 4
    s_mul_i32 s86, s86, 163840
    s_add_u32 s86, s86, s88
    s_barrier
    s_waitcnt lgkmcnt(0)
    s_barrier
    s_waitcnt lgkmcnt(0)
    s_add_u32 m0, s11, 0
    s_add_u32 s77, s20, 0
    buffer_load_dwordx4 v2, s[60:63], s77 offen offset:0 lds
    s_add_u32 s77, s20, 9216
    buffer_load_dwordx4 v2, s[60:63], s77 offen offset:1024 lds
    s_add_u32 s77, s20, 18432
    buffer_load_dwordx4 v2, s[60:63], s77 offen offset:2048 lds
    s_add_u32 s77, s20, 27648
    buffer_load_dwordx4 v2, s[60:63], s77 offen offset:3072 lds
    s_barrier
    s_waitcnt lgkmcnt(0)
    s_barrier
    s_waitcnt lgkmcnt(0)
    s_barrier
    s_waitcnt lgkmcnt(0)
    s_barrier
    s_waitcnt vmcnt(0)
    ds_read_b64_tr_b16 v[152:153], v3 offset:0
    ds_read_b64_tr_b16 v[154:155], v3 offset:512
    ds_read_b64_tr_b16 v[156:157], v4 offset:0
    ds_read_b64_tr_b16 v[158:159], v4 offset:512
    ds_read_b64_tr_b16 v[160:161], v3 offset:2048
    ds_read_b64_tr_b16 v[162:163], v3 offset:2560
    ds_read_b64_tr_b16 v[164:165], v4 offset:2048
    ds_read_b64_tr_b16 v[166:167], v4 offset:2560
    s_waitcnt lgkmcnt(0)
    s_add_u32 m0, s11, 4096
    s_add_u32 s77, s20, 40960
    buffer_load_dwordx4 v2, s[60:63], s77 offen offset:0 lds
    s_add_u32 s77, s20, 50176
    buffer_load_dwordx4 v2, s[60:63], s77 offen offset:1024 lds
    s_add_u32 s77, s20, 59392
    buffer_load_dwordx4 v2, s[60:63], s77 offen offset:2048 lds
    s_add_u32 s77, s20, 68608
    buffer_load_dwordx4 v2, s[60:63], s77 offen offset:3072 lds
    s_barrier
    s_waitcnt lgkmcnt(0)
    s_barrier
    s_waitcnt lgkmcnt(0)
    s_barrier
    s_waitcnt lgkmcnt(0)
    s_barrier
    s_waitcnt vmcnt(0)
    ds_read_b64_tr_b16 v[168:169], v3 offset:4096
    ds_read_b64_tr_b16 v[170:171], v3 offset:4608
    ds_read_b64_tr_b16 v[172:173], v4 offset:4096
    ds_read_b64_tr_b16 v[174:175], v4 offset:4608
    ds_read_b64_tr_b16 v[176:177], v3 offset:6144
    ds_read_b64_tr_b16 v[178:179], v3 offset:6656
    ds_read_b64_tr_b16 v[180:181], v4 offset:6144
    ds_read_b64_tr_b16 v[182:183], v4 offset:6656
    s_waitcnt lgkmcnt(0)
    s_add_u32 m0, s11, 8192
    s_add_u32 s77, s20, 81920
    buffer_load_dwordx4 v2, s[60:63], s77 offen offset:0 lds
    s_add_u32 s77, s20, 91136
    buffer_load_dwordx4 v2, s[60:63], s77 offen offset:1024 lds
    s_add_u32 s77, s20, 100352
    buffer_load_dwordx4 v2, s[60:63], s77 offen offset:2048 lds
    s_add_u32 s77, s20, 109568
    buffer_load_dwordx4 v2, s[60:63], s77 offen offset:3072 lds
    s_barrier
    s_waitcnt lgkmcnt(0)
    s_barrier
    s_waitcnt lgkmcnt(0)
    s_barrier
    s_waitcnt lgkmcnt(0)
    s_barrier
    s_waitcnt vmcnt(0)
    ds_read_b64_tr_b16 v[72:73], v3 offset:8192
    ds_read_b64_tr_b16 v[74:75], v3 offset:8704
    ds_read_b64_tr_b16 v[76:77], v4 offset:8192
    ds_read_b64_tr_b16 v[78:79], v4 offset:8704
    ds_read_b64_tr_b16 v[80:81], v3 offset:10240
    ds_read_b64_tr_b16 v[82:83], v3 offset:10752
    ds_read_b64_tr_b16 v[84:85], v4 offset:10240
    ds_read_b64_tr_b16 v[86:87], v4 offset:10752
    s_waitcnt lgkmcnt(0)
    s_add_u32 m0, s11, 12288
    s_add_u32 s77, s20, 122880
    buffer_load_dwordx4 v2, s[60:63], s77 offen offset:0 lds
    s_add_u32 s77, s20, 132096
    buffer_load_dwordx4 v2, s[60:63], s77 offen offset:1024 lds
    s_add_u32 s77, s20, 141312
    buffer_load_dwordx4 v2, s[60:63], s77 offen offset:2048 lds
    s_add_u32 s77, s20, 150528
    buffer_load_dwordx4 v2, s[60:63], s77 offen offset:3072 lds
    s_barrier
    s_waitcnt lgkmcnt(0)
    s_barrier
    s_waitcnt lgkmcnt(0)
    s_barrier
    s_waitcnt lgkmcnt(0)
    s_barrier
    s_waitcnt vmcnt(0)
    ds_read_b64_tr_b16 v[88:89], v3 offset:12288
    ds_read_b64_tr_b16 v[90:91], v3 offset:12800
    ds_read_b64_tr_b16 v[92:93], v4 offset:12288
    ds_read_b64_tr_b16 v[94:95], v4 offset:12800
    ds_read_b64_tr_b16 v[96:97], v3 offset:14336
    ds_read_b64_tr_b16 v[98:99], v3 offset:14848
    ds_read_b64_tr_b16 v[100:101], v4 offset:14336
    ds_read_b64_tr_b16 v[102:103], v4 offset:14848
    s_waitcnt lgkmcnt(0)
    s_add_u32 m0, s11, 0
    s_add_u32 s77, s21, 0
    buffer_load_dwordx4 v2, s[60:63], s77 offen offset:0 lds
    s_add_u32 s77, s21, 9216
    buffer_load_dwordx4 v2, s[60:63], s77 offen offset:1024 lds
    s_add_u32 s77, s21, 18432
    buffer_load_dwordx4 v2, s[60:63], s77 offen offset:2048 lds
    s_add_u32 s77, s21, 27648
    buffer_load_dwordx4 v2, s[60:63], s77 offen offset:3072 lds
    s_barrier
    s_waitcnt lgkmcnt(0)
    s_barrier
    s_waitcnt lgkmcnt(0)
    s_barrier
    s_waitcnt lgkmcnt(0)
    s_barrier
    s_waitcnt vmcnt(0)
    ds_read_b64_tr_b16 v[104:105], v3 offset:0
    ds_read_b64_tr_b16 v[106:107], v3 offset:512
    ds_read_b64_tr_b16 v[108:109], v4 offset:0
    ds_read_b64_tr_b16 v[110:111], v4 offset:512
    ds_read_b64_tr_b16 v[112:113], v3 offset:2048
    ds_read_b64_tr_b16 v[114:115], v3 offset:2560
    ds_read_b64_tr_b16 v[116:117], v4 offset:2048
    ds_read_b64_tr_b16 v[118:119], v4 offset:2560
    s_waitcnt lgkmcnt(0)
    s_add_u32 m0, s11, 4096
    s_add_u32 s77, s21, 40960
    buffer_load_dwordx4 v2, s[60:63], s77 offen offset:0 lds
    s_add_u32 s77, s21, 50176
    buffer_load_dwordx4 v2, s[60:63], s77 offen offset:1024 lds
    s_add_u32 s77, s21, 59392
    buffer_load_dwordx4 v2, s[60:63], s77 offen offset:2048 lds
    s_add_u32 s77, s21, 68608
    buffer_load_dwordx4 v2, s[60:63], s77 offen offset:3072 lds
    s_barrier
    s_waitcnt lgkmcnt(0)
    s_barrier
    s_waitcnt lgkmcnt(0)
    s_barrier
    s_waitcnt lgkmcnt(0)
    s_barrier
    s_waitcnt vmcnt(0)
    ds_read_b64_tr_b16 v[120:121], v3 offset:4096
    ds_read_b64_tr_b16 v[122:123], v3 offset:4608
    ds_read_b64_tr_b16 v[124:125], v4 offset:4096
    ds_read_b64_tr_b16 v[126:127], v4 offset:4608
    ds_read_b64_tr_b16 v[128:129], v3 offset:6144
    ds_read_b64_tr_b16 v[130:131], v3 offset:6656
    ds_read_b64_tr_b16 v[132:133], v4 offset:6144
    ds_read_b64_tr_b16 v[134:135], v4 offset:6656
    s_waitcnt lgkmcnt(0)
    s_add_u32 m0, s11, 8192
    s_add_u32 s77, s21, 81920
    buffer_load_dwordx4 v2, s[60:63], s77 offen offset:0 lds
    s_add_u32 s77, s21, 91136
    buffer_load_dwordx4 v2, s[60:63], s77 offen offset:1024 lds
    s_add_u32 s77, s21, 100352
    buffer_load_dwordx4 v2, s[60:63], s77 offen offset:2048 lds
    s_add_u32 s77, s21, 109568
    buffer_load_dwordx4 v2, s[60:63], s77 offen offset:3072 lds
    s_barrier
    s_waitcnt lgkmcnt(0)
    s_barrier
    s_waitcnt lgkmcnt(0)
    s_barrier
    s_waitcnt lgkmcnt(0)
    s_barrier
    v_mov_b32 v7, 161792
    ds_read_b32 v7, v7
    s_waitcnt vmcnt(0)
    ds_read_b64_tr_b16 v[136:137], v3 offset:8192
    ds_read_b64_tr_b16 v[138:139], v3 offset:8704
    ds_read_b64_tr_b16 v[140:141], v4 offset:8192
    ds_read_b64_tr_b16 v[142:143], v4 offset:8704
    ds_read_b64_tr_b16 v[144:145], v3 offset:10240
    ds_read_b64_tr_b16 v[146:147], v3 offset:10752
    ds_read_b64_tr_b16 v[148:149], v4 offset:10240
    ds_read_b64_tr_b16 v[150:151], v4 offset:10752
    s_waitcnt lgkmcnt(0)
    s_barrier
    v_readfirstlane_b32 s76, v7
    s_waitcnt lgkmcnt(0)
    s_barrier
    s_waitcnt lgkmcnt(0)
    s_barrier
    s_waitcnt lgkmcnt(0)
    s_add_u32 m0, s11, 12288
    s_add_u32 s77, s21, 122880
    buffer_load_dwordx4 v2, s[60:63], s77 offen offset:0 lds
    s_add_u32 s77, s21, 132096
    buffer_load_dwordx4 v2, s[60:63], s77 offen offset:1024 lds
    s_add_u32 s77, s21, 141312
    buffer_load_dwordx4 v2, s[60:63], s77 offen offset:2048 lds
    s_add_u32 s77, s21, 150528
    buffer_load_dwordx4 v2, s[60:63], s77 offen offset:3072 lds
    s_add_u32 m0, s11, 0
    s_add_u32 s77, s22, 0
    buffer_load_dwordx4 v2, s[60:63], s77 offen offset:0 lds
    s_add_u32 s77, s22, 9216
    buffer_load_dwordx4 v2, s[60:63], s77 offen offset:1024 lds
    s_add_u32 s77, s22, 18432
    buffer_load_dwordx4 v2, s[60:63], s77 offen offset:2048 lds
    s_add_u32 s77, s22, 27648
    buffer_load_dwordx4 v2, s[60:63], s77 offen offset:3072 lds
    s_barrier
    s_waitcnt lgkmcnt(0)
    s_add_u32 m0, s11, 4096
    s_add_u32 s77, s22, 40960
    buffer_load_dwordx4 v2, s[60:63], s77 offen offset:0 lds
    s_add_u32 s77, s22, 50176
    buffer_load_dwordx4 v2, s[60:63], s77 offen offset:1024 lds
    s_add_u32 s77, s22, 59392
    buffer_load_dwordx4 v2, s[60:63], s77 offen offset:2048 lds
    s_add_u32 s77, s22, 68608
    buffer_load_dwordx4 v2, s[60:63], s77 offen offset:3072 lds
    s_add_u32 m0, s11, 8192
    s_add_u32 s77, s22, 81920
    buffer_load_dwordx4 v2, s[60:63], s77 offen offset:0 lds
    s_add_u32 s77, s22, 91136
    buffer_load_dwordx4 v2, s[60:63], s77 offen offset:1024 lds
    s_add_u32 s77, s22, 100352
    buffer_load_dwordx4 v2, s[60:63], s77 offen offset:2048 lds
    s_add_u32 s77, s22, 109568
    buffer_load_dwordx4 v2, s[60:63], s77 offen offset:3072 lds
    buffer_load_dword v6, v5, s[64:67], 0 offen sc1
    s_barrier
    s_waitcnt lgkmcnt(0)
    s_add_u32 m0, s11, 16384
    s_add_u32 s77, s86, 163840
    buffer_load_dwordx4 v2, s[60:63], s77 offen offset:0 lds
    s_add_u32 s77, s86, 173056
    buffer_load_dwordx4 v2, s[60:63], s77 offen offset:1024 lds
    s_add_u32 s77, s86, 182272
    buffer_load_dwordx4 v2, s[60:63], s77 offen offset:2048 lds
    s_add_u32 s77, s86, 191488
    buffer_load_dwordx4 v2, s[60:63], s77 offen offset:3072 lds
    s_barrier
    s_waitcnt lgkmcnt(0)
    s_waitcnt vmcnt(4)
    s_mov_b32 s90, 200000
L_poll1:
    v_cmp_ne_u32 vcc, s76, v6
    s_sub_u32 s90, s90, 1
    s_cbranch_scc1 L_pd1
    s_and_b32 s77, vcc_lo, 3
    s_cbranch_scc0 L_pd1
    buffer_load_dword v6, v5, s[64:67], 0 offen sc1
    s_waitcnt vmcnt(0)
    s_branch L_poll1
L_pd1:
    s_add_u32 s77, s16, 0
    buffer_load_dwordx4 v[184:187], v1, s[64:67], s77 offen offset:0 sc1
    buffer_load_dwordx4 v[188:191], v1, s[64:67], s77 offen offset:1024 sc1
    s_add_u32 s77, s16, 262144
    buffer_load_dwordx4 v[192:195], v1, s[64:67], s77 offen offset:0 sc1
    buffer_load_dwordx4 v[196:199], v1, s[64:67], s77 offen offset:1024 sc1
    s_add_u32 s77, s16, 2048
    buffer_load_dwordx4 v[200:203], v1, s[64:67], s77 offen offset:0 sc1
    buffer_load_dwordx4 v[204:207], v1, s[64:67], s77 offen offset:1024 sc1
    s_add_u32 s77, s16, 264192
    buffer_load_dwordx4 v[208:211], v1, s[64:67], s77 offen offset:0 sc1
    buffer_load_dwordx4 v[212:215], v1, s[64:67], s77 offen offset:1024 sc1
    s_add_u32 s77, s16, 4096
    buffer_load_dwordx4 v[216:219], v1, s[64:67], s77 offen offset:0 sc1
    buffer_load_dwordx4 v[220:223], v1, s[64:67], s77 offen offset:1024 sc1
    s_add_u32 s77, s16, 266240
    buffer_load_dwordx4 v[224:227], v1, s[64:67], s77 offen offset:0 sc1
    buffer_load_dwordx4 v[228:231], v1, s[64:67], s77 offen offset:1024 sc1
    s_add_u32 s77, s16, 6144
    buffer_load_dwordx4 v[232:235], v1, s[64:67], s77 offen offset:0 sc1
    buffer_load_dwordx4 v[236:239], v1, s[64:67], s77 offen offset:1024 sc1
    s_add_u32 s77, s16, 268288
    buffer_load_dwordx4 v[240:243], v1, s[64:67], s77 offen offset:0 sc1
    buffer_load_dwordx4 v[244:247], v1, s[64:67], s77 offen offset:1024 sc1
    buffer_load_dword v6, v5, s[64:67], 0 offen sc1
    s_barrier
    s_waitcnt lgkmcnt(0)
    s_barrier
    s_waitcnt lgkmcnt(0)
    s_barrier
    s_waitcnt lgkmcnt(0)
    s_barrier
    s_waitcnt vmcnt(13)
    v_mfma_f32_32x32x16_bf16 v[8:23], v[152:155], v[184:187], 0
    v_mfma_f32_32x32x16_bf16 v[24:39], v[156:159], v[184:187], 0
    v_mfma_f32_32x32x16_bf16 v[40:55], v[152:155], v[192:195], 0
    v_mfma_f32_32x32x16_bf16 v[56:71], v[156:159], v[192:195], 0
    v_mfma_f32_32x32x16_bf16 v[8:23], v[160:163], v[188:191], v[8:23]
    v_mfma_f32_32x32x16_bf16 v[24:39], v[164:167], v[188:191], v[24:39]
    v_mfma_f32_32x32x16_bf16 v[40:55], v[160:163], v[196:199], v[40:55]
    v_mfma_f32_32x32x16_bf16 v[56:71], v[164:167], v[196:199], v[56:71]
    ds_read_b64_tr_b16 v[152:153], v3 offset:12288
    ds_read_b64_tr_b16 v[154:155], v3 offset:12800
    ds_read_b64_tr_b16 v[156:157], v4 offset:12288
    ds_read_b64_tr_b16 v[158:159], v4 offset:12800
    ds_read_b64_tr_b16 v[160:161], v3 offset:14336
    ds_read_b64_tr_b16 v[162:163], v3 offset:14848
    ds_read_b64_tr_b16 v[164:165], v4 offset:14336
    ds_read_b64_tr_b16 v[166:167], v4 offset:14848
    s_waitcnt lgkmcnt(0)
    s_barrier
    s_waitcnt vmcnt(9)
    v_mfma_f32_32x32x16_bf16 v[8:23], v[168:171], v[200:203], v[8:23]
    v_mfma_f32_32x32x16_bf16 v[24:39], v[172:175], v[200:203], v[24:39]
    v_mfma_f32_32x32x16_bf16 v[40:55], v[168:171], v[208:211], v[40:55]
    v_mfma_f32_32x32x16_bf16 v[56:71], v[172:175], v[208:211], v[56:71]
    v_mfma_f32_32x32x16_bf16 v[8:23], v[176:179], v[204:207], v[8:23]
    v_mfma_f32_32x32x16_bf16 v[24:39], v[180:183], v[204:207], v[24:39]
    v_mfma_f32_32x32x16_bf16 v[40:55], v[176:179], v[212:215], v[40:55]
    v_mfma_f32_32x32x16_bf16 v[56:71], v[180:183], v[212:215], v[56:71]
    ds_read_b64_tr_b16 v[168:169], v3 offset:0
    ds_read_b64_tr_b16 v[170:171], v3 offset:512
    ds_read_b64_tr_b16 v[172:173], v4 offset:0
    ds_read_b64_tr_b16 v[174:175], v4 offset:512
    ds_read_b64_tr_b16 v[176:177], v3 offset:2048
    ds_read_b64_tr_b16 v[178:179], v3 offset:2560
    ds_read_b64_tr_b16 v[180:181], v4 offset:2048
    ds_read_b64_tr_b16 v[182:183], v4 offset:2560
    s_waitcnt lgkmcnt(0)
    s_barrier
    s_waitcnt vmcnt(5)
    v_mfma_f32_32x32x16_bf16 v[8:23], v[72:75], v[216:219], v[8:23]
    v_mfma_f32_32x32x16_bf16 v[24:39], v[76:79], v[216:219], v[24:39]
    v_mfma_f32_32x32x16_bf16 v[40:55], v[72:75], v[224:227], v[40:55]
    v_mfma_f32_32x32x16_bf16 v[56:71], v[76:79], v[224:227], v[56:71]
    v_mfma_f32_32x32x16_bf16 v[8:23], v[80:83], v[220:223], v[8:23]
    v_mfma_f32_32x32x16_bf16 v[24:39], v[84:87], v[220:223], v[24:39]
    v_mfma_f32_32x32x16_bf16 v[40:55], v[80:83], v[228:231], v[40:55]
    v_mfma_f32_32x32x16_bf16 v[56:71], v[84:87], v[228:231], v[56:71]
    ds_read_b64_tr_b16 v[72:73], v3 offset:4096
    ds_read_b64_tr_b16 v[74:75], v3 offset:4608
    ds_read_b64_tr_b16 v[76:77], v4 offset:4096
    ds_read_b64_tr_b16 v[78:79], v4 offset:4608
    ds_read_b64_tr_b16 v[80:81], v3 offset:6144
    ds_read_b64_tr_b16 v[82:83], v3 offset:6656
    ds_read_b64_tr_b16 v[84:85], v4 offset:6144
    ds_read_b64_tr_b16 v[86:87], v4 offset:6656
    s_waitcnt lgkmcnt(0)
    s_barrier
    s_waitcnt vmcnt(1)
    v_mfma_f32_32x32x16_bf16 v[8:23], v[88:91], v[232:235], v[8:23]
    v_mfma_f32_32x32x16_bf16 v[24:39], v[92:95], v[232:235], v[24:39]
    v_mfma_f32_32x32x16_bf16 v[40:55], v[88:91], v[240:243], v[40:55]
    v_mfma_f32_32x32x16_bf16 v[56:71], v[92:95], v[240:243], v[56:71]
    v_mfma_f32_32x32x16_bf16 v[8:23], v[96:99], v[236:239], v[8:23]
    v_mfma_f32_32x32x16_bf16 v[24:39], v[100:103], v[236:239], v[24:39]
    v_mfma_f32_32x32x16_bf16 v[40:55], v[96:99], v[244:247], v[40:55]
    v_mfma_f32_32x32x16_bf16 v[56:71], v[100:103], v[244:247], v[56:71]
    ds_read_b64_tr_b16 v[88:89], v3 offset:8192
    ds_read_b64_tr_b16 v[90:91], v3 offset:8704
    ds_read_b64_tr_b16 v[92:93], v4 offset:8192
    ds_read_b64_tr_b16 v[94:95], v4 offset:8704
    ds_read_b64_tr_b16 v[96:97], v3 offset:10240
    ds_read_b64_tr_b16 v[98:99], v3 offset:10752
    ds_read_b64_tr_b16 v[100:101], v4 offset:10240
    ds_read_b64_tr_b16 v[102:103], v4 offset:10752
    s_waitcnt lgkmcnt(0)
    s_waitcnt vmcnt(0)
    s_mov_b32 s90, 200000
L_poll2:
    v_cmp_ne_u32 vcc, s76, v6
    s_sub_u32 s90, s90, 1
    s_cbranch_scc1 L_pd2
    s_and_b32 s77, vcc_lo, 12
    s_cbranch_scc0 L_pd2
    buffer_load_dword v6, v5, s[64:67], 0 offen sc1
    s_waitcnt vmcnt(0)
    s_branch L_poll2
L_pd2:
    s_add_u32 s77, s17, 0
    buffer_load_dwordx4 v[184:187], v1, s[64:67], s77 offen offset:0 sc1
    buffer_load_dwordx4 v[188:191], v1, s[64:67], s77 offen offset:1024 sc1
    s_add_u32 s77, s17, 262144
    buffer_load_dwordx4 v[192:195], v1, s[64:67], s77 offen offset:0 sc1
    buffer_load_dwordx4 v[196:199], v1, s[64:67], s77 offen offset:1024 sc1
    s_add_u32 s77, s17, 2048
    buffer_load_dwordx4 v[200:203], v1, s[64:67], s77 offen offset:0 sc1
    buffer_load_dwordx4 v[204:207], v1, s[64:67], s77 offen offset:1024 sc1
    s_add_u32 s77, s17, 264192
    buffer_load_dwordx4 v[208:211], v1, s[64:67], s77 offen offset:0 sc1
    buffer_load_dwordx4 v[212:215], v1, s[64:67], s77 offen offset:1024 sc1
    s_add_u32 s77, s17, 4096
    buffer_load_dwordx4 v[216:219], v1, s[64:67], s77 offen offset:0 sc1
    buffer_load_dwordx4 v[220:223], v1, s[64:67], s77 offen offset:1024 sc1
    s_add_u32 s77, s17, 266240
    buffer_load_dwordx4 v[224:227], v1, s[64:67], s77 offen offset:0 sc1
    buffer_load_dwordx4 v[228:231], v1, s[64:67], s77 offen offset:1024 sc1
    s_add_u32 s77, s17, 6144
    buffer_load_dwordx4 v[232:235], v1, s[64:67], s77 offen offset:0 sc1
    buffer_load_dwordx4 v[236:239], v1, s[64:67], s77 offen offset:1024 sc1
    s_add_u32 s77, s17, 268288
    buffer_load_dwordx4 v[240:243], v1, s[64:67], s77 offen offset:0 sc1
    buffer_load_dwordx4 v[244:247], v1, s[64:67], s77 offen offset:1024 sc1
    buffer_load_dword v6, v5, s[64:67], 0 offen sc1
    s_barrier
    s_waitcnt lgkmcnt(0)
    s_barrier
    s_waitcnt lgkmcnt(0)
    s_barrier
    s_waitcnt lgkmcnt(0)
    s_barrier
    s_waitcnt vmcnt(13)
    v_mfma_f32_32x32x16_bf16 v[8:23], v[104:107], v[184:187], v[8:23]
    v_mfma_f32_32x32x16_bf16 v[24:39], v[108:111], v[184:187], v[24:39]
    v_mfma_f32_32x32x16_bf16 v[40:55], v[104:107], v[192:195], v[40:55]
    v_mfma_f32_32x32x16_bf16 v[56:71], v[108:111], v[192:195], v[56:71]
    v_mfma_f32_32x32x16_bf16 v[8:23], v[112:115], v[188:191], v[8:23]
    v_mfma_f32_32x32x16_bf16 v[24:39], v[116:119], v[188:191], v[24:39]
    v_mfma_f32_32x32x16_bf16 v[40:55], v[112:115], v[196:199], v[40:55]
    v_mfma_f32_32x32x16_bf16 v[56:71], v[116:119], v[196:199], v[56:71]
    s_waitcnt lgkmcnt(0)
    s_waitcnt vmcnt(0)
    s_mov_b32 s90, 200000
L_poll3:
    v_cmp_ne_u32 vcc, s76, v6
    s_sub_u32 s90, s90, 1
    s_cbranch_scc1 L_pd3
    s_and_b32 s77, vcc_lo, 48
    s_cbranch_scc0 L_pd3
    buffer_load_dword v6, v5, s[64:67], 0 offen sc1
    s_waitcnt vmcnt(0)
    s_branch L_poll3
L_pd3:
    s_add_u32 s77, s18, 0
    buffer_load_dwordx4 v[184:187], v1, s[64:67], s77 offen offset:0 sc1
    buffer_load_dwordx4 v[188:191], v1, s[64:67], s77 offen offset:1024 sc1
    s_add_u32 s77, s18, 262144
    buffer_load_dwordx4 v[192:195], v1, s[64:67], s77 offen offset:0 sc1
    buffer_load_dwordx4 v[196:199], v1, s[64:67], s77 offen offset:1024 sc1
    s_add_u32 m0, s11, 12288
    s_add_u32 s77, s22, 122880
    buffer_load_dwordx4 v2, s[60:63], s77 offen offset:0 lds
    s_add_u32 s77, s22, 132096
    buffer_load_dwordx4 v2, s[60:63], s77 offen offset:1024 lds
    s_add_u32 s77, s22, 141312
    buffer_load_dwordx4 v2, s[60:63], s77 offen offset:2048 lds
    s_add_u32 s77, s22, 150528
    buffer_load_dwordx4 v2, s[60:63], s77 offen offset:3072 lds
    s_barrier
    v_mfma_f32_32x32x16_bf16 v[8:23], v[120:123], v[200:203], v[8:23]
    v_mfma_f32_32x32x16_bf16 v[24:39], v[124:127], v[200:203], v[24:39]
    v_mfma_f32_32x32x16_bf16 v[40:55], v[120:123], v[208:211], v[40:55]
    v_mfma_f32_32x32x16_bf16 v[56:71], v[124:127], v[208:211], v[56:71]
    v_mfma_f32_32x32x16_bf16 v[8:23], v[128:131], v[204:207], v[8:23]
    v_mfma_f32_32x32x16_bf16 v[24:39], v[132:135], v[204:207], v[24:39]
    v_mfma_f32_32x32x16_bf16 v[40:55], v[128:131], v[212:215], v[40:55]
    v_mfma_f32_32x32x16_bf16 v[56:71], v[132:135], v[212:215], v[56:71]
    s_waitcnt lgkmcnt(0)
    s_add_u32 s77, s18, 2048
    buffer_load_dwordx4 v[200:203], v1, s[64:67], s77 offen offset:0 sc1
    buffer_load_dwordx4 v[204:207], v1, s[64:67], s77 offen offset:1024 sc1
    s_add_u32 s77, s18, 264192
    buffer_load_dwordx4 v[208:211], v1, s[64:67], s77 offen offset:0 sc1
    buffer_load_dwordx4 v[212:215], v1, s[64:67], s77 offen offset:1024 sc1
    s_add_u32 m0, s11, 0
    s_add_u32 s77, s23, 0
    buffer_load_dwordx4 v2, s[60:63], s77 offen offset:0 lds
    s_add_u32 s77, s23, 9216
    buffer_load_dwordx4 v2, s[60:63], s77 offen offset:1024 lds
    s_add_u32 s77, s23, 18432
    buffer_load_dwordx4 v2, s[60:63], s77 offen offset:2048 lds
    s_add_u32 s77, s23, 27648
    buffer_load_dwordx4 v2, s[60:63], s77 offen offset:3072 lds
    buffer_load_dword v6, v5, s[64:67], 0 offen sc1
    s_barrier
    v_mfma_f32_32x32x16_bf16 v[8:23], v[136:139], v[216:219], v[8:23]
    v_mfma_f32_32x32x16_bf16 v[24:39], v[140:143], v[216:219], v[24:39]
    v_mfma_f32_32x32x16_bf16 v[40:55], v[136:139], v[224:227], v[40:55]
    v_mfma_f32_32x32x16_bf16 v[56:71], v[140:143], v[224:227], v[56:71]
    v_mfma_f32_32x32x16_bf16 v[8:23], v[144:147], v[220:223], v[8:23]
    v_mfma_f32_32x32x16_bf16 v[24:39], v[148:151], v[220:223], v[24:39]
    v_mfma_f32_32x32x16_bf16 v[40:55], v[144:147], v[228:231], v[40:55]
    v_mfma_f32_32x32x16_bf16 v[56:71], v[148:151], v[228:231], v[56:71]
    s_waitcnt lgkmcnt(0)
    s_add_u32 s77, s18, 4096
    buffer_load_dwordx4 v[216:219], v1, s[64:67], s77 offen offset:0 sc1
    buffer_load_dwordx4 v[220:223], v1, s[64:67], s77 offen offset:1024 sc1
    s_add_u32 s77, s18, 266240
    buffer_load_dwordx4 v[224:227], v1, s[64:67], s77 offen offset:0 sc1
    buffer_load_dwordx4 v[228:231], v1, s[64:67], s77 offen offset:1024 sc1
    s_barrier
    v_mfma_f32_32x32x16_bf16 v[8:23], v[152:155], v[232:235], v[8:23]
    v_mfma_f32_32x32x16_bf16 v[24:39], v[156:159], v[232:235], v[24:39]
    v_mfma_f32_32x32x16_bf16 v[40:55], v[152:155], v[240:243], v[40:55]
    v_mfma_f32_32x32x16_bf16 v[56:71], v[156:159], v[240:243], v[56:71]
    v_mfma_f32_32x32x16_bf16 v[8:23], v[160:163], v[236:239], v[8:23]
    v_mfma_f32_32x32x16_bf16 v[24:39], v[164:167], v[236:239], v[24:39]
    v_mfma_f32_32x32x16_bf16 v[40:55], v[160:163], v[244:247], v[40:55]
    v_mfma_f32_32x32x16_bf16 v[56:71], v[164:167], v[244:247], v[56:71]
    s_waitcnt lgkmcnt(0)
    s_add_u32 m0, s11, 4096
    s_add_u32 s77, s23, 40960
    buffer_load_dwordx4 v2, s[60:63], s77 offen offset:0 lds
    s_add_u32 s77, s23, 50176
    buffer_load_dwordx4 v2, s[60:63], s77 offen offset:1024 lds
    s_add_u32 s77, s23, 59392
    buffer_load_dwordx4 v2, s[60:63], s77 offen offset:2048 lds
    s_add_u32 s77, s23, 68608
    buffer_load_dwordx4 v2, s[60:63], s77 offen offset:3072 lds
    s_add_u32 s77, s18, 6144
    buffer_load_dwordx4 v[232:235], v1, s[64:67], s77 offen offset:0 sc1
    buffer_load_dwordx4 v[236:239], v1, s[64:67], s77 offen offset:1024 sc1
    s_add_u32 s77, s18, 268288
    buffer_load_dwordx4 v[240:243], v1, s[64:67], s77 offen offset:0 sc1
    buffer_load_dwordx4 v[244:247], v1, s[64:67], s77 offen offset:1024 sc1
    s_add_u32 m0, s11, 8192
    s_add_u32 s77, s23, 81920
    buffer_load_dwordx4 v2, s[60:63], s77 offen offset:0 lds
    s_add_u32 s77, s23, 91136
    buffer_load_dwordx4 v2, s[60:63], s77 offen offset:1024 lds
    s_add_u32 s77, s23, 100352
    buffer_load_dwordx4 v2, s[60:63], s77 offen offset:2048 lds
    s_add_u32 s77, s23, 109568
    buffer_load_dwordx4 v2, s[60:63], s77 offen offset:3072 lds
    s_barrier
    s_waitcnt vmcnt(29)
    s_waitcnt vmcnt(25)
    ds_read_b64_tr_b16 v[104:105], v3 offset:12288
    ds_read_b64_tr_b16 v[106:107], v3 offset:12800
    v_mfma_f32_32x32x16_bf16 v[8:23], v[168:171], v[184:187], v[8:23]
    ds_read_b64_tr_b16 v[108:109], v4 offset:12288
    ds_read_b64_tr_b16 v[110:111], v4 offset:12800
    v_mfma_f32_32x32x16_bf16 v[24:39], v[172:175], v[184:187], v[24:39]
    ds_read_b64_tr_b16 v[112:113], v3 offset:14336
    ds_read_b64_tr_b16 v[114:115], v3 offset:14848
    v_mfma_f32_32x32x16_bf16 v[40:55], v[168:171], v[192:195], v[40:55]
    ds_read_b64_tr_b16 v[116:117], v4 offset:14336
    ds_read_b64_tr_b16 v[118:119], v4 offset:14848
    v_mfma_f32_32x32x16_bf16 v[56:71], v[172:175], v[192:195], v[56:71]
    v_mfma_f32_32x32x16_bf16 v[8:23], v[176:179], v[188:191], v[8:23]
    v_mfma_f32_32x32x16_bf16 v[24:39], v[180:183], v[188:191], v[24:39]
    v_mfma_f32_32x32x16_bf16 v[40:55], v[176:179], v[196:199], v[40:55]
    v_mfma_f32_32x32x16_bf16 v[56:71], v[180:183], v[196:199], v[56:71]
    s_waitcnt lgkmcnt(0)
    s_barrier
    s_waitcnt vmcnt(21)
    s_waitcnt vmcnt(17)
    ds_read_b64_tr_b16 v[120:121], v3 offset:0
    ds_read_b64_tr_b16 v[122:123], v3 offset:512
    v_mfma_f32_32x32x16_bf16 v[8:23], v[72:75], v[200:203], v[8:23]
    ds_read_b64_tr_b16 v[124:125], v4 offset:0
    ds_read_b64_tr_b16 v[126:127], v4 offset:512
    v_mfma_f32_32x32x16_bf16 v[24:39], v[76:79], v[200:203], v[24:39]
    ds_read_b64_tr_b16 v[128:129], v3 offset:2048
    ds_read_b64_tr_b16 v[130:131], v3 offset:2560
    v_mfma_f32_32x32x16_bf16 v[40:55], v[72:75], v[208:211], v[40:55]
    ds_read_b64_tr_b16 v[132:133], v4 offset:2048
    ds_read_b64_tr_b16 v[134:135], v4 offset:2560
    v_mfma_f32_32x32x16_bf16 v[56:71], v[76:79], v[208:211], v[56:71]
    v_mfma_f32_32x32x16_bf16 v[8:23], v[80:83], v[204:207], v[8:23]
    v_mfma_f32_32x32x16_bf16 v[24:39], v[84:87], v[204:207], v[24:39]
    v_mfma_f32_32x32x16_bf16 v[40:55], v[80:83], v[212:215], v[40:55]
    v_mfma_f32_32x32x16_bf16 v[56:71], v[84:87], v[212:215], v[56:71]
    s_waitcnt lgkmcnt(0)
    s_barrier
    s_waitcnt vmcnt(12)
    v_mfma_f32_32x32x16_bf16 v[8:23], v[88:91], v[216:219], v[8:23]
    v_mfma_f32_32x32x16_bf16 v[24:39], v[92:95], v[216:219], v[24:39]
    v_mfma_f32_32x32x16_bf16 v[40:55], v[88:91], v[224:227], v[40:55]
    v_mfma_f32_32x32x16_bf16 v[56:71], v[92:95], v[224:227], v[56:71]
    v_mfma_f32_32x32x16_bf16 v[8:23], v[96:99], v[220:223], v[8:23]
    v_mfma_f32_32x32x16_bf16 v[24:39], v[100:103], v[220:223], v[24:39]
    v_mfma_f32_32x32x16_bf16 v[40:55], v[96:99], v[228:231], v[40:55]
    v_mfma_f32_32x32x16_bf16 v[56:71], v[100:103], v[228:231], v[56:71]
    s_waitcnt lgkmcnt(0)
    s_barrier
    s_waitcnt vmcnt(4)
    ds_read_b64_tr_b16 v[136:137], v3 offset:4096
    ds_read_b64_tr_b16 v[138:139], v3 offset:4608
    v_mfma_f32_32x32x16_bf16 v[8:23], v[104:107], v[232:235], v[8:23]
    ds_read_b64_tr_b16 v[140:141], v4 offset:4096
    ds_read_b64_tr_b16 v[142:143], v4 offset:4608
    v_mfma_f32_32x32x16_bf16 v[24:39], v[108:111], v[232:235], v[24:39]
    ds_read_b64_tr_b16 v[144:145], v3 offset:6144
    ds_read_b64_tr_b16 v[146:147], v3 offset:6656
    v_mfma_f32_32x32x16_bf16 v[40:55], v[104:107], v[240:243], v[40:55]
    ds_read_b64_tr_b16 v[148:149], v4 offset:6144
    ds_read_b64_tr_b16 v[150:151], v4 offset:6656
    v_mfma_f32_32x32x16_bf16 v[56:71], v[108:111], v[240:243], v[56:71]
    v_mfma_f32_32x32x16_bf16 v[8:23], v[112:115], v[236:239], v[8:23]
    v_mfma_f32_32x32x16_bf16 v[24:39], v[116:119], v[236:239], v[24:39]
    v_mfma_f32_32x32x16_bf16 v[40:55], v[112:115], v[244:247], v[40:55]
    v_mfma_f32_32x32x16_bf16 v[56:71], v[116:119], v[244:247], v[56:71]
    s_waitcnt lgkmcnt(0)
    s_mov_b32 s90, 200000
L_poll4:
    v_cmp_ne_u32 vcc, s76, v6
    s_sub_u32 s90, s90, 1
    s_cbranch_scc1 L_pd4
    s_and_b32 s77, vcc_lo, 192
    s_cbranch_scc0 L_pd4
    buffer_load_dword v6, v5, s[64:67], 0 offen sc1
    s_waitcnt vmcnt(0)
    s_branch L_poll4
L_pd4:
    s_add_u32 s77, s19, 0
    buffer_load_dwordx4 v[184:187], v1, s[64:67], s77 offen offset:0 sc1
    buffer_load_dwordx4 v[188:191], v1, s[64:67], s77 offen offset:1024 sc1
    s_add_u32 s77, s19, 262144
    buffer_load_dwordx4 v[192:195], v1, s[64:67], s77 offen offset:0 sc1
    buffer_load_dwordx4 v[196:199], v1, s[64:67], s77 offen offset:1024 sc1
    s_barrier
    s_waitcnt vmcnt(4)
    ds_read_b64_tr_b16 v[152:153], v3 offset:8192
    ds_read_b64_tr_b16 v[154:155], v3 offset:8704
    ds_read_b64_tr_b16 v[156:157], v4 offset:8192
    ds_read_b64_tr_b16 v[158:159], v4 offset:8704
    ds_read_b64_tr_b16 v[160:161], v3 offset:10240
    ds_read_b64_tr_b16 v[162:163], v3 offset:10752
    ds_read_b64_tr_b16 v[164:165], v4 offset:10240
    ds_read_b64_tr_b16 v[166:167], v4 offset:10752
    s_waitcnt lgkmcnt(0)
    s_barrier
    s_waitcnt lgkmcnt(0)
    s_barrier
    s_waitcnt lgkmcnt(0)
    s_add_u32 m0, s11, 12288
    s_add_u32 s77, s23, 122880
    buffer_load_dwordx4 v2, s[60:63], s77 offen offset:0 lds
    s_add_u32 s77, s23, 132096
    buffer_load_dwordx4 v2, s[60:63], s77 offen offset:1024 lds
    s_add_u32 s77, s23, 141312
    buffer_load_dwordx4 v2, s[60:63], s77 offen offset:2048 lds
    s_add_u32 s77, s23, 150528
    buffer_load_dwordx4 v2, s[60:63], s77 offen offset:3072 lds
    s_add_u32 s77, s19, 2048
    buffer_load_dwordx4 v[200:203], v1, s[64:67], s77 offen offset:0 sc1
    buffer_load_dwordx4 v[204:207], v1, s[64:67], s77 offen offset:1024 sc1
    s_add_u32 s77, s19, 264192
    buffer_load_dwordx4 v[208:211], v1, s[64:67], s77 offen offset:0 sc1
    buffer_load_dwordx4 v[212:215], v1, s[64:67], s77 offen offset:1024 sc1
    s_add_u32 s77, s19, 4096
    buffer_load_dwordx4 v[216:219], v1, s[64:67], s77 offen offset:0 sc1
    buffer_load_dwordx4 v[220:223], v1, s[64:67], s77 offen offset:1024 sc1
    s_add_u32 s77, s19, 266240
    buffer_load_dwordx4 v[224:227], v1, s[64:67], s77 offen offset:0 sc1
    buffer_load_dwordx4 v[228:231], v1, s[64:67], s77 offen offset:1024 sc1
    s_add_u32 s77, s19, 6144
    buffer_load_dwordx4 v[232:235], v1, s[64:67], s77 offen offset:0 sc1
    buffer_load_dwordx4 v[236:239], v1, s[64:67], s77 offen offset:1024 sc1
    s_add_u32 s77, s19, 268288
    buffer_load_dwordx4 v[240:243], v1, s[64:67], s77 offen offset:0 sc1
    buffer_load_dwordx4 v[244:247], v1, s[64:67], s77 offen offset:1024 sc1
    s_barrier
    s_waitcnt vmcnt(16)
    v_mfma_f32_32x32x16_bf16 v[8:23], v[120:123], v[184:187], v[8:23]
    v_mfma_f32_32x32x16_bf16 v[24:39], v[124:127], v[184:187], v[24:39]
    v_mfma_f32_32x32x16_bf16 v[40:55], v[120:123], v[192:195], v[40:55]
    v_mfma_f32_32x32x16_bf16 v[56:71], v[124:127], v[192:195], v[56:71]
    v_mfma_f32_32x32x16_bf16 v[8:23], v[128:131], v[188:191], v[8:23]
    v_mfma_f32_32x32x16_bf16 v[24:39], v[132:135], v[188:191], v[24:39]
    v_mfma_f32_32x32x16_bf16 v[40:55], v[128:131], v[196:199], v[40:55]
    v_mfma_f32_32x32x16_bf16 v[56:71], v[132:135], v[196:199], v[56:71]
    s_waitcnt lgkmcnt(0)
    s_barrier
    s_waitcnt lgkmcnt(0)
    s_barrier
    s_waitcnt lgkmcnt(0)
    s_barrier
    s_waitcnt vmcnt(8)
    ds_read_b64_tr_b16 v[168:169], v3 offset:12288
    ds_read_b64_tr_b16 v[170:171], v3 offset:12800
    v_mfma_f32_32x32x16_bf16 v[8:23], v[136:139], v[200:203], v[8:23]
    ds_read_b64_tr_b16 v[172:173], v4 offset:12288
    ds_read_b64_tr_b16 v[174:175], v4 offset:12800
    v_mfma_f32_32x32x16_bf16 v[24:39], v[140:143], v[200:203], v[24:39]
    ds_read_b64_tr_b16 v[176:177], v3 offset:14336
    ds_read_b64_tr_b16 v[178:179], v3 offset:14848
    v_mfma_f32_32x32x16_bf16 v[40:55], v[136:139], v[208:211], v[40:55]
    ds_read_b64_tr_b16 v[180:181], v4 offset:14336
    ds_read_b64_tr_b16 v[182:183], v4 offset:14848
    v_mfma_f32_32x32x16_bf16 v[56:71], v[140:143], v[208:211], v[56:71]
    v_mfma_f32_32x32x16_bf16 v[8:23], v[144:147], v[204:207], v[8:23]
    v_mfma_f32_32x32x16_bf16 v[24:39], v[148:151], v[204:207], v[24:39]
    v_mfma_f32_32x32x16_bf16 v[40:55], v[144:147], v[212:215], v[40:55]
    v_mfma_f32_32x32x16_bf16 v[56:71], v[148:151], v[212:215], v[56:71]
    s_waitcnt lgkmcnt(0)
    s_barrier
    s_waitcnt vmcnt(4)
    v_mfma_f32_32x32x16_bf16 v[8:23], v[152:155], v[216:219], v[8:23]
    v_mfma_f32_32x32x16_bf16 v[24:39], v[156:159], v[216:219], v[24:39]
    v_mfma_f32_32x32x16_bf16 v[40:55], v[152:155], v[224:227], v[40:55]
    v_mfma_f32_32x32x16_bf16 v[56:71], v[156:159], v[224:227], v[56:71]
    v_mfma_f32_32x32x16_bf16 v[8:23], v[160:163], v[220:223], v[8:23]
    v_mfma_f32_32x32x16_bf16 v[24:39], v[164:167], v[220:223], v[24:39]
    v_mfma_f32_32x32x16_bf16 v[40:55], v[160:163], v[228:231], v[40:55]
    v_mfma_f32_32x32x16_bf16 v[56:71], v[164:167], v[228:231], v[56:71]
    s_waitcnt lgkmcnt(0)
    s_add_u32 m0, s11, 0
    s_add_u32 s77, s86, 0
    buffer_load_dwordx4 v2, s[60:63], s77 offen offset:0 lds
    s_add_u32 s77, s86, 9216
    buffer_load_dwordx4 v2, s[60:63], s77 offen offset:1024 lds
    s_add_u32 s77, s86, 18432
    buffer_load_dwordx4 v2, s[60:63], s77 offen offset:2048 lds
    s_add_u32 s77, s86, 27648
    buffer_load_dwordx4 v2, s[60:63], s77 offen offset:3072 lds
    s_add_u32 m0, s11, 4096
    s_add_u32 s77, s86, 40960
    buffer_load_dwordx4 v2, s[60:63], s77 offen offset:0 lds
    s_add_u32 s77, s86, 50176
    buffer_load_dwordx4 v2, s[60:63], s77 offen offset:1024 lds
    s_add_u32 s77, s86, 59392
    buffer_load_dwordx4 v2, s[60:63], s77 offen offset:2048 lds
    s_add_u32 s77, s86, 68608
    buffer_load_dwordx4 v2, s[60:63], s77 offen offset:3072 lds
    s_barrier
    s_waitcnt vmcnt(8)
    v_mfma_f32_32x32x16_bf16 v[8:23], v[168:171], v[232:235], v[8:23]
    v_mfma_f32_32x32x16_bf16 v[24:39], v[172:175], v[232:235], v[24:39]
    v_mfma_f32_32x32x16_bf16 v[40:55], v[168:171], v[240:243], v[40:55]
    v_mfma_f32_32x32x16_bf16 v[56:71], v[172:175], v[240:243], v[56:71]
    v_mfma_f32_32x32x16_bf16 v[8:23], v[176:179], v[236:239], v[8:23]
    v_mfma_f32_32x32x16_bf16 v[24:39], v[180:183], v[236:239], v[24:39]
    v_mfma_f32_32x32x16_bf16 v[40:55], v[176:179], v[244:247], v[40:55]
    v_mfma_f32_32x32x16_bf16 v[56:71], v[180:183], v[244:247], v[56:71]
    s_waitcnt lgkmcnt(0)
    s_add_u32 m0, s11, 8192
    s_add_u32 s77, s86, 81920
    buffer_load_dwordx4 v2, s[60:63], s77 offen offset:0 lds
    s_add_u32 s77, s86, 91136
    buffer_load_dwordx4 v2, s[60:63], s77 offen offset:1024 lds
    s_add_u32 s77, s86, 100352
    buffer_load_dwordx4 v2, s[60:63], s77 offen offset:2048 lds
    s_add_u32 s77, s86, 109568
    buffer_load_dwordx4 v2, s[60:63], s77 offen offset:3072 lds
    s_add_u32 m0, s11, 12288
    s_add_u32 s77, s86, 122880
    buffer_load_dwordx4 v2, s[60:63], s77 offen offset:0 lds
    s_add_u32 s77, s86, 132096
    buffer_load_dwordx4 v2, s[60:63], s77 offen offset:1024 lds
    s_add_u32 s77, s86, 141312
    buffer_load_dwordx4 v2, s[60:63], s77 offen offset:2048 lds
    s_add_u32 s77, s86, 150528
    buffer_load_dwordx4 v2, s[60:63], s77 offen offset:3072 lds
    s_barrier
    s_waitcnt vmcnt(12)
    ds_read_b64_tr_b16 v[72:73], v3 offset:0
    ds_read_b64_tr_b16 v[74:75], v3 offset:512
    ds_read_b64_tr_b16 v[76:77], v4 offset:0
    ds_read_b64_tr_b16 v[78:79], v4 offset:512
    ds_read_b64_tr_b16 v[80:81], v3 offset:2048
    ds_read_b64_tr_b16 v[82:83], v3 offset:2560
    ds_read_b64_tr_b16 v[84:85], v4 offset:2048
    ds_read_b64_tr_b16 v[86:87], v4 offset:2560
    s_waitcnt lgkmcnt(0)
    s_add_u32 m0, s11, 0
    s_add_u32 s77, s86, 204800
    buffer_load_dwordx4 v2, s[60:63], s77 offen offset:0 lds
    s_add_u32 s77, s86, 214016
    buffer_load_dwordx4 v2, s[60:63], s77 offen offset:1024 lds
    s_add_u32 s77, s86, 223232
    buffer_load_dwordx4 v2, s[60:63], s77 offen offset:2048 lds
    s_add_u32 s77, s86, 232448
    buffer_load_dwordx4 v2, s[60:63], s77 offen offset:3072 lds
    s_barrier
    s_waitcnt vmcnt(12)
    ds_read_b64_tr_b16 v[88:89], v3 offset:4096
    ds_read_b64_tr_b16 v[90:91], v3 offset:4608
    ds_read_b64_tr_b16 v[92:93], v4 offset:4096
    ds_read_b64_tr_b16 v[94:95], v4 offset:4608
    ds_read_b64_tr_b16 v[96:97], v3 offset:6144
    ds_read_b64_tr_b16 v[98:99], v3 offset:6656
    ds_read_b64_tr_b16 v[100:101], v4 offset:6144
    ds_read_b64_tr_b16 v[102:103], v4 offset:6656
    s_waitcnt lgkmcnt(0)
    s_add_u32 m0, s11, 4096
    s_add_u32 s77, s86, 245760
    buffer_load_dwordx4 v2, s[60:63], s77 offen offset:0 lds
    s_add_u32 s77, s86, 254976
    buffer_load_dwordx4 v2, s[60:63], s77 offen offset:1024 lds
    s_add_u32 s77, s86, 264192
    buffer_load_dwordx4 v2, s[60:63], s77 offen offset:2048 lds
    s_add_u32 s77, s86, 273408
    buffer_load_dwordx4 v2, s[60:63], s77 offen offset:3072 lds
    s_barrier
    s_waitcnt vmcnt(12)
    ds_read_b64_tr_b16 v[104:105], v3 offset:8192
    ds_read_b64_tr_b16 v[106:107], v3 offset:8704
    ds_read_b64_tr_b16 v[108:109], v4 offset:8192
    ds_read_b64_tr_b16 v[110:111], v4 offset:8704
    ds_read_b64_tr_b16 v[112:113], v3 offset:10240
    ds_read_b64_tr_b16 v[114:115], v3 offset:10752
    ds_read_b64_tr_b16 v[116:117], v4 offset:10240
    ds_read_b64_tr_b16 v[118:119], v4 offset:10752
    s_waitcnt lgkmcnt(0)
    s_add_u32 m0, s11, 8192
    s_add_u32 s77, s86, 286720
    buffer_load_dwordx4 v2, s[60:63], s77 offen offset:0 lds
    s_add_u32 s77, s86, 295936
    buffer_load_dwordx4 v2, s[60:63], s77 offen offset:1024 lds
    s_add_u32 s77, s86, 305152
    buffer_load_dwordx4 v2, s[60:63], s77 offen offset:2048 lds
    s_add_u32 s77, s86, 314368
    buffer_load_dwordx4 v2, s[60:63], s77 offen offset:3072 lds
    s_mul_i32 s77, s9, 3
    s_add_u32 s77, s77, s4
    s_and_b32 s77, s77, 7
    s_and_b32 s91, s77, 6
    s_add_u32 s91, s91, s77
    s_lshl_b32 s91, s91, 1
    s_add_u32 s91, s91, 4
    s_mul_i32 s85, s91, 163840
    s_add_u32 s85, s85, s88
    s_lshl_b32 s84, s91, 13
    s_add_u32 s84, s84, s89
    s_lshr_b32 s77, s89, 6
    s_lshl_b32 s78, s91, 7
    s_add_u32 s77, s77, s78
    s_add_u32 s77, s77, 12582912
    v_and_b32 v5, 1, v0
    v_lshlrev_b32 v5, 12, v5
    v_lshrrev_b32 v6, 1, v0
    v_and_b32 v6, 1, v6
    v_lshl_add_u32 v5, v6, 7, v5
    v_add_u32 v5, s77, v5
    s_barrier
    s_branch L_tail
L_ld:
    s_setprio 3
    s_mov_b32 s12, s4
    v_lshrrev_b32 v6, 4, v0
    v_and_b32 v7, 7, v0
    v_xor_b32 v7, v7, v6
    v_lshlrev_b32 v7, 4, v7
    v_lshrrev_b32 v8, 3, v0
    v_mul_u32_u24 v8, 1280, v8
    v_add_u32 v8, v8, v7
    s_and_b32 s13, s12, 1
    s_lshl_b32 s13, s13, 6
    v_xor_b32 v8, s13, v8
    v_xor_b32 v9, 64, v8
    s_mul_i32 s84, s6, 122880
    s_mul_i32 s13, s12, 30720
    s_add_u32 s84, s84, s13
    s_mul_i32 s15, s12, 3072
    v_lshlrev_b32 v7, 2, v6
    v_and_b32 v10, 15, v0
    v_xor_b32 v7, v7, v10
    v_lshlrev_b32 v7, 4, v7
    v_lshl_add_u32 v10, v6, 13, v7
    s_lshl_b32 s85, s7, 8
    s_lshl_b32 s13, s12, 16
    s_add_u32 s85, s85, s13
    s_lshl_b32 s14, s12, 11
    s_add_u32 m0, s15, 147456
    s_add_u32 s77, s84, 0
    buffer_load_dwordx4 v8, s[44:47], s77 offen offset:0 lds
    s_add_u32 s77, s84, 9216
    buffer_load_dwordx4 v9, s[44:47], s77 offen offset:1024 lds
    s_add_u32 s77, s84, 18432
    buffer_load_dwordx4 v8, s[44:47], s77 offen offset:2048 lds
    s_add_u32 m0, s14, 98304
    s_add_u32 s77, s85, 0
    s_add_u32 s78, s85, 31744
    buffer_load_dwordx4 v10, s[48:51], s77 offen lds
    buffer_load_dwordx4 v10, s[48:51], s78 offen offset:1024 lds
    s_add_u32 m0, s14, 106496
    s_add_u32 s77, s85, 1024
    s_add_u32 s78, s85, 32768
    buffer_load_dwordx4 v10, s[48:51], s77 offen lds
    buffer_load_dwordx4 v10, s[48:51], s78 offen offset:1024 lds
    s_add_u32 m0, s14, 114688
    s_add_u32 s77, s85, 262144
    s_add_u32 s78, s85, 293888
    buffer_load_dwordx4 v10, s[48:51], s77 offen lds
    buffer_load_dwordx4 v10, s[48:51], s78 offen offset:1024 lds
    s_add_u32 m0, s14, 122880
    s_add_u32 s77, s85, 263168
    s_add_u32 s78, s85, 294912
    buffer_load_dwordx4 v10, s[48:51], s77 offen lds
    buffer_load_dwordx4 v10, s[48:51], s78 offen offset:1024 lds
    s_add_u32 m0, s15, 16384
    s_add_u32 s77, s84, 128
    buffer_load_dwordx4 v8, s[44:47], s77 offen offset:0 lds
    s_add_u32 s77, s84, 9344
    buffer_load_dwordx4 v9, s[44:47], s77 offen offset:1024 lds
    s_add_u32 s77, s84, 18560
    buffer_load_dwordx4 v8, s[44:47], s77 offen offset:2048 lds
    s_add_u32 m0, s14, 131072
    s_add_u32 s77, s85, 524288
    s_add_u32 s78, s85, 556032
    buffer_load_dwordx4 v10, s[48:51], s77 offen lds
    buffer_load_dwordx4 v10, s[48:51], s78 offen offset:1024 lds
    s_add_u32 m0, s14, 139264
    s_add_u32 s77, s85, 525312
    s_add_u32 s78, s85, 557056
    buffer_load_dwordx4 v10, s[48:51], s77 offen lds
    buffer_load_dwordx4 v10, s[48:51], s78 offen offset:1024 lds
    s_add_u32 m0, s14, 65536
    s_add_u32 s77, s85, 786432
    s_add_u32 s78, s85, 818176
    buffer_load_dwordx4 v10, s[48:51], s77 offen lds
    buffer_load_dwordx4 v10, s[48:51], s78 offen offset:1024 lds
    s_add_u32 m0, s14, 73728
    s_add_u32 s77, s85, 787456
    s_add_u32 s78, s85, 819200
    buffer_load_dwordx4 v10, s[48:51], s77 offen lds
    buffer_load_dwordx4 v10, s[48:51], s78 offen offset:1024 lds
    s_lshl_b32 s82, s6, 5
    s_add_u32 s82, s82, s7
    s_lshl_b32 s82, s82, 18
    s_lshl_b32 s83, s6, 5
    s_add_u32 s83, s83, s7
    s_add_u32 s83, s83, 4
    s_lshl_b32 s83, s83, 18
    v_lshrrev_b32 v6, 4, v0
    v_and_b32 v7, 15, v0
    v_xor_b32 v7, v7, v6
    v_lshlrev_b32 v7, 4, v7
    v_lshl_add_u32 v248, v6, 8, v7
    v_xor_b32 v249, 64, v248
    v_xor_b32 v250, 128, v248
    v_xor_b32 v251, 192, v248
    v_lshlrev_b32 v7, 2, v6
    v_and_b32 v5, 15, v0
    v_xor_b32 v7, v7, v5
    v_lshlrev_b32 v7, 4, v7
    v_lshl_add_u32 v252, v6, 8, v7
    v_mov_b32 v253, 0
    s_mul_i32 s25, s10, 0
    s_and_b32 s26, s2, 7
    s_mul_i32 s26, s26, 4
    s_add_u32 s25, s25, s26
    s_and_b32 s25, s25, 31
    s_lshl_b32 s25, s25, 13
    s_mul_i32 s77, s9, 3
    s_add_u32 s77, s77, 0
    s_and_b32 s77, s77, 7
    s_and_b32 s20, s77, 6
    s_add_u32 s20, s20, s77
    s_lshl_b32 s20, s20, 1
    s_add_u32 s20, s20, 4
    s_mul_i32 s20, s20, 163840
    s_add_u32 s20, s20, s88
    s_mul_i32 s77, s9, 3
    s_add_u32 s77, s77, 1
    s_and_b32 s77, s77, 7
    s_and_b32 s21, s77, 6
    s_add_u32 s21, s21, s77
    s_lshl_b32 s21, s21, 1
    s_add_u32 s21, s21, 4
    s_mul_i32 s21, s21, 163840
    s_add_u32 s21, s21, s88
    s_mul_i32 s77, s9, 3
    s_add_u32 s77, s77, 2
    s_and_b32 s77, s77, 7
    s_and_b32 s22, s77, 6
    s_add_u32 s22, s22, s77
    s_lshl_b32 s22, s22, 1
    s_add_u32 s22, s22, 4
    s_mul_i32 s22, s22, 163840
    s_add_u32 s22, s22, s88
    s_mul_i32 s77, s9, 3
    s_add_u32 s77, s77, 3
    s_and_b32 s77, s77, 7
    s_and_b32 s23, s77, 6
    s_add_u32 s23, s23, s77
    s_lshl_b32 s23, s23, 1
    s_add_u32 s23, s23, 4
    s_mul_i32 s23, s23, 163840
    s_add_u32 s23, s23, s88
    v_lshrrev_b32 v6, 3, v0
    v_lshrrev_b32 v7, 2, v0
    v_and_b32 v7, 4, v7
    v_and_b32 v2, 7, v0
    v_xor_b32 v7, v7, v2
    v_mul_u32_u24 v2, 1280, v6
    v_lshl_add_u32 v2, v7, 4, v2
    v_lshrrev_b32 v6, 2, v0
    v_and_b32 v6, 3, v6
    v_lshrrev_b32 v3, 4, v0
    v_and_b32 v3, 1, v3
    v_lshlrev_b32 v3, 5, v3
    v_and_b32 v7, 1, v0
    v_lshl_add_u32 v3, v7, 4, v3
    v_and_b32 v7, 2, v0
    v_lshl_add_u32 v3, v7, 2, v3
    v_lshl_add_u32 v3, v6, 7, v3
    v_lshrrev_b32 v6, 1, v6
    v_lshl_add_u32 v3, v6, 6, v3
    v_lshrrev_b32 v7, 5, v0
    v_lshl_add_u32 v3, v7, 10, v3
    v_add_u32 v3, s11, v3
    v_xor_b32 v4, 64, v3
    s_waitcnt vmcnt(15)
    s_barrier
    s_add_u32 m0, s15, 49152
    s_add_u32 s77, s84, 256
    buffer_load_dwordx4 v8, s[44:47], s77 offen offset:0 lds
    s_add_u32 s77, s84, 9472
    buffer_load_dwordx4 v9, s[44:47], s77 offen offset:1024 lds
    s_add_u32 s77, s84, 18688
    buffer_load_dwordx4 v8, s[44:47], s77 offen offset:2048 lds
    s_add_u32 m0, s14, 81920
    s_add_u32 s77, s85, 1048576
    s_add_u32 s78, s85, 1080320
    buffer_load_dwordx4 v10, s[48:51], s77 offen lds
    buffer_load_dwordx4 v10, s[48:51], s78 offen offset:1024 lds
    s_add_u32 m0, s14, 90112
    s_add_u32 s77, s85, 1049600
    s_add_u32 s78, s85, 1081344
    buffer_load_dwordx4 v10, s[48:51], s77 offen lds
    buffer_load_dwordx4 v10, s[48:51], s78 offen offset:1024 lds
    s_waitcnt vmcnt(18)
    s_barrier
    s_add_u32 m0, s14, 98304
    s_add_u32 s77, s85, 1310720
    s_add_u32 s78, s85, 1342464
    buffer_load_dwordx4 v10, s[48:51], s77 offen lds
    buffer_load_dwordx4 v10, s[48:51], s78 offen offset:1024 lds
    s_add_u32 m0, s14, 106496
    s_add_u32 s77, s85, 1311744
    s_add_u32 s78, s85, 1343488
    buffer_load_dwordx4 v10, s[48:51], s77 offen lds
    buffer_load_dwordx4 v10, s[48:51], s78 offen offset:1024 lds
    s_waitcnt vmcnt(15)
    s_barrier
    s_add_u32 m0, s15, 147456
    s_add_u32 s77, s84, 384
    buffer_load_dwordx4 v8, s[44:47], s77 offen offset:0 lds
    s_add_u32 s77, s84, 9600
    buffer_load_dwordx4 v9, s[44:47], s77 offen offset:1024 lds
    s_add_u32 s77, s84, 18816
    buffer_load_dwordx4 v8, s[44:47], s77 offen offset:2048 lds
    s_add_u32 m0, s14, 114688
    s_add_u32 s77, s85, 1572864
    s_add_u32 s78, s85, 1604608
    buffer_load_dwordx4 v10, s[48:51], s77 offen lds
    buffer_load_dwordx4 v10, s[48:51], s78 offen offset:1024 lds
    s_add_u32 m0, s14, 122880
    s_add_u32 s77, s85, 1573888
    s_add_u32 s78, s85, 1605632
    buffer_load_dwordx4 v10, s[48:51], s77 offen lds
    buffer_load_dwordx4 v10, s[48:51], s78 offen offset:1024 lds
    s_waitcnt vmcnt(18)
    s_barrier
    s_add_u32 m0, s14, 131072
    s_add_u32 s77, s85, 1835008
    s_add_u32 s78, s85, 1866752
    buffer_load_dwordx4 v10, s[48:51], s77 offen lds
    buffer_load_dwordx4 v10, s[48:51], s78 offen offset:1024 lds
    s_add_u32 m0, s14, 139264
    s_add_u32 s77, s85, 1836032
    s_add_u32 s78, s85, 1867776
    buffer_load_dwordx4 v10, s[48:51], s77 offen lds
    buffer_load_dwordx4 v10, s[48:51], s78 offen offset:1024 lds
    s_waitcnt vmcnt(15)
    s_barrier
    s_add_u32 m0, s15, 16384
    s_add_u32 s77, s84, 512
    buffer_load_dwordx4 v8, s[44:47], s77 offen offset:0 lds
    s_add_u32 s77, s84, 9728
    buffer_load_dwordx4 v9, s[44:47], s77 offen offset:1024 lds
    s_add_u32 s77, s84, 18944
    buffer_load_dwordx4 v8, s[44:47], s77 offen offset:2048 lds
    s_add_u32 m0, s14, 65536
    s_add_u32 s77, s85, 2097152
    s_add_u32 s78, s85, 2128896
    buffer_load_dwordx4 v10, s[48:51], s77 offen lds
    buffer_load_dwordx4 v10, s[48:51], s78 offen offset:1024 lds
    s_add_u32 m0, s14, 73728
    s_add_u32 s77, s85, 2098176
    s_add_u32 s78, s85, 2129920
    buffer_load_dwordx4 v10, s[48:51], s77 offen lds
    buffer_load_dwordx4 v10, s[48:51], s78 offen offset:1024 lds
    s_waitcnt vmcnt(18)
    s_barrier
    s_add_u32 m0, s14, 81920
    s_add_u32 s77, s85, 2359296
    s_add_u32 s78, s85, 2391040
    buffer_load_dwordx4 v10, s[48:51], s77 offen lds
    buffer_load_dwordx4 v10, s[48:51], s78 offen offset:1024 lds
    s_add_u32 m0, s14, 90112
    s_add_u32 s77, s85, 2360320
    s_add_u32 s78, s85, 2392064
    buffer_load_dwordx4 v10, s[48:51], s77 offen lds
    buffer_load_dwordx4 v10, s[48:51], s78 offen offset:1024 lds
    s_waitcnt vmcnt(15)
    s_barrier
    s_add_u32 m0, s15, 49152
    s_add_u32 s77, s84, 640
    buffer_load_dwordx4 v8, s[44:47], s77 offen offset:0 lds
    s_add_u32 s77, s84, 9856
    buffer_load_dwordx4 v9, s[44:47], s77 offen offset:1024 lds
    s_add_u32 s77, s84, 19072
    buffer_load_dwordx4 v8, s[44:47], s77 offen offset:2048 lds
    s_add_u32 m0, s14, 98304
    s_add_u32 s77, s85, 2621440
    s_add_u32 s78, s85, 2653184
    buffer_load_dwordx4 v10, s[48:51], s77 offen lds
    buffer_load_dwordx4 v10, s[48:51], s78 offen offset:1024 lds
    s_add_u32 m0, s14, 106496
    s_add_u32 s77, s85, 2622464
    s_add_u32 s78, s85, 2654208
    buffer_load_dwordx4 v10, s[48:51], s77 offen lds
    buffer_load_dwordx4 v10, s[48:51], s78 offen offset:1024 lds
    s_waitcnt vmcnt(18)
    s_barrier
    s_add_u32 m0, s14, 114688
    s_add_u32 s77, s85, 2883584
    s_add_u32 s78, s85, 2915328
    buffer_load_dwordx4 v10, s[48:51], s77 offen lds
    buffer_load_dwordx4 v10, s[48:51], s78 offen offset:1024 lds
    s_add_u32 m0, s14, 122880
    s_add_u32 s77, s85, 2884608
    s_add_u32 s78, s85, 2916352
    buffer_load_dwordx4 v10, s[48:51], s77 offen lds
    buffer_load_dwordx4 v10, s[48:51], s78 offen offset:1024 lds
    s_waitcnt vmcnt(15)
    s_barrier
    s_add_u32 m0, s15, 147456
    s_add_u32 s77, s84, 768
    buffer_load_dwordx4 v8, s[44:47], s77 offen offset:0 lds
    s_add_u32 s77, s84, 9984
    buffer_load_dwordx4 v9, s[44:47], s77 offen offset:1024 lds
    s_add_u32 s77, s84, 19200
    buffer_load_dwordx4 v8, s[44:47], s77 offen offset:2048 lds
    s_add_u32 m0, s14, 131072
    s_add_u32 s77, s85, 3145728
    s_add_u32 s78, s85, 3177472
    buffer_load_dwordx4 v10, s[48:51], s77 offen lds
    buffer_load_dwordx4 v10, s[48:51], s78 offen offset:1024 lds
    s_add_u32 m0, s14, 139264
    s_add_u32 s77, s85, 3146752
    s_add_u32 s78, s85, 3178496
    buffer_load_dwordx4 v10, s[48:51], s77 offen lds
    buffer_load_dwordx4 v10, s[48:51], s78 offen offset:1024 lds
    s_waitcnt vmcnt(18)
    s_barrier
    s_add_u32 m0, s14, 65536
    s_add_u32 s77, s85, 3407872
    s_add_u32 s78, s85, 3439616
    buffer_load_dwordx4 v10, s[48:51], s77 offen lds
    buffer_load_dwordx4 v10, s[48:51], s78 offen offset:1024 lds
    s_add_u32 m0, s14, 73728
    s_add_u32 s77, s85, 3408896
    s_add_u32 s78, s85, 3440640
    buffer_load_dwordx4 v10, s[48:51], s77 offen lds
    buffer_load_dwordx4 v10, s[48:51], s78 offen offset:1024 lds
    s_waitcnt vmcnt(15)
    s_barrier
    s_add_u32 m0, s15, 16384
    s_add_u32 s77, s84, 896
    buffer_load_dwordx4 v8, s[44:47], s77 offen offset:0 lds
    s_add_u32 s77, s84, 10112
    buffer_load_dwordx4 v9, s[44:47], s77 offen offset:1024 lds
    s_add_u32 s77, s84, 19328
    buffer_load_dwordx4 v8, s[44:47], s77 offen offset:2048 lds
    s_add_u32 m0, s14, 81920
    s_add_u32 s77, s85, 3670016
    s_add_u32 s78, s85, 3701760
    buffer_load_dwordx4 v10, s[48:51], s77 offen lds
    buffer_load_dwordx4 v10, s[48:51], s78 offen offset:1024 lds
    s_add_u32 m0, s14, 90112
    s_add_u32 s77, s85, 3671040
    s_add_u32 s78, s85, 3702784
    buffer_load_dwordx4 v10, s[48:51], s77 offen lds
    buffer_load_dwordx4 v10, s[48:51], s78 offen offset:1024 lds
    s_waitcnt vmcnt(18)
    s_barrier
    s_add_u32 m0, s14, 98304
    s_add_u32 s77, s85, 3932160
    s_add_u32 s78, s85, 3963904
    buffer_load_dwordx4 v10, s[48:51], s77 offen lds
    buffer_load_dwordx4 v10, s[48:51], s78 offen offset:1024 lds
    s_add_u32 m0, s14, 106496
    s_add_u32 s77, s85, 3933184
    s_add_u32 s78, s85, 3964928
    buffer_load_dwordx4 v10, s[48:51], s77 offen lds
    buffer_load_dwordx4 v10, s[48:51], s78 offen offset:1024 lds
    s_waitcnt vmcnt(15)
    s_barrier
    s_add_u32 m0, s15, 49152
    s_add_u32 s77, s84, 1024
    buffer_load_dwordx4 v8, s[44:47], s77 offen offset:0 lds
    s_add_u32 s77, s84, 10240
    buffer_load_dwordx4 v9, s[44:47], s77 offen offset:1024 lds
    s_add_u32 s77, s84, 19456
    buffer_load_dwordx4 v8, s[44:47], s77 offen offset:2048 lds
    s_add_u32 m0, s14, 114688
    s_add_u32 s77, s85, 4194304
    s_add_u32 s78, s85, 4226048
    buffer_load_dwordx4 v10, s[48:51], s77 offen lds
    buffer_load_dwordx4 v10, s[48:51], s78 offen offset:1024 lds
    s_add_u32 m0, s14, 122880
    s_add_u32 s77, s85, 4195328
    s_add_u32 s78, s85, 4227072
    buffer_load_dwordx4 v10, s[48:51], s77 offen lds
    buffer_load_dwordx4 v10, s[48:51], s78 offen offset:1024 lds
    s_waitcnt vmcnt(18)
    s_barrier
    s_add_u32 m0, s14, 131072
    s_add_u32 s77, s85, 4456448
    s_add_u32 s78, s85, 4488192
    buffer_load_dwordx4 v10, s[48:51], s77 offen lds
    buffer_load_dwordx4 v10, s[48:51], s78 offen offset:1024 lds
    s_add_u32 m0, s14, 139264
    s_add_u32 s77, s85, 4457472
    s_add_u32 s78, s85, 4489216
    buffer_load_dwordx4 v10, s[48:51], s77 offen lds
    buffer_load_dwordx4 v10, s[48:51], s78 offen offset:1024 lds
    s_waitcnt vmcnt(15)
    s_barrier
    s_add_u32 m0, s15, 147456
    s_add_u32 s77, s84, 1152
    buffer_load_dwordx4 v8, s[44:47], s77 offen offset:0 lds
    s_add_u32 s77, s84, 10368
    buffer_load_dwordx4 v9, s[44:47], s77 offen offset:1024 lds
    s_add_u32 s77, s84, 19584
    buffer_load_dwordx4 v8, s[44:47], s77 offen offset:2048 lds
    s_add_u32 m0, s14, 65536
    s_add_u32 s77, s85, 4718592
    s_add_u32 s78, s85, 4750336
    buffer_load_dwordx4 v10, s[48:51], s77 offen lds
    buffer_load_dwordx4 v10, s[48:51], s78 offen offset:1024 lds
    s_add_u32 m0, s14, 73728
    s_add_u32 s77, s85, 4719616
    s_add_u32 s78, s85, 4751360
    buffer_load_dwordx4 v10, s[48:51], s77 offen lds
    buffer_load_dwordx4 v10, s[48:51], s78 offen offset:1024 lds
    s_waitcnt vmcnt(18)
    s_barrier
    s_add_u32 m0, s14, 81920
    s_add_u32 s77, s85, 4980736
    s_add_u32 s78, s85, 5012480
    buffer_load_dwordx4 v10, s[48:51], s77 offen lds
    buffer_load_dwordx4 v10, s[48:51], s78 offen offset:1024 lds
    s_add_u32 m0, s14, 90112
    s_add_u32 s77, s85, 4981760
    s_add_u32 s78, s85, 5013504
    buffer_load_dwordx4 v10, s[48:51], s77 offen lds
    buffer_load_dwordx4 v10, s[48:51], s78 offen offset:1024 lds
    s_waitcnt vmcnt(15)
    s_barrier
    s_mov_b32 m0, 0
    s_add_u32 s77, s82, 0
    buffer_load_dwordx4 v248, s[52:55], s77 offen offset:0 nt lds
    buffer_load_dwordx4 v249, s[52:55], s77 offen offset:1024 nt lds
    buffer_load_dwordx4 v250, s[52:55], s77 offen offset:2048 nt lds
    buffer_load_dwordx4 v251, s[52:55], s77 offen offset:3072 nt lds
    s_mov_b32 m0, 4096
    s_add_u32 s77, s82, 4096
    buffer_load_dwordx4 v248, s[52:55], s77 offen offset:0 nt lds
    buffer_load_dwordx4 v249, s[52:55], s77 offen offset:1024 nt lds
    buffer_load_dwordx4 v250, s[52:55], s77 offen offset:2048 nt lds
    buffer_load_dwordx4 v251, s[52:55], s77 offen offset:3072 nt lds
    s_mov_b32 m0, 32768
    s_add_u32 s77, s82, 0
    buffer_load_dwordx4 v252, s[56:59], s77 offen offset:0 nt lds
    buffer_load_dwordx4 v252, s[56:59], s77 offen offset:1024 nt lds
    buffer_load_dwordx4 v252, s[56:59], s77 offen offset:2048 nt lds
    buffer_load_dwordx4 v252, s[56:59], s77 offen offset:3072 nt lds
    s_mov_b32 m0, 36864
    s_add_u32 s77, s82, 4096
    buffer_load_dwordx4 v252, s[56:59], s77 offen offset:0 nt lds
    buffer_load_dwordx4 v252, s[56:59], s77 offen offset:1024 nt lds
    buffer_load_dwordx4 v252, s[56:59], s77 offen offset:2048 nt lds
    buffer_load_dwordx4 v252, s[56:59], s77 offen offset:3072 nt lds
    s_mov_b32 m0, 8192
    s_add_u32 s77, s82, 8192
    buffer_load_dwordx4 v248, s[52:55], s77 offen offset:0 nt lds
    buffer_load_dwordx4 v249, s[52:55], s77 offen offset:1024 nt lds
    buffer_load_dwordx4 v250, s[52:55], s77 offen offset:2048 nt lds
    buffer_load_dwordx4 v251, s[52:55], s77 offen offset:3072 nt lds
    s_mov_b32 m0, 12288
    s_add_u32 s77, s82, 12288
    buffer_load_dwordx4 v248, s[52:55], s77 offen offset:0 nt lds
    buffer_load_dwordx4 v249, s[52:55], s77 offen offset:1024 nt lds
    buffer_load_dwordx4 v250, s[52:55], s77 offen offset:2048 nt lds
    buffer_load_dwordx4 v251, s[52:55], s77 offen offset:3072 nt lds
    s_waitcnt vmcnt(35)
    s_barrier
    s_mov_b32 m0, 40960
    s_add_u32 s77, s82, 8192
    buffer_load_dwordx4 v252, s[56:59], s77 offen offset:0 nt lds
    buffer_load_dwordx4 v252, s[56:59], s77 offen offset:1024 nt lds
    buffer_load_dwordx4 v252, s[56:59], s77 offen offset:2048 nt lds
    buffer_load_dwordx4 v252, s[56:59], s77 offen offset:3072 nt lds
    s_mov_b32 m0, 45056
    s_add_u32 s77, s82, 12288
    buffer_load_dwordx4 v252, s[56:59], s77 offen offset:0 nt lds
    buffer_load_dwordx4 v252, s[56:59], s77 offen offset:1024 nt lds
    buffer_load_dwordx4 v252, s[56:59], s77 offen offset:2048 nt lds
    buffer_load_dwordx4 v252, s[56:59], s77 offen offset:3072 nt lds
    s_mov_b32 m0, 16384
    s_add_u32 s77, s82, 16384
    buffer_load_dwordx4 v248, s[52:55], s77 offen offset:0 nt lds
    buffer_load_dwordx4 v249, s[52:55], s77 offen offset:1024 nt lds
    buffer_load_dwordx4 v250, s[52:55], s77 offen offset:2048 nt lds
    buffer_load_dwordx4 v251, s[52:55], s77 offen offset:3072 nt lds
    s_mov_b32 m0, 20480
    s_add_u32 s77, s82, 20480
    buffer_load_dwordx4 v248, s[52:55], s77 offen offset:0 nt lds
    buffer_load_dwordx4 v249, s[52:55], s77 offen offset:1024 nt lds
    buffer_load_dwordx4 v250, s[52:55], s77 offen offset:2048 nt lds
    buffer_load_dwordx4 v251, s[52:55], s77 offen offset:3072 nt lds
    s_waitcnt vmcnt(44)
    s_barrier
    s_mov_b32 m0, 49152
    s_add_u32 s77, s82, 16384
    buffer_load_dwordx4 v252, s[56:59], s77 offen offset:0 nt lds
    buffer_load_dwordx4 v252, s[56:59], s77 offen offset:1024 nt lds
    buffer_load_dwordx4 v252, s[56:59], s77 offen offset:2048 nt lds
    buffer_load_dwordx4 v252, s[56:59], s77 offen offset:3072 nt lds
    s_mov_b32 m0, 53248
    s_add_u32 s77, s82, 20480
    buffer_load_dwordx4 v252, s[56:59], s77 offen offset:0 nt lds
    buffer_load_dwordx4 v252, s[56:59], s77 offen offset:1024 nt lds
    buffer_load_dwordx4 v252, s[56:59], s77 offen offset:2048 nt lds
    buffer_load_dwordx4 v252, s[56:59], s77 offen offset:3072 nt lds
    s_mov_b32 m0, 24576
    s_add_u32 s77, s82, 24576
    buffer_load_dwordx4 v248, s[52:55], s77 offen offset:0 nt lds
    buffer_load_dwordx4 v249, s[52:55], s77 offen offset:1024 nt lds
    buffer_load_dwordx4 v250, s[52:55], s77 offen offset:2048 nt lds
    buffer_load_dwordx4 v251, s[52:55], s77 offen offset:3072 nt lds
    s_mov_b32 m0, 28672
    s_add_u32 s77, s82, 28672
    buffer_load_dwordx4 v248, s[52:55], s77 offen offset:0 nt lds
    buffer_load_dwordx4 v249, s[52:55], s77 offen offset:1024 nt lds
    buffer_load_dwordx4 v250, s[52:55], s77 offen offset:2048 nt lds
    buffer_load_dwordx4 v251, s[52:55], s77 offen offset:3072 nt lds
    s_waitcnt vmcnt(56)
    s_barrier
    s_waitcnt vmcnt(55)
    s_mov_b32 m0, 57344
    s_add_u32 s77, s82, 24576
    buffer_load_dwordx4 v252, s[56:59], s77 offen offset:0 nt lds
    buffer_load_dwordx4 v252, s[56:59], s77 offen offset:1024 nt lds
    buffer_load_dwordx4 v252, s[56:59], s77 offen offset:2048 nt lds
    buffer_load_dwordx4 v252, s[56:59], s77 offen offset:3072 nt lds
    s_mov_b32 m0, 61440
    s_add_u32 s77, s82, 28672
    buffer_load_dwordx4 v252, s[56:59], s77 offen offset:0 nt lds
    buffer_load_dwordx4 v252, s[56:59], s77 offen offset:1024 nt lds
    buffer_load_dwordx4 v252, s[56:59], s77 offen offset:2048 nt lds
    buffer_load_dwordx4 v252, s[56:59], s77 offen offset:3072 nt lds
    s_waitcnt vmcnt(56)
    s_barrier
    s_waitcnt vmcnt(40)
    s_barrier
    s_mov_b32 m0, 0
    s_add_u32 s77, s82, 32768
    buffer_load_dwordx4 v248, s[52:55], s77 offen offset:0 nt lds
    buffer_load_dwordx4 v249, s[52:55], s77 offen offset:1024 nt lds
    buffer_load_dwordx4 v250, s[52:55], s77 offen offset:2048 nt lds
    buffer_load_dwordx4 v251, s[52:55], s77 offen offset:3072 nt lds
    s_mov_b32 m0, 4096
    s_add_u32 s77, s82, 36864
    buffer_load_dwordx4 v248, s[52:55], s77 offen offset:0 nt lds
    buffer_load_dwordx4 v249, s[52:55], s77 offen offset:1024 nt lds
    buffer_load_dwordx4 v250, s[52:55], s77 offen offset:2048 nt lds
    buffer_load_dwordx4 v251, s[52:55], s77 offen offset:3072 nt lds
    s_waitcnt vmcnt(32)
    s_barrier
    s_mov_b32 m0, 32768
    s_add_u32 s77, s82, 32768
    buffer_load_dwordx4 v252, s[56:59], s77 offen offset:0 nt lds
    buffer_load_dwordx4 v252, s[56:59], s77 offen offset:1024 nt lds
    buffer_load_dwordx4 v252, s[56:59], s77 offen offset:2048 nt lds
    buffer_load_dwordx4 v252, s[56:59], s77 offen offset:3072 nt lds
    s_mov_b32 m0, 36864
    s_add_u32 s77, s82, 36864
    buffer_load_dwordx4 v252, s[56:59], s77 offen offset:0 nt lds
    buffer_load_dwordx4 v252, s[56:59], s77 offen offset:1024 nt lds
    buffer_load_dwordx4 v252, s[56:59], s77 offen offset:2048 nt lds
    buffer_load_dwordx4 v252, s[56:59], s77 offen offset:3072 nt lds
    s_mov_b32 m0, 8192
    s_add_u32 s77, s82, 40960
    buffer_load_dwordx4 v248, s[52:55], s77 offen offset:0 nt lds
    buffer_load_dwordx4 v249, s[52:55], s77 offen offset:1024 nt lds
    buffer_load_dwordx4 v250, s[52:55], s77 offen offset:2048 nt lds
    buffer_load_dwordx4 v251, s[52:55], s77 offen offset:3072 nt lds
    s_mov_b32 m0, 12288
    s_add_u32 s77, s82, 45056
    buffer_load_dwordx4 v248, s[52:55], s77 offen offset:0 nt lds
    buffer_load_dwordx4 v249, s[52:55], s77 offen offset:1024 nt lds
    buffer_load_dwordx4 v250, s[52:55], s77 offen offset:2048 nt lds
    buffer_load_dwordx4 v251, s[52:55], s77 offen offset:3072 nt lds
    s_waitcnt vmcnt(32)
    s_barrier
    s_mov_b32 m0, 40960
    s_add_u32 s77, s82, 40960
    buffer_load_dwordx4 v252, s[56:59], s77 offen offset:0 nt lds
    buffer_load_dwordx4 v252, s[56:59], s77 offen offset:1024 nt lds
    buffer_load_dwordx4 v252, s[56:59], s77 offen offset:2048 nt lds
    buffer_load_dwordx4 v252, s[56:59], s77 offen offset:3072 nt lds
    s_mov_b32 m0, 45056
    s_add_u32 s77, s82, 45056
    buffer_load_dwordx4 v252, s[56:59], s77 offen offset:0 nt lds
    buffer_load_dwordx4 v252, s[56:59], s77 offen offset:1024 nt lds
    buffer_load_dwordx4 v252, s[56:59], s77 offen offset:2048 nt lds
    buffer_load_dwordx4 v252, s[56:59], s77 offen offset:3072 nt lds
    s_mov_b32 m0, 16384
    s_add_u32 s77, s82, 49152
    buffer_load_dwordx4 v248, s[52:55], s77 offen offset:0 nt lds
    buffer_load_dwordx4 v249, s[52:55], s77 offen offset:1024 nt lds
    buffer_load_dwordx4 v250, s[52:55], s77 offen offset:2048 nt lds
    buffer_load_dwordx4 v251, s[52:55], s77 offen offset:3072 nt lds
    s_mov_b32 m0, 20480
    s_add_u32 s77, s82, 53248
    buffer_load_dwordx4 v248, s[52:55], s77 offen offset:0 nt lds
    buffer_load_dwordx4 v249, s[52:55], s77 offen offset:1024 nt lds
    buffer_load_dwordx4 v250, s[52:55], s77 offen offset:2048 nt lds
    buffer_load_dwordx4 v251, s[52:55], s77 offen offset:3072 nt lds
    s_waitcnt vmcnt(32)
    s_barrier
    s_mov_b32 m0, 49152
    s_add_u32 s77, s82, 49152
    buffer_load_dwordx4 v252, s[56:59], s77 offen offset:0 nt lds
    buffer_load_dwordx4 v252, s[56:59], s77 offen offset:1024 nt lds
    buffer_load_dwordx4 v252, s[56:59], s77 offen offset:2048 nt lds
    buffer_load_dwordx4 v252, s[56:59], s77 offen offset:3072 nt lds
    s_mov_b32 m0, 53248
    s_add_u32 s77, s82, 53248
    buffer_load_dwordx4 v252, s[56:59], s77 offen offset:0 nt lds
    buffer_load_dwordx4 v252, s[56:59], s77 offen offset:1024 nt lds
    buffer_load_dwordx4 v252, s[56:59], s77 offen offset:2048 nt lds
    buffer_load_dwordx4 v252, s[56:59], s77 offen offset:3072 nt lds
    s_mov_b32 m0, 24576
    s_add_u32 s77, s82, 57344
    buffer_load_dwordx4 v248, s[52:55], s77 offen offset:0 nt lds
    buffer_load_dwordx4 v249, s[52:55], s77 offen offset:1024 nt lds
    buffer_load_dwordx4 v250, s[52:55], s77 offen offset:2048 nt lds
    buffer_load_dwordx4 v251, s[52:55], s77 offen offset:3072 nt lds
    s_mov_b32 m0, 28672
    s_add_u32 s77, s82, 61440
    buffer_load_dwordx4 v248, s[52:55], s77 offen offset:0 nt lds
    buffer_load_dwordx4 v249, s[52:55], s77 offen offset:1024 nt lds
    buffer_load_dwordx4 v250, s[52:55], s77 offen offset:2048 nt lds
    buffer_load_dwordx4 v251, s[52:55], s77 offen offset:3072 nt lds
    s_waitcnt vmcnt(32)
    s_barrier
    s_mov_b32 m0, 57344
    s_add_u32 s77, s82, 57344
    buffer_load_dwordx4 v252, s[56:59], s77 offen offset:0 nt lds
    buffer_load_dwordx4 v252, s[56:59], s77 offen offset:1024 nt lds
    buffer_load_dwordx4 v252, s[56:59], s77 offen offset:2048 nt lds
    buffer_load_dwordx4 v252, s[56:59], s77 offen offset:3072 nt lds
    s_mov_b32 m0, 61440
    s_add_u32 s77, s82, 61440
    buffer_load_dwordx4 v252, s[56:59], s77 offen offset:0 nt lds
    buffer_load_dwordx4 v252, s[56:59], s77 offen offset:1024 nt lds
    buffer_load_dwordx4 v252, s[56:59], s77 offen offset:2048 nt lds
    buffer_load_dwordx4 v252, s[56:59], s77 offen offset:3072 nt lds
    s_mov_b32 m0, 0
    s_add_u32 s77, s82, 65536
    buffer_load_dwordx4 v248, s[52:55], s77 offen offset:0 nt lds
    buffer_load_dwordx4 v249, s[52:55], s77 offen offset:1024 nt lds
    buffer_load_dwordx4 v250, s[52:55], s77 offen offset:2048 nt lds
    buffer_load_dwordx4 v251, s[52:55], s77 offen offset:3072 nt lds
    s_mov_b32 m0, 4096
    s_add_u32 s77, s82, 69632
    buffer_load_dwordx4 v248, s[52:55], s77 offen offset:0 nt lds
    buffer_load_dwordx4 v249, s[52:55], s77 offen offset:1024 nt lds
    buffer_load_dwordx4 v250, s[52:55], s77 offen offset:2048 nt lds
    buffer_load_dwordx4 v251, s[52:55], s77 offen offset:3072 nt lds
    s_waitcnt vmcnt(32)
    s_barrier
    s_mov_b32 m0, 32768
    s_add_u32 s77, s82, 65536
    buffer_load_dwordx4 v252, s[56:59], s77 offen offset:0 nt lds
    buffer_load_dwordx4 v252, s[56:59], s77 offen offset:1024 nt lds
    buffer_load_dwordx4 v252, s[56:59], s77 offen offset:2048 nt lds
    buffer_load_dwordx4 v252, s[56:59], s77 offen offset:3072 nt lds
    s_mov_b32 m0, 36864
    s_add_u32 s77, s82, 69632
    buffer_load_dwordx4 v252, s[56:59], s77 offen offset:0 nt lds
    buffer_load_dwordx4 v252, s[56:59], s77 offen offset:1024 nt lds
    buffer_load_dwordx4 v252, s[56:59], s77 offen offset:2048 nt lds
    buffer_load_dwordx4 v252, s[56:59], s77 offen offset:3072 nt lds
    s_mov_b32 m0, 8192
    s_add_u32 s77, s82, 73728
    buffer_load_dwordx4 v248, s[52:55], s77 offen offset:0 nt lds
    buffer_load_dwordx4 v249, s[52:55], s77 offen offset:1024 nt lds
    buffer_load_dwordx4 v250, s[52:55], s77 offen offset:2048 nt lds
    buffer_load_dwordx4 v251, s[52:55], s77 offen offset:3072 nt lds
    s_mov_b32 m0, 12288
    s_add_u32 s77, s82, 77824
    buffer_load_dwordx4 v248, s[52:55], s77 offen offset:0 nt lds
    buffer_load_dwordx4 v249, s[52:55], s77 offen offset:1024 nt lds
    buffer_load_dwordx4 v250, s[52:55], s77 offen offset:2048 nt lds
    buffer_load_dwordx4 v251, s[52:55], s77 offen offset:3072 nt lds
    s_load_dword s76, s[38:39], 0
    s_waitcnt vmcnt(32)
    s_barrier
    s_mov_b32 m0, 40960
    s_add_u32 s77, s82, 73728
    buffer_load_dwordx4 v252, s[56:59], s77 offen offset:0 nt lds
    buffer_load_dwordx4 v252, s[56:59], s77 offen offset:1024 nt lds
    buffer_load_dwordx4 v252, s[56:59], s77 offen offset:2048 nt lds
    buffer_load_dwordx4 v252, s[56:59], s77 offen offset:3072 nt lds
    s_mov_b32 m0, 45056
    s_add_u32 s77, s82, 77824
    buffer_load_dwordx4 v252, s[56:59], s77 offen offset:0 nt lds
    buffer_load_dwordx4 v252, s[56:59], s77 offen offset:1024 nt lds
    buffer_load_dwordx4 v252, s[56:59], s77 offen offset:2048 nt lds
    buffer_load_dwordx4 v252, s[56:59], s77 offen offset:3072 nt lds
    s_mov_b32 m0, 16384
    s_add_u32 s77, s82, 81920
    buffer_load_dwordx4 v248, s[52:55], s77 offen offset:0 nt lds
    buffer_load_dwordx4 v249, s[52:55], s77 offen offset:1024 nt lds
    buffer_load_dwordx4 v250, s[52:55], s77 offen offset:2048 nt lds
    buffer_load_dwordx4 v251, s[52:55], s77 offen offset:3072 nt lds
    s_mov_b32 m0, 20480
    s_add_u32 s77, s82, 86016
    buffer_load_dwordx4 v248, s[52:55], s77 offen offset:0 nt lds
    buffer_load_dwordx4 v249, s[52:55], s77 offen offset:1024 nt lds
    buffer_load_dwordx4 v250, s[52:55], s77 offen offset:2048 nt lds
    buffer_load_dwordx4 v251, s[52:55], s77 offen offset:3072 nt lds
    s_waitcnt vmcnt(32)
    s_barrier
    s_mov_b32 m0, 49152
    s_add_u32 s77, s82, 81920
    buffer_load_dwordx4 v252, s[56:59], s77 offen offset:0 nt lds
    buffer_load_dwordx4 v252, s[56:59], s77 offen offset:1024 nt lds
    buffer_load_dwordx4 v252, s[56:59], s77 offen offset:2048 nt lds
    buffer_load_dwordx4 v252, s[56:59], s77 offen offset:3072 nt lds
    s_mov_b32 m0, 53248
    s_add_u32 s77, s82, 86016
    buffer_load_dwordx4 v252, s[56:59], s77 offen offset:0 nt lds
    buffer_load_dwordx4 v252, s[56:59], s77 offen offset:1024 nt lds
    buffer_load_dwordx4 v252, s[56:59], s77 offen offset:2048 nt lds
    buffer_load_dwordx4 v252, s[56:59], s77 offen offset:3072 nt lds
    s_mov_b32 m0, 24576
    s_add_u32 s77, s82, 90112
    buffer_load_dwordx4 v248, s[52:55], s77 offen offset:0 nt lds
    buffer_load_dwordx4 v249, s[52:55], s77 offen offset:1024 nt lds
    buffer_load_dwordx4 v250, s[52:55], s77 offen offset:2048 nt lds
    buffer_load_dwordx4 v251, s[52:55], s77 offen offset:3072 nt lds
    s_mov_b32 m0, 28672
    s_add_u32 s77, s82, 94208
    buffer_load_dwordx4 v248, s[52:55], s77 offen offset:0 nt lds
    buffer_load_dwordx4 v249, s[52:55], s77 offen offset:1024 nt lds
    buffer_load_dwordx4 v250, s[52:55], s77 offen offset:2048 nt lds
    buffer_load_dwordx4 v251, s[52:55], s77 offen offset:3072 nt lds
    s_waitcnt vmcnt(32)
    s_barrier
    s_mov_b32 m0, 57344
    s_add_u32 s77, s82, 90112
    buffer_load_dwordx4 v252, s[56:59], s77 offen offset:0 nt lds
    buffer_load_dwordx4 v252, s[56:59], s77 offen offset:1024 nt lds
    buffer_load_dwordx4 v252, s[56:59], s77 offen offset:2048 nt lds
    buffer_load_dwordx4 v252, s[56:59], s77 offen offset:3072 nt lds
    s_mov_b32 m0, 61440
    s_add_u32 s77, s82, 94208
    buffer_load_dwordx4 v252, s[56:59], s77 offen offset:0 nt lds
    buffer_load_dwordx4 v252, s[56:59], s77 offen offset:1024 nt lds
    buffer_load_dwordx4 v252, s[56:59], s77 offen offset:2048 nt lds
    buffer_load_dwordx4 v252, s[56:59], s77 offen offset:3072 nt lds
    s_mov_b32 m0, 0
    s_add_u32 s77, s82, 98304
    buffer_load_dwordx4 v248, s[52:55], s77 offen offset:0 nt lds
    buffer_load_dwordx4 v249, s[52:55], s77 offen offset:1024 nt lds
    buffer_load_dwordx4 v250, s[52:55], s77 offen offset:2048 nt lds
    buffer_load_dwordx4 v251, s[52:55], s77 offen offset:3072 nt lds
    s_mov_b32 m0, 4096
    s_add_u32 s77, s82, 102400
    buffer_load_dwordx4 v248, s[52:55], s77 offen offset:0 nt lds
    buffer_load_dwordx4 v249, s[52:55], s77 offen offset:1024 nt lds
    buffer_load_dwordx4 v250, s[52:55], s77 offen offset:2048 nt lds
    buffer_load_dwordx4 v251, s[52:55], s77 offen offset:3072 nt lds
    s_waitcnt vmcnt(32)
    s_barrier
    s_mov_b32 m0, 32768
    s_add_u32 s77, s82, 98304
    buffer_load_dwordx4 v252, s[56:59], s77 offen offset:0 nt lds
    buffer_load_dwordx4 v252, s[56:59], s77 offen offset:1024 nt lds
    buffer_load_dwordx4 v252, s[56:59], s77 offen offset:2048 nt lds
    buffer_load_dwordx4 v252, s[56:59], s77 offen offset:3072 nt lds
    s_mov_b32 m0, 36864
    s_add_u32 s77, s82, 102400
    buffer_load_dwordx4 v252, s[56:59], s77 offen offset:0 nt lds
    buffer_load_dwordx4 v252, s[56:59], s77 offen offset:1024 nt lds
    buffer_load_dwordx4 v252, s[56:59], s77 offen offset:2048 nt lds
    buffer_load_dwordx4 v252, s[56:59], s77 offen offset:3072 nt lds
    s_mov_b32 m0, 8192
    s_add_u32 s77, s82, 106496
    buffer_load_dwordx4 v248, s[52:55], s77 offen offset:0 nt lds
    buffer_load_dwordx4 v249, s[52:55], s77 offen offset:1024 nt lds
    buffer_load_dwordx4 v250, s[52:55], s77 offen offset:2048 nt lds
    buffer_load_dwordx4 v251, s[52:55], s77 offen offset:3072 nt lds
    s_mov_b32 m0, 12288
    s_add_u32 s77, s82, 110592
    buffer_load_dwordx4 v248, s[52:55], s77 offen offset:0 nt lds
    buffer_load_dwordx4 v249, s[52:55], s77 offen offset:1024 nt lds
    buffer_load_dwordx4 v250, s[52:55], s77 offen offset:2048 nt lds
    buffer_load_dwordx4 v251, s[52:55], s77 offen offset:3072 nt lds
    s_waitcnt vmcnt(32)
    s_barrier
    s_mov_b32 m0, 40960
    s_add_u32 s77, s82, 106496
    buffer_load_dwordx4 v252, s[56:59], s77 offen offset:0 nt lds
    buffer_load_dwordx4 v252, s[56:59], s77 offen offset:1024 nt lds
    buffer_load_dwordx4 v252, s[56:59], s77 offen offset:2048 nt lds
    buffer_load_dwordx4 v252, s[56:59], s77 offen offset:3072 nt lds
    s_mov_b32 m0, 45056
    s_add_u32 s77, s82, 110592
    buffer_load_dwordx4 v252, s[56:59], s77 offen offset:0 nt lds
    buffer_load_dwordx4 v252, s[56:59], s77 offen offset:1024 nt lds
    buffer_load_dwordx4 v252, s[56:59], s77 offen offset:2048 nt lds
    buffer_load_dwordx4 v252, s[56:59], s77 offen offset:3072 nt lds
    s_mov_b32 m0, 16384
    s_add_u32 s77, s82, 114688
    buffer_load_dwordx4 v248, s[52:55], s77 offen offset:0 nt lds
    buffer_load_dwordx4 v249, s[52:55], s77 offen offset:1024 nt lds
    buffer_load_dwordx4 v250, s[52:55], s77 offen offset:2048 nt lds
    buffer_load_dwordx4 v251, s[52:55], s77 offen offset:3072 nt lds
    s_mov_b32 m0, 20480
    s_add_u32 s77, s82, 118784
    buffer_load_dwordx4 v248, s[52:55], s77 offen offset:0 nt lds
    buffer_load_dwordx4 v249, s[52:55], s77 offen offset:1024 nt lds
    buffer_load_dwordx4 v250, s[52:55], s77 offen offset:2048 nt lds
    buffer_load_dwordx4 v251, s[52:55], s77 offen offset:3072 nt lds
    s_waitcnt vmcnt(32)
    s_barrier
    s_mov_b32 m0, 49152
    s_add_u32 s77, s82, 114688
    buffer_load_dwordx4 v252, s[56:59], s77 offen offset:0 nt lds
    buffer_load_dwordx4 v252, s[56:59], s77 offen offset:1024 nt lds
    buffer_load_dwordx4 v252, s[56:59], s77 offen offset:2048 nt lds
    buffer_load_dwordx4 v252, s[56:59], s77 offen offset:3072 nt lds
    s_mov_b32 m0, 53248
    s_add_u32 s77, s82, 118784
    buffer_load_dwordx4 v252, s[56:59], s77 offen offset:0 nt lds
    buffer_load_dwordx4 v252, s[56:59], s77 offen offset:1024 nt lds
    buffer_load_dwordx4 v252, s[56:59], s77 offen offset:2048 nt lds
    buffer_load_dwordx4 v252, s[56:59], s77 offen offset:3072 nt lds
    s_mov_b32 m0, 24576
    s_add_u32 s77, s82, 122880
    buffer_load_dwordx4 v248, s[52:55], s77 offen offset:0 nt lds
    buffer_load_dwordx4 v249, s[52:55], s77 offen offset:1024 nt lds
    buffer_load_dwordx4 v250, s[52:55], s77 offen offset:2048 nt lds
    buffer_load_dwordx4 v251, s[52:55], s77 offen offset:3072 nt lds
    s_mov_b32 m0, 28672
    s_add_u32 s77, s82, 126976
    buffer_load_dwordx4 v248, s[52:55], s77 offen offset:0 nt lds
    buffer_load_dwordx4 v249, s[52:55], s77 offen offset:1024 nt lds
    buffer_load_dwordx4 v250, s[52:55], s77 offen offset:2048 nt lds
    buffer_load_dwordx4 v251, s[52:55], s77 offen offset:3072 nt lds
    s_waitcnt vmcnt(32)
    s_barrier
    s_mov_b32 m0, 57344
    s_add_u32 s77, s82, 122880
    buffer_load_dwordx4 v252, s[56:59], s77 offen offset:0 nt lds
    buffer_load_dwordx4 v252, s[56:59], s77 offen offset:1024 nt lds
    buffer_load_dwordx4 v252, s[56:59], s77 offen offset:2048 nt lds
    buffer_load_dwordx4 v252, s[56:59], s77 offen offset:3072 nt lds
    s_mov_b32 m0, 61440
    s_add_u32 s77, s82, 126976
    buffer_load_dwordx4 v252, s[56:59], s77 offen offset:0 nt lds
    buffer_load_dwordx4 v252, s[56:59], s77 offen offset:1024 nt lds
    buffer_load_dwordx4 v252, s[56:59], s77 offen offset:2048 nt lds
    buffer_load_dwordx4 v252, s[56:59], s77 offen offset:3072 nt lds
    s_mov_b32 m0, 0
    s_add_u32 s77, s82, 131072
    buffer_load_dwordx4 v248, s[52:55], s77 offen offset:0 nt lds
    buffer_load_dwordx4 v249, s[52:55], s77 offen offset:1024 nt lds
    buffer_load_dwordx4 v250, s[52:55], s77 offen offset:2048 nt lds
    buffer_load_dwordx4 v251, s[52:55], s77 offen offset:3072 nt lds
    s_mov_b32 m0, 4096
    s_add_u32 s77, s82, 135168
    buffer_load_dwordx4 v248, s[52:55], s77 offen offset:0 nt lds
    buffer_load_dwordx4 v249, s[52:55], s77 offen offset:1024 nt lds
    buffer_load_dwordx4 v250, s[52:55], s77 offen offset:2048 nt lds
    buffer_load_dwordx4 v251, s[52:55], s77 offen offset:3072 nt lds
    s_waitcnt vmcnt(32)
    s_barrier
    s_mov_b32 m0, 32768
    s_add_u32 s77, s82, 131072
    buffer_load_dwordx4 v252, s[56:59], s77 offen offset:0 nt lds
    buffer_load_dwordx4 v252, s[56:59], s77 offen offset:1024 nt lds
    buffer_load_dwordx4 v252, s[56:59], s77 offen offset:2048 nt lds
    buffer_load_dwordx4 v252, s[56:59], s77 offen offset:3072 nt lds
    s_mov_b32 m0, 36864
    s_add_u32 s77, s82, 135168
    buffer_load_dwordx4 v252, s[56:59], s77 offen offset:0 nt lds
    buffer_load_dwordx4 v252, s[56:59], s77 offen offset:1024 nt lds
    buffer_load_dwordx4 v252, s[56:59], s77 offen offset:2048 nt lds
    buffer_load_dwordx4 v252, s[56:59], s77 offen offset:3072 nt lds
    s_mov_b32 m0, 8192
    s_add_u32 s77, s82, 139264
    buffer_load_dwordx4 v248, s[52:55], s77 offen offset:0 nt lds
    buffer_load_dwordx4 v249, s[52:55], s77 offen offset:1024 nt lds
    buffer_load_dwordx4 v250, s[52:55], s77 offen offset:2048 nt lds
    buffer_load_dwordx4 v251, s[52:55], s77 offen offset:3072 nt lds
    s_mov_b32 m0, 12288
    s_add_u32 s77, s82, 143360
    buffer_load_dwordx4 v248, s[52:55], s77 offen offset:0 nt lds
    buffer_load_dwordx4 v249, s[52:55], s77 offen offset:1024 nt lds
    buffer_load_dwordx4 v250, s[52:55], s77 offen offset:2048 nt lds
    buffer_load_dwordx4 v251, s[52:55], s77 offen offset:3072 nt lds
    s_waitcnt vmcnt(32)
    s_barrier
    s_mov_b32 m0, 40960
    s_add_u32 s77, s82, 139264
    buffer_load_dwordx4 v252, s[56:59], s77 offen offset:0 nt lds
    buffer_load_dwordx4 v252, s[56:59], s77 offen offset:1024 nt lds
    buffer_load_dwordx4 v252, s[56:59], s77 offen offset:2048 nt lds
    buffer_load_dwordx4 v252, s[56:59], s77 offen offset:3072 nt lds
    s_mov_b32 m0, 45056
    s_add_u32 s77, s82, 143360
    buffer_load_dwordx4 v252, s[56:59], s77 offen offset:0 nt lds
    buffer_load_dwordx4 v252, s[56:59], s77 offen offset:1024 nt lds
    buffer_load_dwordx4 v252, s[56:59], s77 offen offset:2048 nt lds
    buffer_load_dwordx4 v252, s[56:59], s77 offen offset:3072 nt lds
    s_mov_b32 m0, 16384
    s_add_u32 s77, s82, 147456
    buffer_load_dwordx4 v248, s[52:55], s77 offen offset:0 nt lds
    buffer_load_dwordx4 v249, s[52:55], s77 offen offset:1024 nt lds
    buffer_load_dwordx4 v250, s[52:55], s77 offen offset:2048 nt lds
    buffer_load_dwordx4 v251, s[52:55], s77 offen offset:3072 nt lds
    s_mov_b32 m0, 20480
    s_add_u32 s77, s82, 151552
    buffer_load_dwordx4 v248, s[52:55], s77 offen offset:0 nt lds
    buffer_load_dwordx4 v249, s[52:55], s77 offen offset:1024 nt lds
    buffer_load_dwordx4 v250, s[52:55], s77 offen offset:2048 nt lds
    buffer_load_dwordx4 v251, s[52:55], s77 offen offset:3072 nt lds
    s_waitcnt vmcnt(32)
    s_barrier
    s_mov_b32 m0, 49152
    s_add_u32 s77, s82, 147456
    buffer_load_dwordx4 v252, s[56:59], s77 offen offset:0 nt lds
    buffer_load_dwordx4 v252, s[56:59], s77 offen offset:1024 nt lds
    buffer_load_dwordx4 v252, s[56:59], s77 offen offset:2048 nt lds
    buffer_load_dwordx4 v252, s[56:59], s77 offen offset:3072 nt lds
    s_mov_b32 m0, 53248
    s_add_u32 s77, s82, 151552
    buffer_load_dwordx4 v252, s[56:59], s77 offen offset:0 nt lds
    buffer_load_dwordx4 v252, s[56:59], s77 offen offset:1024 nt lds
    buffer_load_dwordx4 v252, s[56:59], s77 offen offset:2048 nt lds
    buffer_load_dwordx4 v252, s[56:59], s77 offen offset:3072 nt lds
    s_mov_b32 m0, 24576
    s_add_u32 s77, s82, 155648
    buffer_load_dwordx4 v248, s[52:55], s77 offen offset:0 nt lds
    buffer_load_dwordx4 v249, s[52:55], s77 offen offset:1024 nt lds
    buffer_load_dwordx4 v250, s[52:55], s77 offen offset:2048 nt lds
    buffer_load_dwordx4 v251, s[52:55], s77 offen offset:3072 nt lds
    s_mov_b32 m0, 28672
    s_add_u32 s77, s82, 159744
    buffer_load_dwordx4 v248, s[52:55], s77 offen offset:0 nt lds
    buffer_load_dwordx4 v249, s[52:55], s77 offen offset:1024 nt lds
    buffer_load_dwordx4 v250, s[52:55], s77 offen offset:2048 nt lds
    buffer_load_dwordx4 v251, s[52:55], s77 offen offset:3072 nt lds
    s_waitcnt lgkmcnt(0)
    s_cmp_lg_u32 s76, 0
    s_cbranch_scc1 L_nok
    s_memrealtime s[16:17]
    v_mov_b32 v7, 0
    s_waitcnt lgkmcnt(0)
    s_or_b32 s16, s16, 1
    v_mov_b32 v6, s16
    s_mov_b64 exec, 1
    buffer_atomic_cmpswap v[6:7], off, s[72:75], 0 sc0 sc1
    s_mov_b64 exec, -1
    s_waitcnt vmcnt(0)
    v_readfirstlane_b32 s76, v6
    s_cmp_lg_u32 s76, 0
    s_cselect_b32 s76, s76, s16
L_nok:
    v_mov_b32 v6, 161792
    v_mov_b32 v7, s76
    ds_write_b32 v6, v7
    s_waitcnt lgkmcnt(0)
    s_waitcnt vmcnt(32)
    s_barrier
    s_mov_b32 m0, 57344
    s_add_u32 s77, s82, 155648
    buffer_load_dwordx4 v252, s[56:59], s77 offen offset:0 nt lds
    buffer_load_dwordx4 v252, s[56:59], s77 offen offset:1024 nt lds
    buffer_load_dwordx4 v252, s[56:59], s77 offen offset:2048 nt lds
    buffer_load_dwordx4 v252, s[56:59], s77 offen offset:3072 nt lds
    s_mov_b32 m0, 61440
    s_add_u32 s77, s82, 159744
    buffer_load_dwordx4 v252, s[56:59], s77 offen offset:0 nt lds
    buffer_load_dwordx4 v252, s[56:59], s77 offen offset:1024 nt lds
    buffer_load_dwordx4 v252, s[56:59], s77 offen offset:2048 nt lds
    buffer_load_dwordx4 v252, s[56:59], s77 offen offset:3072 nt lds
    s_mov_b32 m0, 0
    s_add_u32 s77, s82, 163840
    buffer_load_dwordx4 v248, s[52:55], s77 offen offset:0 nt lds
    buffer_load_dwordx4 v249, s[52:55], s77 offen offset:1024 nt lds
    buffer_load_dwordx4 v250, s[52:55], s77 offen offset:2048 nt lds
    buffer_load_dwordx4 v251, s[52:55], s77 offen offset:3072 nt lds
    s_mov_b32 m0, 4096
    s_add_u32 s77, s82, 167936
    buffer_load_dwordx4 v248, s[52:55], s77 offen offset:0 nt lds
    buffer_load_dwordx4 v249, s[52:55], s77 offen offset:1024 nt lds
    buffer_load_dwordx4 v250, s[52:55], s77 offen offset:2048 nt lds
    buffer_load_dwordx4 v251, s[52:55], s77 offen offset:3072 nt lds
    s_waitcnt vmcnt(32)
    s_barrier
    s_mov_b32 m0, 32768
    s_add_u32 s77, s82, 163840
    buffer_load_dwordx4 v252, s[56:59], s77 offen offset:0 nt lds
    buffer_load_dwordx4 v252, s[56:59], s77 offen offset:1024 nt lds
    buffer_load_dwordx4 v252, s[56:59], s77 offen offset:2048 nt lds
    buffer_load_dwordx4 v252, s[56:59], s77 offen offset:3072 nt lds
    s_mov_b32 m0, 36864
    s_add_u32 s77, s82, 167936
    buffer_load_dwordx4 v252, s[56:59], s77 offen offset:0 nt lds
    buffer_load_dwordx4 v252, s[56:59], s77 offen offset:1024 nt lds
    buffer_load_dwordx4 v252, s[56:59], s77 offen offset:2048 nt lds
    buffer_load_dwordx4 v252, s[56:59], s77 offen offset:3072 nt lds
    s_mov_b32 m0, 8192
    s_add_u32 s77, s82, 172032
    buffer_load_dwordx4 v248, s[52:55], s77 offen offset:0 nt lds
    buffer_load_dwordx4 v249, s[52:55], s77 offen offset:1024 nt lds
    buffer_load_dwordx4 v250, s[52:55], s77 offen offset:2048 nt lds
    buffer_load_dwordx4 v251, s[52:55], s77 offen offset:3072 nt lds
    s_mov_b32 m0, 12288
    s_add_u32 s77, s82, 176128
    buffer_load_dwordx4 v248, s[52:55], s77 offen offset:0 nt lds
    buffer_load_dwordx4 v249, s[52:55], s77 offen offset:1024 nt lds
    buffer_load_dwordx4 v250, s[52:55], s77 offen offset:2048 nt lds
    buffer_load_dwordx4 v251, s[52:55], s77 offen offset:3072 nt lds
    s_waitcnt vmcnt(32)
    s_barrier
    s_mov_b32 m0, 40960
    s_add_u32 s77, s82, 172032
    buffer_load_dwordx4 v252, s[56:59], s77 offen offset:0 nt lds
    buffer_load_dwordx4 v252, s[56:59], s77 offen offset:1024 nt lds
    buffer_load_dwordx4 v252, s[56:59], s77 offen offset:2048 nt lds
    buffer_load_dwordx4 v252, s[56:59], s77 offen offset:3072 nt lds
    s_mov_b32 m0, 45056
    s_add_u32 s77, s82, 176128
    buffer_load_dwordx4 v252, s[56:59], s77 offen offset:0 nt lds
    buffer_load_dwordx4 v252, s[56:59], s77 offen offset:1024 nt lds
    buffer_load_dwordx4 v252, s[56:59], s77 offen offset:2048 nt lds
    buffer_load_dwordx4 v252, s[56:59], s77 offen offset:3072 nt lds
    s_mov_b32 m0, 16384
    s_add_u32 s77, s82, 180224
    buffer_load_dwordx4 v248, s[52:55], s77 offen offset:0 nt lds
    buffer_load_dwordx4 v249, s[52:55], s77 offen offset:1024 nt lds
    buffer_load_dwordx4 v250, s[52:55], s77 offen offset:2048 nt lds
    buffer_load_dwordx4 v251, s[52:55], s77 offen offset:3072 nt lds
    s_mov_b32 m0, 20480
    s_add_u32 s77, s82, 184320
    buffer_load_dwordx4 v248, s[52:55], s77 offen offset:0 nt lds
    buffer_load_dwordx4 v249, s[52:55], s77 offen offset:1024 nt lds
    buffer_load_dwordx4 v250, s[52:55], s77 offen offset:2048 nt lds
    buffer_load_dwordx4 v251, s[52:55], s77 offen offset:3072 nt lds
    s_waitcnt vmcnt(32)
    s_barrier
    s_mov_b32 m0, 49152
    s_add_u32 s77, s82, 180224
    buffer_load_dwordx4 v252, s[56:59], s77 offen offset:0 nt lds
    buffer_load_dwordx4 v252, s[56:59], s77 offen offset:1024 nt lds
    buffer_load_dwordx4 v252, s[56:59], s77 offen offset:2048 nt lds
    buffer_load_dwordx4 v252, s[56:59], s77 offen offset:3072 nt lds
    s_mov_b32 m0, 53248
    s_add_u32 s77, s82, 184320
    buffer_load_dwordx4 v252, s[56:59], s77 offen offset:0 nt lds
    buffer_load_dwordx4 v252, s[56:59], s77 offen offset:1024 nt lds
    buffer_load_dwordx4 v252, s[56:59], s77 offen offset:2048 nt lds
    buffer_load_dwordx4 v252, s[56:59], s77 offen offset:3072 nt lds
    s_mov_b32 m0, 24576
    s_add_u32 s77, s82, 188416
    buffer_load_dwordx4 v248, s[52:55], s77 offen offset:0 nt lds
    buffer_load_dwordx4 v249, s[52:55], s77 offen offset:1024 nt lds
    buffer_load_dwordx4 v250, s[52:55], s77 offen offset:2048 nt lds
    buffer_load_dwordx4 v251, s[52:55], s77 offen offset:3072 nt lds
    s_mov_b32 m0, 28672
    s_add_u32 s77, s82, 192512
    buffer_load_dwordx4 v248, s[52:55], s77 offen offset:0 nt lds
    buffer_load_dwordx4 v249, s[52:55], s77 offen offset:1024 nt lds
    buffer_load_dwordx4 v250, s[52:55], s77 offen offset:2048 nt lds
    buffer_load_dwordx4 v251, s[52:55], s77 offen offset:3072 nt lds
    s_waitcnt vmcnt(32)
    s_barrier
    s_mov_b32 m0, 57344
    s_add_u32 s77, s82, 188416
    buffer_load_dwordx4 v252, s[56:59], s77 offen offset:0 nt lds
    buffer_load_dwordx4 v252, s[56:59], s77 offen offset:1024 nt lds
    buffer_load_dwordx4 v252, s[56:59], s77 offen offset:2048 nt lds
    buffer_load_dwordx4 v252, s[56:59], s77 offen offset:3072 nt lds
    s_mov_b32 m0, 61440
    s_add_u32 s77, s82, 192512
    buffer_load_dwordx4 v252, s[56:59], s77 offen offset:0 nt lds
    buffer_load_dwordx4 v252, s[56:59], s77 offen offset:1024 nt lds
    buffer_load_dwordx4 v252, s[56:59], s77 offen offset:2048 nt lds
    buffer_load_dwordx4 v252, s[56:59], s77 offen offset:3072 nt lds
    s_mov_b32 m0, 0
    s_add_u32 s77, s82, 196608
    buffer_load_dwordx4 v248, s[52:55], s77 offen offset:0 nt lds
    buffer_load_dwordx4 v249, s[52:55], s77 offen offset:1024 nt lds
    buffer_load_dwordx4 v250, s[52:55], s77 offen offset:2048 nt lds
    buffer_load_dwordx4 v251, s[52:55], s77 offen offset:3072 nt lds
    s_mov_b32 m0, 4096
    s_add_u32 s77, s82, 200704
    buffer_load_dwordx4 v248, s[52:55], s77 offen offset:0 nt lds
    buffer_load_dwordx4 v249, s[52:55], s77 offen offset:1024 nt lds
    buffer_load_dwordx4 v250, s[52:55], s77 offen offset:2048 nt lds
    buffer_load_dwordx4 v251, s[52:55], s77 offen offset:3072 nt lds
    s_waitcnt vmcnt(32)
    s_barrier
    s_mov_b32 m0, 32768
    s_add_u32 s77, s82, 196608
    buffer_load_dwordx4 v252, s[56:59], s77 offen offset:0 nt lds
    buffer_load_dwordx4 v252, s[56:59], s77 offen offset:1024 nt lds
    buffer_load_dwordx4 v252, s[56:59], s77 offen offset:2048 nt lds
    buffer_load_dwordx4 v252, s[56:59], s77 offen offset:3072 nt lds
    s_mov_b32 m0, 36864
    s_add_u32 s77, s82, 200704
    buffer_load_dwordx4 v252, s[56:59], s77 offen offset:0 nt lds
    buffer_load_dwordx4 v252, s[56:59], s77 offen offset:1024 nt lds
    buffer_load_dwordx4 v252, s[56:59], s77 offen offset:2048 nt lds
    buffer_load_dwordx4 v252, s[56:59], s77 offen offset:3072 nt lds
    s_mov_b32 m0, 8192
    s_add_u32 s77, s82, 204800
    buffer_load_dwordx4 v248, s[52:55], s77 offen offset:0 nt lds
    buffer_load_dwordx4 v249, s[52:55], s77 offen offset:1024 nt lds
    buffer_load_dwordx4 v250, s[52:55], s77 offen offset:2048 nt lds
    buffer_load_dwordx4 v251, s[52:55], s77 offen offset:3072 nt lds
    s_mov_b32 m0, 12288
    s_add_u32 s77, s82, 208896
    buffer_load_dwordx4 v248, s[52:55], s77 offen offset:0 nt lds
    buffer_load_dwordx4 v249, s[52:55], s77 offen offset:1024 nt lds
    buffer_load_dwordx4 v250, s[52:55], s77 offen offset:2048 nt lds
    buffer_load_dwordx4 v251, s[52:55], s77 offen offset:3072 nt lds
    s_waitcnt vmcnt(32)
    s_barrier
    s_mov_b32 m0, 40960
    s_add_u32 s77, s82, 204800
    buffer_load_dwordx4 v252, s[56:59], s77 offen offset:0 nt lds
    buffer_load_dwordx4 v252, s[56:59], s77 offen offset:1024 nt lds
    buffer_load_dwordx4 v252, s[56:59], s77 offen offset:2048 nt lds
    buffer_load_dwordx4 v252, s[56:59], s77 offen offset:3072 nt lds
    s_mov_b32 m0, 45056
    s_add_u32 s77, s82, 208896
    buffer_load_dwordx4 v252, s[56:59], s77 offen offset:0 nt lds
    buffer_load_dwordx4 v252, s[56:59], s77 offen offset:1024 nt lds
    buffer_load_dwordx4 v252, s[56:59], s77 offen offset:2048 nt lds
    buffer_load_dwordx4 v252, s[56:59], s77 offen offset:3072 nt lds
    s_mov_b32 m0, 16384
    s_add_u32 s77, s82, 212992
    buffer_load_dwordx4 v248, s[52:55], s77 offen offset:0 nt lds
    buffer_load_dwordx4 v249, s[52:55], s77 offen offset:1024 nt lds
    buffer_load_dwordx4 v250, s[52:55], s77 offen offset:2048 nt lds
    buffer_load_dwordx4 v251, s[52:55], s77 offen offset:3072 nt lds
    s_mov_b32 m0, 20480
    s_add_u32 s77, s82, 217088
    buffer_load_dwordx4 v248, s[52:55], s77 offen offset:0 nt lds
    buffer_load_dwordx4 v249, s[52:55], s77 offen offset:1024 nt lds
    buffer_load_dwordx4 v250, s[52:55], s77 offen offset:2048 nt lds
    buffer_load_dwordx4 v251, s[52:55], s77 offen offset:3072 nt lds
    s_waitcnt vmcnt(32)
    s_barrier
    s_mov_b32 m0, 49152
    s_add_u32 s77, s82, 212992
    buffer_load_dwordx4 v252, s[56:59], s77 offen offset:0 nt lds
    buffer_load_dwordx4 v252, s[56:59], s77 offen offset:1024 nt lds
    buffer_load_dwordx4 v252, s[56:59], s77 offen offset:2048 nt lds
    buffer_load_dwordx4 v252, s[56:59], s77 offen offset:3072 nt lds
    s_mov_b32 m0, 53248
    s_add_u32 s77, s82, 217088
    buffer_load_dwordx4 v252, s[56:59], s77 offen offset:0 nt lds
    buffer_load_dwordx4 v252, s[56:59], s77 offen offset:1024 nt lds
    buffer_load_dwordx4 v252, s[56:59], s77 offen offset:2048 nt lds
    buffer_load_dwordx4 v252, s[56:59], s77 offen offset:3072 nt lds
    s_mov_b32 m0, 24576
    s_add_u32 s77, s82, 221184
    buffer_load_dwordx4 v248, s[52:55], s77 offen offset:0 nt lds
    buffer_load_dwordx4 v249, s[52:55], s77 offen offset:1024 nt lds
    buffer_load_dwordx4 v250, s[52:55], s77 offen offset:2048 nt lds
    buffer_load_dwordx4 v251, s[52:55], s77 offen offset:3072 nt lds
    s_mov_b32 m0, 28672
    s_add_u32 s77, s82, 225280
    buffer_load_dwordx4 v248, s[52:55], s77 offen offset:0 nt lds
    buffer_load_dwordx4 v249, s[52:55], s77 offen offset:1024 nt lds
    buffer_load_dwordx4 v250, s[52:55], s77 offen offset:2048 nt lds
    buffer_load_dwordx4 v251, s[52:55], s77 offen offset:3072 nt lds
    s_waitcnt vmcnt(32)
    s_barrier
    s_mov_b32 m0, 57344
    s_add_u32 s77, s82, 221184
    buffer_load_dwordx4 v252, s[56:59], s77 offen offset:0 nt lds
    buffer_load_dwordx4 v252, s[56:59], s77 offen offset:1024 nt lds
    buffer_load_dwordx4 v252, s[56:59], s77 offen offset:2048 nt lds
    buffer_load_dwordx4 v252, s[56:59], s77 offen offset:3072 nt lds
    s_mov_b32 m0, 61440
    s_add_u32 s77, s82, 225280
    buffer_load_dwordx4 v252, s[56:59], s77 offen offset:0 nt lds
    buffer_load_dwordx4 v252, s[56:59], s77 offen offset:1024 nt lds
    buffer_load_dwordx4 v252, s[56:59], s77 offen offset:2048 nt lds
    buffer_load_dwordx4 v252, s[56:59], s77 offen offset:3072 nt lds
    s_mov_b32 m0, 0
    s_add_u32 s77, s82, 229376
    buffer_load_dwordx4 v248, s[52:55], s77 offen offset:0 nt lds
    buffer_load_dwordx4 v249, s[52:55], s77 offen offset:1024 nt lds
    buffer_load_dwordx4 v250, s[52:55], s77 offen offset:2048 nt lds
    buffer_load_dwordx4 v251, s[52:55], s77 offen offset:3072 nt lds
    s_mov_b32 m0, 4096
    s_add_u32 s77, s82, 233472
    buffer_load_dwordx4 v248, s[52:55], s77 offen offset:0 nt lds
    buffer_load_dwordx4 v249, s[52:55], s77 offen offset:1024 nt lds
    buffer_load_dwordx4 v250, s[52:55], s77 offen offset:2048 nt lds
    buffer_load_dwordx4 v251, s[52:55], s77 offen offset:3072 nt lds
    s_waitcnt vmcnt(32)
    s_barrier
    s_mov_b32 m0, 32768
    s_add_u32 s77, s82, 229376
    buffer_load_dwordx4 v252, s[56:59], s77 offen offset:0 nt lds
    buffer_load_dwordx4 v252, s[56:59], s77 offen offset:1024 nt lds
    buffer_load_dwordx4 v252, s[56:59], s77 offen offset:2048 nt lds
    buffer_load_dwordx4 v252, s[56:59], s77 offen offset:3072 nt lds
    s_mov_b32 m0, 36864
    s_add_u32 s77, s82, 233472
    buffer_load_dwordx4 v252, s[56:59], s77 offen offset:0 nt lds
    buffer_load_dwordx4 v252, s[56:59], s77 offen offset:1024 nt lds
    buffer_load_dwordx4 v252, s[56:59], s77 offen offset:2048 nt lds
    buffer_load_dwordx4 v252, s[56:59], s77 offen offset:3072 nt lds
    s_mov_b32 m0, 8192
    s_add_u32 s77, s82, 237568
    buffer_load_dwordx4 v248, s[52:55], s77 offen offset:0 nt lds
    buffer_load_dwordx4 v249, s[52:55], s77 offen offset:1024 nt lds
    buffer_load_dwordx4 v250, s[52:55], s77 offen offset:2048 nt lds
    buffer_load_dwordx4 v251, s[52:55], s77 offen offset:3072 nt lds
    s_mov_b32 m0, 12288
    s_add_u32 s77, s82, 241664
    buffer_load_dwordx4 v248, s[52:55], s77 offen offset:0 nt lds
    buffer_load_dwordx4 v249, s[52:55], s77 offen offset:1024 nt lds
    buffer_load_dwordx4 v250, s[52:55], s77 offen offset:2048 nt lds
    buffer_load_dwordx4 v251, s[52:55], s77 offen offset:3072 nt lds
    s_waitcnt vmcnt(32)
    s_barrier
    s_mov_b32 m0, 40960
    s_add_u32 s77, s82, 237568
    buffer_load_dwordx4 v252, s[56:59], s77 offen offset:0 nt lds
    buffer_load_dwordx4 v252, s[56:59], s77 offen offset:1024 nt lds
    buffer_load_dwordx4 v252, s[56:59], s77 offen offset:2048 nt lds
    buffer_load_dwordx4 v252, s[56:59], s77 offen offset:3072 nt lds
    s_mov_b32 m0, 45056
    s_add_u32 s77, s82, 241664
    buffer_load_dwordx4 v252, s[56:59], s77 offen offset:0 nt lds
    buffer_load_dwordx4 v252, s[56:59], s77 offen offset:1024 nt lds
    buffer_load_dwordx4 v252, s[56:59], s77 offen offset:2048 nt lds
    buffer_load_dwordx4 v252, s[56:59], s77 offen offset:3072 nt lds
    s_mov_b32 m0, 16384
    s_add_u32 s77, s82, 245760
    buffer_load_dwordx4 v248, s[52:55], s77 offen offset:0 nt lds
    buffer_load_dwordx4 v249, s[52:55], s77 offen offset:1024 nt lds
    buffer_load_dwordx4 v250, s[52:55], s77 offen offset:2048 nt lds
    buffer_load_dwordx4 v251, s[52:55], s77 offen offset:3072 nt lds
    s_mov_b32 m0, 20480
    s_add_u32 s77, s82, 249856
    buffer_load_dwordx4 v248, s[52:55], s77 offen offset:0 nt lds
    buffer_load_dwordx4 v249, s[52:55], s77 offen offset:1024 nt lds
    buffer_load_dwordx4 v250, s[52:55], s77 offen offset:2048 nt lds
    buffer_load_dwordx4 v251, s[52:55], s77 offen offset:3072 nt lds
    s_waitcnt vmcnt(32)
    s_barrier
    s_mov_b32 m0, 49152
    s_add_u32 s77, s82, 245760
    buffer_load_dwordx4 v252, s[56:59], s77 offen offset:0 nt lds
    buffer_load_dwordx4 v252, s[56:59], s77 offen offset:1024 nt lds
    buffer_load_dwordx4 v252, s[56:59], s77 offen offset:2048 nt lds
    buffer_load_dwordx4 v252, s[56:59], s77 offen offset:3072 nt lds
    s_mov_b32 m0, 53248
    s_add_u32 s77, s82, 249856
    buffer_load_dwordx4 v252, s[56:59], s77 offen offset:0 nt lds
    buffer_load_dwordx4 v252, s[56:59], s77 offen offset:1024 nt lds
    buffer_load_dwordx4 v252, s[56:59], s77 offen offset:2048 nt lds
    buffer_load_dwordx4 v252, s[56:59], s77 offen offset:3072 nt lds
    s_mov_b32 m0, 24576
    s_add_u32 s77, s82, 253952
    buffer_load_dwordx4 v248, s[52:55], s77 offen offset:0 nt lds
    buffer_load_dwordx4 v249, s[52:55], s77 offen offset:1024 nt lds
    buffer_load_dwordx4 v250, s[52:55], s77 offen offset:2048 nt lds
    buffer_load_dwordx4 v251, s[52:55], s77 offen offset:3072 nt lds
    s_mov_b32 m0, 28672
    s_add_u32 s77, s82, 258048
    buffer_load_dwordx4 v248, s[52:55], s77 offen offset:0 nt lds
    buffer_load_dwordx4 v249, s[52:55], s77 offen offset:1024 nt lds
    buffer_load_dwordx4 v250, s[52:55], s77 offen offset:2048 nt lds
    buffer_load_dwordx4 v251, s[52:55], s77 offen offset:3072 nt lds
    s_waitcnt vmcnt(32)
    s_barrier
    s_mov_b32 m0, 57344
    s_add_u32 s77, s82, 253952
    buffer_load_dwordx4 v252, s[56:59], s77 offen offset:0 nt lds
    buffer_load_dwordx4 v252, s[56:59], s77 offen offset:1024 nt lds
    buffer_load_dwordx4 v252, s[56:59], s77 offen offset:2048 nt lds
    buffer_load_dwordx4 v252, s[56:59], s77 offen offset:3072 nt lds
    s_mov_b32 m0, 61440
    s_add_u32 s77, s82, 258048
    buffer_load_dwordx4 v252, s[56:59], s77 offen offset:0 nt lds
    buffer_load_dwordx4 v252, s[56:59], s77 offen offset:1024 nt lds
    buffer_load_dwordx4 v252, s[56:59], s77 offen offset:2048 nt lds
    buffer_load_dwordx4 v252, s[56:59], s77 offen offset:3072 nt lds
    s_mov_b32 m0, 0
    s_add_u32 s77, s83, 0
    buffer_load_dwordx4 v248, s[52:55], s77 offen offset:0 nt lds
    buffer_load_dwordx4 v249, s[52:55], s77 offen offset:1024 nt lds
    buffer_load_dwordx4 v250, s[52:55], s77 offen offset:2048 nt lds
    buffer_load_dwordx4 v251, s[52:55], s77 offen offset:3072 nt lds
    s_mov_b32 m0, 4096
    s_add_u32 s77, s83, 4096
    buffer_load_dwordx4 v248, s[52:55], s77 offen offset:0 nt lds
    buffer_load_dwordx4 v249, s[52:55], s77 offen offset:1024 nt lds
    buffer_load_dwordx4 v250, s[52:55], s77 offen offset:2048 nt lds
    buffer_load_dwordx4 v251, s[52:55], s77 offen offset:3072 nt lds
    s_waitcnt vmcnt(32)
    s_barrier
    s_mov_b32 m0, 32768
    s_add_u32 s77, s83, 0
    buffer_load_dwordx4 v252, s[56:59], s77 offen offset:0 nt lds
    buffer_load_dwordx4 v252, s[56:59], s77 offen offset:1024 nt lds
    buffer_load_dwordx4 v252, s[56:59], s77 offen offset:2048 nt lds
    buffer_load_dwordx4 v252, s[56:59], s77 offen offset:3072 nt lds
    s_mov_b32 m0, 36864
    s_add_u32 s77, s83, 4096
    buffer_load_dwordx4 v252, s[56:59], s77 offen offset:0 nt lds
    buffer_load_dwordx4 v252, s[56:59], s77 offen offset:1024 nt lds
    buffer_load_dwordx4 v252, s[56:59], s77 offen offset:2048 nt lds
    buffer_load_dwordx4 v252, s[56:59], s77 offen offset:3072 nt lds
    s_mov_b32 m0, 8192
    s_add_u32 s77, s83, 8192
    buffer_load_dwordx4 v248, s[52:55], s77 offen offset:0 nt lds
    buffer_load_dwordx4 v249, s[52:55], s77 offen offset:1024 nt lds
    buffer_load_dwordx4 v250, s[52:55], s77 offen offset:2048 nt lds
    buffer_load_dwordx4 v251, s[52:55], s77 offen offset:3072 nt lds
    s_mov_b32 m0, 12288
    s_add_u32 s77, s83, 12288
    buffer_load_dwordx4 v248, s[52:55], s77 offen offset:0 nt lds
    buffer_load_dwordx4 v249, s[52:55], s77 offen offset:1024 nt lds
    buffer_load_dwordx4 v250, s[52:55], s77 offen offset:2048 nt lds
    buffer_load_dwordx4 v251, s[52:55], s77 offen offset:3072 nt lds
    s_waitcnt vmcnt(32)
    s_barrier
    s_mov_b32 m0, 40960
    s_add_u32 s77, s83, 8192
    buffer_load_dwordx4 v252, s[56:59], s77 offen offset:0 nt lds
    buffer_load_dwordx4 v252, s[56:59], s77 offen offset:1024 nt lds
    buffer_load_dwordx4 v252, s[56:59], s77 offen offset:2048 nt lds
    buffer_load_dwordx4 v252, s[56:59], s77 offen offset:3072 nt lds
    s_mov_b32 m0, 45056
    s_add_u32 s77, s83, 12288
    buffer_load_dwordx4 v252, s[56:59], s77 offen offset:0 nt lds
    buffer_load_dwordx4 v252, s[56:59], s77 offen offset:1024 nt lds
    buffer_load_dwordx4 v252, s[56:59], s77 offen offset:2048 nt lds
    buffer_load_dwordx4 v252, s[56:59], s77 offen offset:3072 nt lds
    s_mov_b32 m0, 16384
    s_add_u32 s77, s83, 16384
    buffer_load_dwordx4 v248, s[52:55], s77 offen offset:0 nt lds
    buffer_load_dwordx4 v249, s[52:55], s77 offen offset:1024 nt lds
    buffer_load_dwordx4 v250, s[52:55], s77 offen offset:2048 nt lds
    buffer_load_dwordx4 v251, s[52:55], s77 offen offset:3072 nt lds
    s_mov_b32 m0, 20480
    s_add_u32 s77, s83, 20480
    buffer_load_dwordx4 v248, s[52:55], s77 offen offset:0 nt lds
    buffer_load_dwordx4 v249, s[52:55], s77 offen offset:1024 nt lds
    buffer_load_dwordx4 v250, s[52:55], s77 offen offset:2048 nt lds
    buffer_load_dwordx4 v251, s[52:55], s77 offen offset:3072 nt lds
    s_waitcnt vmcnt(40)
    s_barrier
    s_mov_b32 m0, 49152
    s_add_u32 s77, s83, 16384
    buffer_load_dwordx4 v252, s[56:59], s77 offen offset:0 nt lds
    buffer_load_dwordx4 v252, s[56:59], s77 offen offset:1024 nt lds
    buffer_load_dwordx4 v252, s[56:59], s77 offen offset:2048 nt lds
    buffer_load_dwordx4 v252, s[56:59], s77 offen offset:3072 nt lds
    s_mov_b32 m0, 53248
    s_add_u32 s77, s83, 20480
    buffer_load_dwordx4 v252, s[56:59], s77 offen offset:0 nt lds
    buffer_load_dwordx4 v252, s[56:59], s77 offen offset:1024 nt lds
    buffer_load_dwordx4 v252, s[56:59], s77 offen offset:2048 nt lds
    buffer_load_dwordx4 v252, s[56:59], s77 offen offset:3072 nt lds
    s_mov_b32 m0, 24576
    s_add_u32 s77, s83, 24576
    buffer_load_dwordx4 v248, s[52:55], s77 offen offset:0 nt lds
    buffer_load_dwordx4 v249, s[52:55], s77 offen offset:1024 nt lds
    buffer_load_dwordx4 v250, s[52:55], s77 offen offset:2048 nt lds
    buffer_load_dwordx4 v251, s[52:55], s77 offen offset:3072 nt lds
    s_mov_b32 m0, 28672
    s_add_u32 s77, s83, 28672
    buffer_load_dwordx4 v248, s[52:55], s77 offen offset:0 nt lds
    buffer_load_dwordx4 v249, s[52:55], s77 offen offset:1024 nt lds
    buffer_load_dwordx4 v250, s[52:55], s77 offen offset:2048 nt lds
    buffer_load_dwordx4 v251, s[52:55], s77 offen offset:3072 nt lds
    s_barrier
    s_waitcnt vmcnt(55)
    s_mov_b32 m0, 57344
    s_add_u32 s77, s83, 24576
    buffer_load_dwordx4 v252, s[56:59], s77 offen offset:0 nt lds
    buffer_load_dwordx4 v252, s[56:59], s77 offen offset:1024 nt lds
    buffer_load_dwordx4 v252, s[56:59], s77 offen offset:2048 nt lds
    buffer_load_dwordx4 v252, s[56:59], s77 offen offset:3072 nt lds
    s_mov_b32 m0, 61440
    s_add_u32 s77, s83, 28672
    buffer_load_dwordx4 v252, s[56:59], s77 offen offset:0 nt lds
    buffer_load_dwordx4 v252, s[56:59], s77 offen offset:1024 nt lds
    buffer_load_dwordx4 v252, s[56:59], s77 offen offset:2048 nt lds
    buffer_load_dwordx4 v252, s[56:59], s77 offen offset:3072 nt lds
    s_waitcnt vmcnt(56)
    s_barrier
    s_waitcnt vmcnt(40)
    s_barrier
    s_mov_b32 m0, 0
    s_add_u32 s77, s83, 32768
    buffer_load_dwordx4 v248, s[52:55], s77 offen offset:0 nt lds
    buffer_load_dwordx4 v249, s[52:55], s77 offen offset:1024 nt lds
    buffer_load_dwordx4 v250, s[52:55], s77 offen offset:2048 nt lds
    buffer_load_dwordx4 v251, s[52:55], s77 offen offset:3072 nt lds
    s_mov_b32 m0, 4096
    s_add_u32 s77, s83, 36864
    buffer_load_dwordx4 v248, s[52:55], s77 offen offset:0 nt lds
    buffer_load_dwordx4 v249, s[52:55], s77 offen offset:1024 nt lds
    buffer_load_dwordx4 v250, s[52:55], s77 offen offset:2048 nt lds
    buffer_load_dwordx4 v251, s[52:55], s77 offen offset:3072 nt lds
    s_waitcnt vmcnt(32)
    s_barrier
    s_mov_b32 m0, 32768
    s_add_u32 s77, s83, 32768
    buffer_load_dwordx4 v252, s[56:59], s77 offen offset:0 nt lds
    buffer_load_dwordx4 v252, s[56:59], s77 offen offset:1024 nt lds
    buffer_load_dwordx4 v252, s[56:59], s77 offen offset:2048 nt lds
    buffer_load_dwordx4 v252, s[56:59], s77 offen offset:3072 nt lds
    s_mov_b32 m0, 36864
    s_add_u32 s77, s83, 36864
    buffer_load_dwordx4 v252, s[56:59], s77 offen offset:0 nt lds
    buffer_load_dwordx4 v252, s[56:59], s77 offen offset:1024 nt lds
    buffer_load_dwordx4 v252, s[56:59], s77 offen offset:2048 nt lds
    buffer_load_dwordx4 v252, s[56:59], s77 offen offset:3072 nt lds
    s_mov_b32 m0, 8192
    s_add_u32 s77, s83, 40960
    buffer_load_dwordx4 v248, s[52:55], s77 offen offset:0 nt lds
    buffer_load_dwordx4 v249, s[52:55], s77 offen offset:1024 nt lds
    buffer_load_dwordx4 v250, s[52:55], s77 offen offset:2048 nt lds
    buffer_load_dwordx4 v251, s[52:55], s77 offen offset:3072 nt lds
    s_mov_b32 m0, 12288
    s_add_u32 s77, s83, 45056
    buffer_load_dwordx4 v248, s[52:55], s77 offen offset:0 nt lds
    buffer_load_dwordx4 v249, s[52:55], s77 offen offset:1024 nt lds
    buffer_load_dwordx4 v250, s[52:55], s77 offen offset:2048 nt lds
    buffer_load_dwordx4 v251, s[52:55], s77 offen offset:3072 nt lds
    s_waitcnt vmcnt(32)
    s_barrier
    s_mov_b32 m0, 40960
    s_add_u32 s77, s83, 40960
    buffer_load_dwordx4 v252, s[56:59], s77 offen offset:0 nt lds
    buffer_load_dwordx4 v252, s[56:59], s77 offen offset:1024 nt lds
    buffer_load_dwordx4 v252, s[56:59], s77 offen offset:2048 nt lds
    buffer_load_dwordx4 v252, s[56:59], s77 offen offset:3072 nt lds
    s_mov_b32 m0, 45056
    s_add_u32 s77, s83, 45056
    buffer_load_dwordx4 v252, s[56:59], s77 offen offset:0 nt lds
    buffer_load_dwordx4 v252, s[56:59], s77 offen offset:1024 nt lds
    buffer_load_dwordx4 v252, s[56:59], s77 offen offset:2048 nt lds
    buffer_load_dwordx4 v252, s[56:59], s77 offen offset:3072 nt lds
    s_mov_b32 m0, 16384
    s_add_u32 s77, s83, 49152
    buffer_load_dwordx4 v248, s[52:55], s77 offen offset:0 nt lds
    buffer_load_dwordx4 v249, s[52:55], s77 offen offset:1024 nt lds
    buffer_load_dwordx4 v250, s[52:55], s77 offen offset:2048 nt lds
    buffer_load_dwordx4 v251, s[52:55], s77 offen offset:3072 nt lds
    s_mov_b32 m0, 20480
    s_add_u32 s77, s83, 53248
    buffer_load_dwordx4 v248, s[52:55], s77 offen offset:0 nt lds
    buffer_load_dwordx4 v249, s[52:55], s77 offen offset:1024 nt lds
    buffer_load_dwordx4 v250, s[52:55], s77 offen offset:2048 nt lds
    buffer_load_dwordx4 v251, s[52:55], s77 offen offset:3072 nt lds
    s_waitcnt vmcnt(32)
    s_barrier
    s_mov_b32 m0, 49152
    s_add_u32 s77, s83, 49152
    buffer_load_dwordx4 v252, s[56:59], s77 offen offset:0 nt lds
    buffer_load_dwordx4 v252, s[56:59], s77 offen offset:1024 nt lds
    buffer_load_dwordx4 v252, s[56:59], s77 offen offset:2048 nt lds
    buffer_load_dwordx4 v252, s[56:59], s77 offen offset:3072 nt lds
    s_mov_b32 m0, 53248
    s_add_u32 s77, s83, 53248
    buffer_load_dwordx4 v252, s[56:59], s77 offen offset:0 nt lds
    buffer_load_dwordx4 v252, s[56:59], s77 offen offset:1024 nt lds
    buffer_load_dwordx4 v252, s[56:59], s77 offen offset:2048 nt lds
    buffer_load_dwordx4 v252, s[56:59], s77 offen offset:3072 nt lds
    s_mov_b32 m0, 24576
    s_add_u32 s77, s83, 57344
    buffer_load_dwordx4 v248, s[52:55], s77 offen offset:0 nt lds
    buffer_load_dwordx4 v249, s[52:55], s77 offen offset:1024 nt lds
    buffer_load_dwordx4 v250, s[52:55], s77 offen offset:2048 nt lds
    buffer_load_dwordx4 v251, s[52:55], s77 offen offset:3072 nt lds
    s_mov_b32 m0, 28672
    s_add_u32 s77, s83, 61440
    buffer_load_dwordx4 v248, s[52:55], s77 offen offset:0 nt lds
    buffer_load_dwordx4 v249, s[52:55], s77 offen offset:1024 nt lds
    buffer_load_dwordx4 v250, s[52:55], s77 offen offset:2048 nt lds
    buffer_load_dwordx4 v251, s[52:55], s77 offen offset:3072 nt lds
    s_waitcnt vmcnt(32)
    s_barrier
    s_mov_b32 m0, 57344
    s_add_u32 s77, s83, 57344
    buffer_load_dwordx4 v252, s[56:59], s77 offen offset:0 nt lds
    buffer_load_dwordx4 v252, s[56:59], s77 offen offset:1024 nt lds
    buffer_load_dwordx4 v252, s[56:59], s77 offen offset:2048 nt lds
    buffer_load_dwordx4 v252, s[56:59], s77 offen offset:3072 nt lds
    s_mov_b32 m0, 61440
    s_add_u32 s77, s83, 61440
    buffer_load_dwordx4 v252, s[56:59], s77 offen offset:0 nt lds
    buffer_load_dwordx4 v252, s[56:59], s77 offen offset:1024 nt lds
    buffer_load_dwordx4 v252, s[56:59], s77 offen offset:2048 nt lds
    buffer_load_dwordx4 v252, s[56:59], s77 offen offset:3072 nt lds
    s_mov_b32 m0, 0
    s_add_u32 s77, s83, 65536
    buffer_load_dwordx4 v248, s[52:55], s77 offen offset:0 nt lds
    buffer_load_dwordx4 v249, s[52:55], s77 offen offset:1024 nt lds
    buffer_load_dwordx4 v250, s[52:55], s77 offen offset:2048 nt lds
    buffer_load_dwordx4 v251, s[52:55], s77 offen offset:3072 nt lds
    s_mov_b32 m0, 4096
    s_add_u32 s77, s83, 69632
    buffer_load_dwordx4 v248, s[52:55], s77 offen offset:0 nt lds
    buffer_load_dwordx4 v249, s[52:55], s77 offen offset:1024 nt lds
    buffer_load_dwordx4 v250, s[52:55], s77 offen offset:2048 nt lds
    buffer_load_dwordx4 v251, s[52:55], s77 offen offset:3072 nt lds
    s_waitcnt vmcnt(32)
    s_barrier
    s_mov_b32 m0, 32768
    s_add_u32 s77, s83, 65536
    buffer_load_dwordx4 v252, s[56:59], s77 offen offset:0 nt lds
    buffer_load_dwordx4 v252, s[56:59], s77 offen offset:1024 nt lds
    buffer_load_dwordx4 v252, s[56:59], s77 offen offset:2048 nt lds
    buffer_load_dwordx4 v252, s[56:59], s77 offen offset:3072 nt lds
    s_mov_b32 m0, 36864
    s_add_u32 s77, s83, 69632
    buffer_load_dwordx4 v252, s[56:59], s77 offen offset:0 nt lds
    buffer_load_dwordx4 v252, s[56:59], s77 offen offset:1024 nt lds
    buffer_load_dwordx4 v252, s[56:59], s77 offen offset:2048 nt lds
    buffer_load_dwordx4 v252, s[56:59], s77 offen offset:3072 nt lds
    s_mov_b32 m0, 8192
    s_add_u32 s77, s83, 73728
    buffer_load_dwordx4 v248, s[52:55], s77 offen offset:0 nt lds
    buffer_load_dwordx4 v249, s[52:55], s77 offen offset:1024 nt lds
    buffer_load_dwordx4 v250, s[52:55], s77 offen offset:2048 nt lds
    buffer_load_dwordx4 v251, s[52:55], s77 offen offset:3072 nt lds
    s_mov_b32 m0, 12288
    s_add_u32 s77, s83, 77824
    buffer_load_dwordx4 v248, s[52:55], s77 offen offset:0 nt lds
    buffer_load_dwordx4 v249, s[52:55], s77 offen offset:1024 nt lds
    buffer_load_dwordx4 v250, s[52:55], s77 offen offset:2048 nt lds
    buffer_load_dwordx4 v251, s[52:55], s77 offen offset:3072 nt lds
    s_waitcnt vmcnt(32)
    s_barrier
    s_mov_b32 m0, 40960
    s_add_u32 s77, s83, 73728
    buffer_load_dwordx4 v252, s[56:59], s77 offen offset:0 nt lds
    buffer_load_dwordx4 v252, s[56:59], s77 offen offset:1024 nt lds
    buffer_load_dwordx4 v252, s[56:59], s77 offen offset:2048 nt lds
    buffer_load_dwordx4 v252, s[56:59], s77 offen offset:3072 nt lds
    s_mov_b32 m0, 45056
    s_add_u32 s77, s83, 77824
    buffer_load_dwordx4 v252, s[56:59], s77 offen offset:0 nt lds
    buffer_load_dwordx4 v252, s[56:59], s77 offen offset:1024 nt lds
    buffer_load_dwordx4 v252, s[56:59], s77 offen offset:2048 nt lds
    buffer_load_dwordx4 v252, s[56:59], s77 offen offset:3072 nt lds
    s_mov_b32 m0, 16384
    s_add_u32 s77, s83, 81920
    buffer_load_dwordx4 v248, s[52:55], s77 offen offset:0 nt lds
    buffer_load_dwordx4 v249, s[52:55], s77 offen offset:1024 nt lds
    buffer_load_dwordx4 v250, s[52:55], s77 offen offset:2048 nt lds
    buffer_load_dwordx4 v251, s[52:55], s77 offen offset:3072 nt lds
    s_mov_b32 m0, 20480
    s_add_u32 s77, s83, 86016
    buffer_load_dwordx4 v248, s[52:55], s77 offen offset:0 nt lds
    buffer_load_dwordx4 v249, s[52:55], s77 offen offset:1024 nt lds
    buffer_load_dwordx4 v250, s[52:55], s77 offen offset:2048 nt lds
    buffer_load_dwordx4 v251, s[52:55], s77 offen offset:3072 nt lds
    s_waitcnt vmcnt(32)
    s_barrier
    s_mov_b32 m0, 49152
    s_add_u32 s77, s83, 81920
    buffer_load_dwordx4 v252, s[56:59], s77 offen offset:0 nt lds
    buffer_load_dwordx4 v252, s[56:59], s77 offen offset:1024 nt lds
    buffer_load_dwordx4 v252, s[56:59], s77 offen offset:2048 nt lds
    buffer_load_dwordx4 v252, s[56:59], s77 offen offset:3072 nt lds
    s_mov_b32 m0, 53248
    s_add_u32 s77, s83, 86016
    buffer_load_dwordx4 v252, s[56:59], s77 offen offset:0 nt lds
    buffer_load_dwordx4 v252, s[56:59], s77 offen offset:1024 nt lds
    buffer_load_dwordx4 v252, s[56:59], s77 offen offset:2048 nt lds
    buffer_load_dwordx4 v252, s[56:59], s77 offen offset:3072 nt lds
    s_mov_b32 m0, 24576
    s_add_u32 s77, s83, 90112
    buffer_load_dwordx4 v248, s[52:55], s77 offen offset:0 nt lds
    buffer_load_dwordx4 v249, s[52:55], s77 offen offset:1024 nt lds
    buffer_load_dwordx4 v250, s[52:55], s77 offen offset:2048 nt lds
    buffer_load_dwordx4 v251, s[52:55], s77 offen offset:3072 nt lds
    s_mov_b32 m0, 28672
    s_add_u32 s77, s83, 94208
    buffer_load_dwordx4 v248, s[52:55], s77 offen offset:0 nt lds
    buffer_load_dwordx4 v249, s[52:55], s77 offen offset:1024 nt lds
    buffer_load_dwordx4 v250, s[52:55], s77 offen offset:2048 nt lds
    buffer_load_dwordx4 v251, s[52:55], s77 offen offset:3072 nt lds
    s_waitcnt vmcnt(32)
    s_barrier
    s_mov_b32 m0, 57344
    s_add_u32 s77, s83, 90112
    buffer_load_dwordx4 v252, s[56:59], s77 offen offset:0 nt lds
    buffer_load_dwordx4 v252, s[56:59], s77 offen offset:1024 nt lds
    buffer_load_dwordx4 v252, s[56:59], s77 offen offset:2048 nt lds
    buffer_load_dwordx4 v252, s[56:59], s77 offen offset:3072 nt lds
    s_mov_b32 m0, 61440
    s_add_u32 s77, s83, 94208
    buffer_load_dwordx4 v252, s[56:59], s77 offen offset:0 nt lds
    buffer_load_dwordx4 v252, s[56:59], s77 offen offset:1024 nt lds
    buffer_load_dwordx4 v252, s[56:59], s77 offen offset:2048 nt lds
    buffer_load_dwordx4 v252, s[56:59], s77 offen offset:3072 nt lds
    s_mov_b32 m0, 0
    s_add_u32 s77, s83, 98304
    buffer_load_dwordx4 v248, s[52:55], s77 offen offset:0 nt lds
    buffer_load_dwordx4 v249, s[52:55], s77 offen offset:1024 nt lds
    buffer_load_dwordx4 v250, s[52:55], s77 offen offset:2048 nt lds
    buffer_load_dwordx4 v251, s[52:55], s77 offen offset:3072 nt lds
    s_mov_b32 m0, 4096
    s_add_u32 s77, s83, 102400
    buffer_load_dwordx4 v248, s[52:55], s77 offen offset:0 nt lds
    buffer_load_dwordx4 v249, s[52:55], s77 offen offset:1024 nt lds
    buffer_load_dwordx4 v250, s[52:55], s77 offen offset:2048 nt lds
    buffer_load_dwordx4 v251, s[52:55], s77 offen offset:3072 nt lds
    s_waitcnt vmcnt(32)
    s_barrier
    s_mov_b32 m0, 32768
    s_add_u32 s77, s83, 98304
    buffer_load_dwordx4 v252, s[56:59], s77 offen offset:0 nt lds
    buffer_load_dwordx4 v252, s[56:59], s77 offen offset:1024 nt lds
    buffer_load_dwordx4 v252, s[56:59], s77 offen offset:2048 nt lds
    buffer_load_dwordx4 v252, s[56:59], s77 offen offset:3072 nt lds
    s_mov_b32 m0, 36864
    s_add_u32 s77, s83, 102400
    buffer_load_dwordx4 v252, s[56:59], s77 offen offset:0 nt lds
    buffer_load_dwordx4 v252, s[56:59], s77 offen offset:1024 nt lds
    buffer_load_dwordx4 v252, s[56:59], s77 offen offset:2048 nt lds
    buffer_load_dwordx4 v252, s[56:59], s77 offen offset:3072 nt lds
    s_mov_b32 m0, 8192
    s_add_u32 s77, s83, 106496
    buffer_load_dwordx4 v248, s[52:55], s77 offen offset:0 nt lds
    buffer_load_dwordx4 v249, s[52:55], s77 offen offset:1024 nt lds
    buffer_load_dwordx4 v250, s[52:55], s77 offen offset:2048 nt lds
    buffer_load_dwordx4 v251, s[52:55], s77 offen offset:3072 nt lds
    s_mov_b32 m0, 12288
    s_add_u32 s77, s83, 110592
    buffer_load_dwordx4 v248, s[52:55], s77 offen offset:0 nt lds
    buffer_load_dwordx4 v249, s[52:55], s77 offen offset:1024 nt lds
    buffer_load_dwordx4 v250, s[52:55], s77 offen offset:2048 nt lds
    buffer_load_dwordx4 v251, s[52:55], s77 offen offset:3072 nt lds
    s_waitcnt vmcnt(32)
    s_barrier
    s_mov_b32 m0, 40960
    s_add_u32 s77, s83, 106496
    buffer_load_dwordx4 v252, s[56:59], s77 offen offset:0 nt lds
    buffer_load_dwordx4 v252, s[56:59], s77 offen offset:1024 nt lds
    buffer_load_dwordx4 v252, s[56:59], s77 offen offset:2048 nt lds
    buffer_load_dwordx4 v252, s[56:59], s77 offen offset:3072 nt lds
    s_mov_b32 m0, 45056
    s_add_u32 s77, s83, 110592
    buffer_load_dwordx4 v252, s[56:59], s77 offen offset:0 nt lds
    buffer_load_dwordx4 v252, s[56:59], s77 offen offset:1024 nt lds
    buffer_load_dwordx4 v252, s[56:59], s77 offen offset:2048 nt lds
    buffer_load_dwordx4 v252, s[56:59], s77 offen offset:3072 nt lds
    s_mov_b32 m0, 16384
    s_add_u32 s77, s83, 114688
    buffer_load_dwordx4 v248, s[52:55], s77 offen offset:0 nt lds
    buffer_load_dwordx4 v249, s[52:55], s77 offen offset:1024 nt lds
    buffer_load_dwordx4 v250, s[52:55], s77 offen offset:2048 nt lds
    buffer_load_dwordx4 v251, s[52:55], s77 offen offset:3072 nt lds
    s_mov_b32 m0, 20480
    s_add_u32 s77, s83, 118784
    buffer_load_dwordx4 v248, s[52:55], s77 offen offset:0 nt lds
    buffer_load_dwordx4 v249, s[52:55], s77 offen offset:1024 nt lds
    buffer_load_dwordx4 v250, s[52:55], s77 offen offset:2048 nt lds
    buffer_load_dwordx4 v251, s[52:55], s77 offen offset:3072 nt lds
    s_waitcnt vmcnt(32)
    s_barrier
    s_mov_b32 m0, 49152
    s_add_u32 s77, s83, 114688
    buffer_load_dwordx4 v252, s[56:59], s77 offen offset:0 nt lds
    buffer_load_dwordx4 v252, s[56:59], s77 offen offset:1024 nt lds
    buffer_load_dwordx4 v252, s[56:59], s77 offen offset:2048 nt lds
    buffer_load_dwordx4 v252, s[56:59], s77 offen offset:3072 nt lds
    s_mov_b32 m0, 53248
    s_add_u32 s77, s83, 118784
    buffer_load_dwordx4 v252, s[56:59], s77 offen offset:0 nt lds
    buffer_load_dwordx4 v252, s[56:59], s77 offen offset:1024 nt lds
    buffer_load_dwordx4 v252, s[56:59], s77 offen offset:2048 nt lds
    buffer_load_dwordx4 v252, s[56:59], s77 offen offset:3072 nt lds
    s_mov_b32 m0, 24576
    s_add_u32 s77, s83, 122880
    buffer_load_dwordx4 v248, s[52:55], s77 offen offset:0 nt lds
    buffer_load_dwordx4 v249, s[52:55], s77 offen offset:1024 nt lds
    buffer_load_dwordx4 v250, s[52:55], s77 offen offset:2048 nt lds
    buffer_load_dwordx4 v251, s[52:55], s77 offen offset:3072 nt lds
    s_mov_b32 m0, 28672
    s_add_u32 s77, s83, 126976
    buffer_load_dwordx4 v248, s[52:55], s77 offen offset:0 nt lds
    buffer_load_dwordx4 v249, s[52:55], s77 offen offset:1024 nt lds
    buffer_load_dwordx4 v250, s[52:55], s77 offen offset:2048 nt lds
    buffer_load_dwordx4 v251, s[52:55], s77 offen offset:3072 nt lds
    s_waitcnt vmcnt(32)
    s_barrier
    s_mov_b32 m0, 57344
    s_add_u32 s77, s83, 122880
    buffer_load_dwordx4 v252, s[56:59], s77 offen offset:0 nt lds
    buffer_load_dwordx4 v252, s[56:59], s77 offen offset:1024 nt lds
    buffer_load_dwordx4 v252, s[56:59], s77 offen offset:2048 nt lds
    buffer_load_dwordx4 v252, s[56:59], s77 offen offset:3072 nt lds
    s_mov_b32 m0, 61440
    s_add_u32 s77, s83, 126976
    buffer_load_dwordx4 v252, s[56:59], s77 offen offset:0 nt lds
    buffer_load_dwordx4 v252, s[56:59], s77 offen offset:1024 nt lds
    buffer_load_dwordx4 v252, s[56:59], s77 offen offset:2048 nt lds
    buffer_load_dwordx4 v252, s[56:59], s77 offen offset:3072 nt lds
    s_mov_b32 m0, 0
    s_add_u32 s77, s83, 131072
    buffer_load_dwordx4 v248, s[52:55], s77 offen offset:0 nt lds
    buffer_load_dwordx4 v249, s[52:55], s77 offen offset:1024 nt lds
    buffer_load_dwordx4 v250, s[52:55], s77 offen offset:2048 nt lds
    buffer_load_dwordx4 v251, s[52:55], s77 offen offset:3072 nt lds
    s_mov_b32 m0, 4096
    s_add_u32 s77, s83, 135168
    buffer_load_dwordx4 v248, s[52:55], s77 offen offset:0 nt lds
    buffer_load_dwordx4 v249, s[52:55], s77 offen offset:1024 nt lds
    buffer_load_dwordx4 v250, s[52:55], s77 offen offset:2048 nt lds
    buffer_load_dwordx4 v251, s[52:55], s77 offen offset:3072 nt lds
    s_waitcnt vmcnt(32)
    s_barrier
    s_mov_b32 m0, 32768
    s_add_u32 s77, s83, 131072
    buffer_load_dwordx4 v252, s[56:59], s77 offen offset:0 nt lds
    buffer_load_dwordx4 v252, s[56:59], s77 offen offset:1024 nt lds
    buffer_load_dwordx4 v252, s[56:59], s77 offen offset:2048 nt lds
    buffer_load_dwordx4 v252, s[56:59], s77 offen offset:3072 nt lds
    s_mov_b32 m0, 36864
    s_add_u32 s77, s83, 135168
    buffer_load_dwordx4 v252, s[56:59], s77 offen offset:0 nt lds
    buffer_load_dwordx4 v252, s[56:59], s77 offen offset:1024 nt lds
    buffer_load_dwordx4 v252, s[56:59], s77 offen offset:2048 nt lds
    buffer_load_dwordx4 v252, s[56:59], s77 offen offset:3072 nt lds
    s_mov_b32 m0, 8192
    s_add_u32 s77, s83, 139264
    buffer_load_dwordx4 v248, s[52:55], s77 offen offset:0 nt lds
    buffer_load_dwordx4 v249, s[52:55], s77 offen offset:1024 nt lds
    buffer_load_dwordx4 v250, s[52:55], s77 offen offset:2048 nt lds
    buffer_load_dwordx4 v251, s[52:55], s77 offen offset:3072 nt lds
    s_mov_b32 m0, 12288
    s_add_u32 s77, s83, 143360
    buffer_load_dwordx4 v248, s[52:55], s77 offen offset:0 nt lds
    buffer_load_dwordx4 v249, s[52:55], s77 offen offset:1024 nt lds
    buffer_load_dwordx4 v250, s[52:55], s77 offen offset:2048 nt lds
    buffer_load_dwordx4 v251, s[52:55], s77 offen offset:3072 nt lds
    s_waitcnt vmcnt(32)
    s_barrier
    s_mov_b32 m0, 40960
    s_add_u32 s77, s83, 139264
    buffer_load_dwordx4 v252, s[56:59], s77 offen offset:0 nt lds
    buffer_load_dwordx4 v252, s[56:59], s77 offen offset:1024 nt lds
    buffer_load_dwordx4 v252, s[56:59], s77 offen offset:2048 nt lds
    buffer_load_dwordx4 v252, s[56:59], s77 offen offset:3072 nt lds
    s_mov_b32 m0, 45056
    s_add_u32 s77, s83, 143360
    buffer_load_dwordx4 v252, s[56:59], s77 offen offset:0 nt lds
    buffer_load_dwordx4 v252, s[56:59], s77 offen offset:1024 nt lds
    buffer_load_dwordx4 v252, s[56:59], s77 offen offset:2048 nt lds
    buffer_load_dwordx4 v252, s[56:59], s77 offen offset:3072 nt lds
    s_mov_b32 m0, 16384
    s_add_u32 s77, s83, 147456
    buffer_load_dwordx4 v248, s[52:55], s77 offen offset:0 nt lds
    buffer_load_dwordx4 v249, s[52:55], s77 offen offset:1024 nt lds
    buffer_load_dwordx4 v250, s[52:55], s77 offen offset:2048 nt lds
    buffer_load_dwordx4 v251, s[52:55], s77 offen offset:3072 nt lds
    s_mov_b32 m0, 20480
    s_add_u32 s77, s83, 151552
    buffer_load_dwordx4 v248, s[52:55], s77 offen offset:0 nt lds
    buffer_load_dwordx4 v249, s[52:55], s77 offen offset:1024 nt lds
    buffer_load_dwordx4 v250, s[52:55], s77 offen offset:2048 nt lds
    buffer_load_dwordx4 v251, s[52:55], s77 offen offset:3072 nt lds
    s_waitcnt vmcnt(32)
    s_barrier
    s_mov_b32 m0, 49152
    s_add_u32 s77, s83, 147456
    buffer_load_dwordx4 v252, s[56:59], s77 offen offset:0 nt lds
    buffer_load_dwordx4 v252, s[56:59], s77 offen offset:1024 nt lds
    buffer_load_dwordx4 v252, s[56:59], s77 offen offset:2048 nt lds
    buffer_load_dwordx4 v252, s[56:59], s77 offen offset:3072 nt lds
    s_mov_b32 m0, 53248
    s_add_u32 s77, s83, 151552
    buffer_load_dwordx4 v252, s[56:59], s77 offen offset:0 nt lds
    buffer_load_dwordx4 v252, s[56:59], s77 offen offset:1024 nt lds
    buffer_load_dwordx4 v252, s[56:59], s77 offen offset:2048 nt lds
    buffer_load_dwordx4 v252, s[56:59], s77 offen offset:3072 nt lds
    s_mov_b32 m0, 24576
    s_add_u32 s77, s83, 155648
    buffer_load_dwordx4 v248, s[52:55], s77 offen offset:0 nt lds
    buffer_load_dwordx4 v249, s[52:55], s77 offen offset:1024 nt lds
    buffer_load_dwordx4 v250, s[52:55], s77 offen offset:2048 nt lds
    buffer_load_dwordx4 v251, s[52:55], s77 offen offset:3072 nt lds
    s_mov_b32 m0, 28672
    s_add_u32 s77, s83, 159744
    buffer_load_dwordx4 v248, s[52:55], s77 offen offset:0 nt lds
    buffer_load_dwordx4 v249, s[52:55], s77 offen offset:1024 nt lds
    buffer_load_dwordx4 v250, s[52:55], s77 offen offset:2048 nt lds
    buffer_load_dwordx4 v251, s[52:55], s77 offen offset:3072 nt lds
    s_waitcnt vmcnt(32)
    s_barrier
    s_mov_b32 m0, 57344
    s_add_u32 s77, s83, 155648
    buffer_load_dwordx4 v252, s[56:59], s77 offen offset:0 nt lds
    buffer_load_dwordx4 v252, s[56:59], s77 offen offset:1024 nt lds
    buffer_load_dwordx4 v252, s[56:59], s77 offen offset:2048 nt lds
    buffer_load_dwordx4 v252, s[56:59], s77 offen offset:3072 nt lds
    s_mov_b32 m0, 61440
    s_add_u32 s77, s83, 159744
    buffer_load_dwordx4 v252, s[56:59], s77 offen offset:0 nt lds
    buffer_load_dwordx4 v252, s[56:59], s77 offen offset:1024 nt lds
    buffer_load_dwordx4 v252, s[56:59], s77 offen offset:2048 nt lds
    buffer_load_dwordx4 v252, s[56:59], s77 offen offset:3072 nt lds
    s_mov_b32 m0, 0
    s_add_u32 s77, s83, 163840
    buffer_load_dwordx4 v248, s[52:55], s77 offen offset:0 nt lds
    buffer_load_dwordx4 v249, s[52:55], s77 offen offset:1024 nt lds
    buffer_load_dwordx4 v250, s[52:55], s77 offen offset:2048 nt lds
    buffer_load_dwordx4 v251, s[52:55], s77 offen offset:3072 nt lds
    s_mov_b32 m0, 4096
    s_add_u32 s77, s83, 167936
    buffer_load_dwordx4 v248, s[52:55], s77 offen offset:0 nt lds
    buffer_load_dwordx4 v249, s[52:55], s77 offen offset:1024 nt lds
    buffer_load_dwordx4 v250, s[52:55], s77 offen offset:2048 nt lds
    buffer_load_dwordx4 v251, s[52:55], s77 offen offset:3072 nt lds
    s_waitcnt vmcnt(32)
    s_barrier
    s_mov_b32 m0, 32768
    s_add_u32 s77, s83, 163840
    buffer_load_dwordx4 v252, s[56:59], s77 offen offset:0 nt lds
    buffer_load_dwordx4 v252, s[56:59], s77 offen offset:1024 nt lds
    buffer_load_dwordx4 v252, s[56:59], s77 offen offset:2048 nt lds
    buffer_load_dwordx4 v252, s[56:59], s77 offen offset:3072 nt lds
    s_mov_b32 m0, 36864
    s_add_u32 s77, s83, 167936
    buffer_load_dwordx4 v252, s[56:59], s77 offen offset:0 nt lds
    buffer_load_dwordx4 v252, s[56:59], s77 offen offset:1024 nt lds
    buffer_load_dwordx4 v252, s[56:59], s77 offen offset:2048 nt lds
    buffer_load_dwordx4 v252, s[56:59], s77 offen offset:3072 nt lds
    s_mov_b32 m0, 8192
    s_add_u32 s77, s83, 172032
    buffer_load_dwordx4 v248, s[52:55], s77 offen offset:0 nt lds
    buffer_load_dwordx4 v249, s[52:55], s77 offen offset:1024 nt lds
    buffer_load_dwordx4 v250, s[52:55], s77 offen offset:2048 nt lds
    buffer_load_dwordx4 v251, s[52:55], s77 offen offset:3072 nt lds
    s_mov_b32 m0, 12288
    s_add_u32 s77, s83, 176128
    buffer_load_dwordx4 v248, s[52:55], s77 offen offset:0 nt lds
    buffer_load_dwordx4 v249, s[52:55], s77 offen offset:1024 nt lds
    buffer_load_dwordx4 v250, s[52:55], s77 offen offset:2048 nt lds
    buffer_load_dwordx4 v251, s[52:55], s77 offen offset:3072 nt lds
    s_waitcnt vmcnt(32)
    s_barrier
    s_mov_b32 m0, 40960
    s_add_u32 s77, s83, 172032
    buffer_load_dwordx4 v252, s[56:59], s77 offen offset:0 nt lds
    buffer_load_dwordx4 v252, s[56:59], s77 offen offset:1024 nt lds
    buffer_load_dwordx4 v252, s[56:59], s77 offen offset:2048 nt lds
    buffer_load_dwordx4 v252, s[56:59], s77 offen offset:3072 nt lds
    s_mov_b32 m0, 45056
    s_add_u32 s77, s83, 176128
    buffer_load_dwordx4 v252, s[56:59], s77 offen offset:0 nt lds
    buffer_load_dwordx4 v252, s[56:59], s77 offen offset:1024 nt lds
    buffer_load_dwordx4 v252, s[56:59], s77 offen offset:2048 nt lds
    buffer_load_dwordx4 v252, s[56:59], s77 offen offset:3072 nt lds
    s_mov_b32 m0, 16384
    s_add_u32 s77, s83, 180224
    buffer_load_dwordx4 v248, s[52:55], s77 offen offset:0 nt lds
    buffer_load_dwordx4 v249, s[52:55], s77 offen offset:1024 nt lds
    buffer_load_dwordx4 v250, s[52:55], s77 offen offset:2048 nt lds
    buffer_load_dwordx4 v251, s[52:55], s77 offen offset:3072 nt lds
    s_mov_b32 m0, 20480
    s_add_u32 s77, s83, 184320
    buffer_load_dwordx4 v248, s[52:55], s77 offen offset:0 nt lds
    buffer_load_dwordx4 v249, s[52:55], s77 offen offset:1024 nt lds
    buffer_load_dwordx4 v250, s[52:55], s77 offen offset:2048 nt lds
    buffer_load_dwordx4 v251, s[52:55], s77 offen offset:3072 nt lds
    s_waitcnt vmcnt(32)
    s_barrier
    s_mov_b32 m0, 49152
    s_add_u32 s77, s83, 180224
    buffer_load_dwordx4 v252, s[56:59], s77 offen offset:0 nt lds
    buffer_load_dwordx4 v252, s[56:59], s77 offen offset:1024 nt lds
    buffer_load_dwordx4 v252, s[56:59], s77 offen offset:2048 nt lds
    buffer_load_dwordx4 v252, s[56:59], s77 offen offset:3072 nt lds
    s_mov_b32 m0, 53248
    s_add_u32 s77, s83, 184320
    buffer_load_dwordx4 v252, s[56:59], s77 offen offset:0 nt lds
    buffer_load_dwordx4 v252, s[56:59], s77 offen offset:1024 nt lds
    buffer_load_dwordx4 v252, s[56:59], s77 offen offset:2048 nt lds
    buffer_load_dwordx4 v252, s[56:59], s77 offen offset:3072 nt lds
    s_mov_b32 m0, 24576
    s_add_u32 s77, s83, 188416
    buffer_load_dwordx4 v248, s[52:55], s77 offen offset:0 nt lds
    buffer_load_dwordx4 v249, s[52:55], s77 offen offset:1024 nt lds
    buffer_load_dwordx4 v250, s[52:55], s77 offen offset:2048 nt lds
    buffer_load_dwordx4 v251, s[52:55], s77 offen offset:3072 nt lds
    s_mov_b32 m0, 28672
    s_add_u32 s77, s83, 192512
    buffer_load_dwordx4 v248, s[52:55], s77 offen offset:0 nt lds
    buffer_load_dwordx4 v249, s[52:55], s77 offen offset:1024 nt lds
    buffer_load_dwordx4 v250, s[52:55], s77 offen offset:2048 nt lds
    buffer_load_dwordx4 v251, s[52:55], s77 offen offset:3072 nt lds
    s_waitcnt vmcnt(32)
    s_barrier
    s_mov_b32 m0, 57344
    s_add_u32 s77, s83, 188416
    buffer_load_dwordx4 v252, s[56:59], s77 offen offset:0 nt lds
    buffer_load_dwordx4 v252, s[56:59], s77 offen offset:1024 nt lds
    buffer_load_dwordx4 v252, s[56:59], s77 offen offset:2048 nt lds
    buffer_load_dwordx4 v252, s[56:59], s77 offen offset:3072 nt lds
    s_mov_b32 m0, 61440
    s_add_u32 s77, s83, 192512
    buffer_load_dwordx4 v252, s[56:59], s77 offen offset:0 nt lds
    buffer_load_dwordx4 v252, s[56:59], s77 offen offset:1024 nt lds
    buffer_load_dwordx4 v252, s[56:59], s77 offen offset:2048 nt lds
    buffer_load_dwordx4 v252, s[56:59], s77 offen offset:3072 nt lds
    s_mov_b32 m0, 0
    s_add_u32 s77, s83, 196608
    buffer_load_dwordx4 v248, s[52:55], s77 offen offset:0 nt lds
    buffer_load_dwordx4 v249, s[52:55], s77 offen offset:1024 nt lds
    buffer_load_dwordx4 v250, s[52:55], s77 offen offset:2048 nt lds
    buffer_load_dwordx4 v251, s[52:55], s77 offen offset:3072 nt lds
    s_mov_b32 m0, 4096
    s_add_u32 s77, s83, 200704
    buffer_load_dwordx4 v248, s[52:55], s77 offen offset:0 nt lds
    buffer_load_dwordx4 v249, s[52:55], s77 offen offset:1024 nt lds
    buffer_load_dwordx4 v250, s[52:55], s77 offen offset:2048 nt lds
    buffer_load_dwordx4 v251, s[52:55], s77 offen offset:3072 nt lds
    s_waitcnt vmcnt(32)
    s_barrier
    s_mov_b32 m0, 32768
    s_add_u32 s77, s83, 196608
    buffer_load_dwordx4 v252, s[56:59], s77 offen offset:0 nt lds
    buffer_load_dwordx4 v252, s[56:59], s77 offen offset:1024 nt lds
    buffer_load_dwordx4 v252, s[56:59], s77 offen offset:2048 nt lds
    buffer_load_dwordx4 v252, s[56:59], s77 offen offset:3072 nt lds
    s_mov_b32 m0, 36864
    s_add_u32 s77, s83, 200704
    buffer_load_dwordx4 v252, s[56:59], s77 offen offset:0 nt lds
    buffer_load_dwordx4 v252, s[56:59], s77 offen offset:1024 nt lds
    buffer_load_dwordx4 v252, s[56:59], s77 offen offset:2048 nt lds
    buffer_load_dwordx4 v252, s[56:59], s77 offen offset:3072 nt lds
    s_mov_b32 m0, 8192
    s_add_u32 s77, s83, 204800
    buffer_load_dwordx4 v248, s[52:55], s77 offen offset:0 nt lds
    buffer_load_dwordx4 v249, s[52:55], s77 offen offset:1024 nt lds
    buffer_load_dwordx4 v250, s[52:55], s77 offen offset:2048 nt lds
    buffer_load_dwordx4 v251, s[52:55], s77 offen offset:3072 nt lds
    s_mov_b32 m0, 12288
    s_add_u32 s77, s83, 208896
    buffer_load_dwordx4 v248, s[52:55], s77 offen offset:0 nt lds
    buffer_load_dwordx4 v249, s[52:55], s77 offen offset:1024 nt lds
    buffer_load_dwordx4 v250, s[52:55], s77 offen offset:2048 nt lds
    buffer_load_dwordx4 v251, s[52:55], s77 offen offset:3072 nt lds
    s_waitcnt vmcnt(32)
    s_barrier
    s_mov_b32 m0, 40960
    s_add_u32 s77, s83, 204800
    buffer_load_dwordx4 v252, s[56:59], s77 offen offset:0 nt lds
    buffer_load_dwordx4 v252, s[56:59], s77 offen offset:1024 nt lds
    buffer_load_dwordx4 v252, s[56:59], s77 offen offset:2048 nt lds
    buffer_load_dwordx4 v252, s[56:59], s77 offen offset:3072 nt lds
    s_mov_b32 m0, 45056
    s_add_u32 s77, s83, 208896
    buffer_load_dwordx4 v252, s[56:59], s77 offen offset:0 nt lds
    buffer_load_dwordx4 v252, s[56:59], s77 offen offset:1024 nt lds
    buffer_load_dwordx4 v252, s[56:59], s77 offen offset:2048 nt lds
    buffer_load_dwordx4 v252, s[56:59], s77 offen offset:3072 nt lds
    s_mov_b32 m0, 16384
    s_add_u32 s77, s83, 212992
    buffer_load_dwordx4 v248, s[52:55], s77 offen offset:0 nt lds
    buffer_load_dwordx4 v249, s[52:55], s77 offen offset:1024 nt lds
    buffer_load_dwordx4 v250, s[52:55], s77 offen offset:2048 nt lds
    buffer_load_dwordx4 v251, s[52:55], s77 offen offset:3072 nt lds
    s_mov_b32 m0, 20480
    s_add_u32 s77, s83, 217088
    buffer_load_dwordx4 v248, s[52:55], s77 offen offset:0 nt lds
    buffer_load_dwordx4 v249, s[52:55], s77 offen offset:1024 nt lds
    buffer_load_dwordx4 v250, s[52:55], s77 offen offset:2048 nt lds
    buffer_load_dwordx4 v251, s[52:55], s77 offen offset:3072 nt lds
    s_waitcnt vmcnt(32)
    s_barrier
    s_mov_b32 m0, 49152
    s_add_u32 s77, s83, 212992
    buffer_load_dwordx4 v252, s[56:59], s77 offen offset:0 nt lds
    buffer_load_dwordx4 v252, s[56:59], s77 offen offset:1024 nt lds
    buffer_load_dwordx4 v252, s[56:59], s77 offen offset:2048 nt lds
    buffer_load_dwordx4 v252, s[56:59], s77 offen offset:3072 nt lds
    s_mov_b32 m0, 53248
    s_add_u32 s77, s83, 217088
    buffer_load_dwordx4 v252, s[56:59], s77 offen offset:0 nt lds
    buffer_load_dwordx4 v252, s[56:59], s77 offen offset:1024 nt lds
    buffer_load_dwordx4 v252, s[56:59], s77 offen offset:2048 nt lds
    buffer_load_dwordx4 v252, s[56:59], s77 offen offset:3072 nt lds
    s_mov_b32 m0, 24576
    s_add_u32 s77, s83, 221184
    buffer_load_dwordx4 v248, s[52:55], s77 offen offset:0 nt lds
    buffer_load_dwordx4 v249, s[52:55], s77 offen offset:1024 nt lds
    buffer_load_dwordx4 v250, s[52:55], s77 offen offset:2048 nt lds
    buffer_load_dwordx4 v251, s[52:55], s77 offen offset:3072 nt lds
    s_mov_b32 m0, 28672
    s_add_u32 s77, s83, 225280
    buffer_load_dwordx4 v248, s[52:55], s77 offen offset:0 nt lds
    buffer_load_dwordx4 v249, s[52:55], s77 offen offset:1024 nt lds
    buffer_load_dwordx4 v250, s[52:55], s77 offen offset:2048 nt lds
    buffer_load_dwordx4 v251, s[52:55], s77 offen offset:3072 nt lds
    s_waitcnt vmcnt(32)
    s_barrier
    s_mov_b32 m0, 57344
    s_add_u32 s77, s83, 221184
    buffer_load_dwordx4 v252, s[56:59], s77 offen offset:0 nt lds
    buffer_load_dwordx4 v252, s[56:59], s77 offen offset:1024 nt lds
    buffer_load_dwordx4 v252, s[56:59], s77 offen offset:2048 nt lds
    buffer_load_dwordx4 v252, s[56:59], s77 offen offset:3072 nt lds
    s_mov_b32 m0, 61440
    s_add_u32 s77, s83, 225280
    buffer_load_dwordx4 v252, s[56:59], s77 offen offset:0 nt lds
    buffer_load_dwordx4 v252, s[56:59], s77 offen offset:1024 nt lds
    buffer_load_dwordx4 v252, s[56:59], s77 offen offset:2048 nt lds
    buffer_load_dwordx4 v252, s[56:59], s77 offen offset:3072 nt lds
    s_mov_b32 m0, 0
    s_add_u32 s77, s83, 229376
    buffer_load_dwordx4 v248, s[52:55], s77 offen offset:0 nt lds
    buffer_load_dwordx4 v249, s[52:55], s77 offen offset:1024 nt lds
    buffer_load_dwordx4 v250, s[52:55], s77 offen offset:2048 nt lds
    buffer_load_dwordx4 v251, s[52:55], s77 offen offset:3072 nt lds
    s_mov_b32 m0, 4096
    s_add_u32 s77, s83, 233472
    buffer_load_dwordx4 v248, s[52:55], s77 offen offset:0 nt lds
    buffer_load_dwordx4 v249, s[52:55], s77 offen offset:1024 nt lds
    buffer_load_dwordx4 v250, s[52:55], s77 offen offset:2048 nt lds
    buffer_load_dwordx4 v251, s[52:55], s77 offen offset:3072 nt lds
    s_waitcnt vmcnt(32)
    s_barrier
    s_mov_b32 m0, 32768
    s_add_u32 s77, s83, 229376
    buffer_load_dwordx4 v252, s[56:59], s77 offen offset:0 nt lds
    buffer_load_dwordx4 v252, s[56:59], s77 offen offset:1024 nt lds
    buffer_load_dwordx4 v252, s[56:59], s77 offen offset:2048 nt lds
    buffer_load_dwordx4 v252, s[56:59], s77 offen offset:3072 nt lds
    s_mov_b32 m0, 36864
    s_add_u32 s77, s83, 233472
    buffer_load_dwordx4 v252, s[56:59], s77 offen offset:0 nt lds
    buffer_load_dwordx4 v252, s[56:59], s77 offen offset:1024 nt lds
    buffer_load_dwordx4 v252, s[56:59], s77 offen offset:2048 nt lds
    buffer_load_dwordx4 v252, s[56:59], s77 offen offset:3072 nt lds
    s_mov_b32 m0, 8192
    s_add_u32 s77, s83, 237568
    buffer_load_dwordx4 v248, s[52:55], s77 offen offset:0 nt lds
    buffer_load_dwordx4 v249, s[52:55], s77 offen offset:1024 nt lds
    buffer_load_dwordx4 v250, s[52:55], s77 offen offset:2048 nt lds
    buffer_load_dwordx4 v251, s[52:55], s77 offen offset:3072 nt lds
    s_mov_b32 m0, 12288
    s_add_u32 s77, s83, 241664
    buffer_load_dwordx4 v248, s[52:55], s77 offen offset:0 nt lds
    buffer_load_dwordx4 v249, s[52:55], s77 offen offset:1024 nt lds
    buffer_load_dwordx4 v250, s[52:55], s77 offen offset:2048 nt lds
    buffer_load_dwordx4 v251, s[52:55], s77 offen offset:3072 nt lds
    s_mul_i32 s77, s9, 3
    s_add_u32 s77, s77, s4
    s_and_b32 s77, s77, 7
    s_and_b32 s91, s77, 6
    s_add_u32 s91, s91, s77
    s_lshl_b32 s91, s91, 1
    s_add_u32 s91, s91, 4
    s_mul_i32 s85, s91, 163840
    s_add_u32 s85, s85, s88
    s_lshl_b32 s84, s91, 13
    s_add_u32 s84, s84, s89
    s_lshr_b32 s77, s89, 6
    s_lshl_b32 s78, s91, 7
    s_add_u32 s77, s77, s78
    s_add_u32 s77, s77, 12582912
    v_and_b32 v5, 1, v0
    v_lshlrev_b32 v5, 12, v5
    v_lshrrev_b32 v6, 1, v0
    v_and_b32 v6, 1, v6
    v_lshl_add_u32 v5, v6, 7, v5
    v_add_u32 v5, s77, v5
    v_mov_b32 v8, 0
    v_mov_b32 v9, 0
    v_mov_b32 v10, 0
    v_mov_b32 v11, 0
    v_mov_b32 v12, 0
    v_mov_b32 v13, 0
    v_mov_b32 v14, 0
    v_mov_b32 v15, 0
    v_mov_b32 v16, 0
    v_mov_b32 v17, 0
    v_mov_b32 v18, 0
    v_mov_b32 v19, 0
    v_mov_b32 v20, 0
    v_mov_b32 v21, 0
    v_mov_b32 v22, 0
    v_mov_b32 v23, 0
    v_mov_b32 v24, 0
    v_mov_b32 v25, 0
    v_mov_b32 v26, 0
    v_mov_b32 v27, 0
    v_mov_b32 v28, 0
    v_mov_b32 v29, 0
    v_mov_b32 v30, 0
    v_mov_b32 v31, 0
    v_mov_b32 v32, 0
    v_mov_b32 v33, 0
    v_mov_b32 v34, 0
    v_mov_b32 v35, 0
    v_mov_b32 v36, 0
    v_mov_b32 v37, 0
    v_mov_b32 v38, 0
    v_mov_b32 v39, 0
    v_mov_b32 v40, 0
    v_mov_b32 v41, 0
    v_mov_b32 v42, 0
    v_mov_b32 v43, 0
    v_mov_b32 v44, 0
    v_mov_b32 v45, 0
    v_mov_b32 v46, 0
    v_mov_b32 v47, 0
    v_mov_b32 v48, 0
    v_mov_b32 v49, 0
    v_mov_b32 v50, 0
    v_mov_b32 v51, 0
    v_mov_b32 v52, 0
    v_mov_b32 v53, 0
    v_mov_b32 v54, 0
    v_mov_b32 v55, 0
    v_mov_b32 v56, 0
    v_mov_b32 v57, 0
    v_mov_b32 v58, 0
    v_mov_b32 v59, 0
    v_mov_b32 v60, 0
    v_mov_b32 v61, 0
    v_mov_b32 v62, 0
    v_mov_b32 v63, 0
    v_mov_b32 v64, 0
    v_mov_b32 v65, 0
    v_mov_b32 v66, 0
    v_mov_b32 v67, 0
    v_mov_b32 v68, 0
    v_mov_b32 v69, 0
    v_mov_b32 v70, 0
    v_mov_b32 v71, 0
    s_waitcnt vmcnt(32)
    s_barrier
    s_mov_b32 m0, 40960
    s_add_u32 s77, s83, 237568
    buffer_load_dwordx4 v252, s[56:59], s77 offen offset:0 nt lds
    buffer_load_dwordx4 v252, s[56:59], s77 offen offset:1024 nt lds
    buffer_load_dwordx4 v252, s[56:59], s77 offen offset:2048 nt lds
    buffer_load_dwordx4 v252, s[56:59], s77 offen offset:3072 nt lds
    s_mov_b32 m0, 45056
    s_add_u32 s77, s83, 241664
    buffer_load_dwordx4 v252, s[56:59], s77 offen offset:0 nt lds
    buffer_load_dwordx4 v252, s[56:59], s77 offen offset:1024 nt lds
    buffer_load_dwordx4 v252, s[56:59], s77 offen offset:2048 nt lds
    buffer_load_dwordx4 v252, s[56:59], s77 offen offset:3072 nt lds
    s_mov_b32 m0, 16384
    s_add_u32 s77, s83, 245760
    buffer_load_dwordx4 v248, s[52:55], s77 offen offset:0 nt lds
    buffer_load_dwordx4 v249, s[52:55], s77 offen offset:1024 nt lds
    buffer_load_dwordx4 v250, s[52:55], s77 offen offset:2048 nt lds
    buffer_load_dwordx4 v251, s[52:55], s77 offen offset:3072 nt lds
    s_mov_b32 m0, 20480
    s_add_u32 s77, s83, 249856
    buffer_load_dwordx4 v248, s[52:55], s77 offen offset:0 nt lds
    buffer_load_dwordx4 v249, s[52:55], s77 offen offset:1024 nt lds
    buffer_load_dwordx4 v250, s[52:55], s77 offen offset:2048 nt lds
    buffer_load_dwordx4 v251, s[52:55], s77 offen offset:3072 nt lds
    s_waitcnt vmcnt(32)
    s_barrier
    s_mov_b32 m0, 49152
    s_add_u32 s77, s83, 245760
    buffer_load_dwordx4 v252, s[56:59], s77 offen offset:0 nt lds
    buffer_load_dwordx4 v252, s[56:59], s77 offen offset:1024 nt lds
    buffer_load_dwordx4 v252, s[56:59], s77 offen offset:2048 nt lds
    buffer_load_dwordx4 v252, s[56:59], s77 offen offset:3072 nt lds
    s_mov_b32 m0, 53248
    s_add_u32 s77, s83, 249856
    buffer_load_dwordx4 v252, s[56:59], s77 offen offset:0 nt lds
    buffer_load_dwordx4 v252, s[56:59], s77 offen offset:1024 nt lds
    buffer_load_dwordx4 v252, s[56:59], s77 offen offset:2048 nt lds
    buffer_load_dwordx4 v252, s[56:59], s77 offen offset:3072 nt lds
    s_mov_b32 m0, 24576
    s_add_u32 s77, s83, 253952
    buffer_load_dwordx4 v248, s[52:55], s77 offen offset:0 nt lds
    buffer_load_dwordx4 v249, s[52:55], s77 offen offset:1024 nt lds
    buffer_load_dwordx4 v250, s[52:55], s77 offen offset:2048 nt lds
    buffer_load_dwordx4 v251, s[52:55], s77 offen offset:3072 nt lds
    s_mov_b32 m0, 28672
    s_add_u32 s77, s83, 258048
    buffer_load_dwordx4 v248, s[52:55], s77 offen offset:0 nt lds
    buffer_load_dwordx4 v249, s[52:55], s77 offen offset:1024 nt lds
    buffer_load_dwordx4 v250, s[52:55], s77 offen offset:2048 nt lds
    buffer_load_dwordx4 v251, s[52:55], s77 offen offset:3072 nt lds
    s_waitcnt vmcnt(32)
    s_barrier
    s_mov_b32 m0, 57344
    s_add_u32 s77, s83, 253952
    buffer_load_dwordx4 v252, s[56:59], s77 offen offset:0 nt lds
    buffer_load_dwordx4 v252, s[56:59], s77 offen offset:1024 nt lds
    buffer_load_dwordx4 v252, s[56:59], s77 offen offset:2048 nt lds
    buffer_load_dwordx4 v252, s[56:59], s77 offen offset:3072 nt lds
    s_mov_b32 m0, 61440
    s_add_u32 s77, s83, 258048
    buffer_load_dwordx4 v252, s[56:59], s77 offen offset:0 nt lds
    buffer_load_dwordx4 v252, s[56:59], s77 offen offset:1024 nt lds
    buffer_load_dwordx4 v252, s[56:59], s77 offen offset:2048 nt lds
    buffer_load_dwordx4 v252, s[56:59], s77 offen offset:3072 nt lds
    s_mov_b32 m0, 0
    s_add_u32 s77, s20, 0
    buffer_load_dwordx4 v2, s[60:63], s77 offen offset:0 lds
    s_add_u32 s77, s20, 9216
    buffer_load_dwordx4 v2, s[60:63], s77 offen offset:1024 lds
    s_add_u32 s77, s20, 18432
    buffer_load_dwordx4 v2, s[60:63], s77 offen offset:2048 lds
    s_add_u32 s77, s20, 27648
    buffer_load_dwordx4 v2, s[60:63], s77 offen offset:3072 lds
    s_mov_b32 m0, 4096
    s_add_u32 s77, s20, 40960
    buffer_load_dwordx4 v2, s[60:63], s77 offen offset:0 lds
    s_add_u32 s77, s20, 50176
    buffer_load_dwordx4 v2, s[60:63], s77 offen offset:1024 lds
    s_add_u32 s77, s20, 59392
    buffer_load_dwordx4 v2, s[60:63], s77 offen offset:2048 lds
    s_add_u32 s77, s20, 68608
    buffer_load_dwordx4 v2, s[60:63], s77 offen offset:3072 lds
    s_waitcnt vmcnt(32)
    s_barrier
    s_mov_b32 m0, 8192
    s_add_u32 s77, s20, 81920
    buffer_load_dwordx4 v2, s[60:63], s77 offen offset:0 lds
    s_add_u32 s77, s20, 91136
    buffer_load_dwordx4 v2, s[60:63], s77 offen offset:1024 lds
    s_add_u32 s77, s20, 100352
    buffer_load_dwordx4 v2, s[60:63], s77 offen offset:2048 lds
    s_add_u32 s77, s20, 109568
    buffer_load_dwordx4 v2, s[60:63], s77 offen offset:3072 lds
    s_mov_b32 m0, 12288
    s_add_u32 s77, s20, 122880
    buffer_load_dwordx4 v2, s[60:63], s77 offen offset:0 lds
    s_add_u32 s77, s20, 132096
    buffer_load_dwordx4 v2, s[60:63], s77 offen offset:1024 lds
    s_add_u32 s77, s20, 141312
    buffer_load_dwordx4 v2, s[60:63], s77 offen offset:2048 lds
    s_add_u32 s77, s20, 150528
    buffer_load_dwordx4 v2, s[60:63], s77 offen offset:3072 lds
    s_mov_b32 m0, 32768
    s_add_u32 s77, s21, 122880
    buffer_load_dwordx4 v2, s[60:63], s77 offen offset:0 lds
    s_add_u32 s77, s21, 132096
    buffer_load_dwordx4 v2, s[60:63], s77 offen offset:1024 lds
    s_add_u32 s77, s21, 141312
    buffer_load_dwordx4 v2, s[60:63], s77 offen offset:2048 lds
    s_add_u32 s77, s21, 150528
    buffer_load_dwordx4 v2, s[60:63], s77 offen offset:3072 lds
    s_mov_b32 m0, 36864
    s_add_u32 s77, s21, 163840
    buffer_load_dwordx4 v2, s[60:63], s77 offen offset:0 lds
    s_add_u32 s77, s21, 173056
    buffer_load_dwordx4 v2, s[60:63], s77 offen offset:1024 lds
    s_add_u32 s77, s21, 182272
    buffer_load_dwordx4 v2, s[60:63], s77 offen offset:2048 lds
    s_add_u32 s77, s21, 191488
    buffer_load_dwordx4 v2, s[60:63], s77 offen offset:3072 lds
    s_mov_b32 m0, 65536
    s_add_u32 s77, s23, 40960
    buffer_load_dwordx4 v2, s[60:63], s77 offen offset:0 lds
    s_add_u32 s77, s23, 50176
    buffer_load_dwordx4 v2, s[60:63], s77 offen offset:1024 lds
    s_add_u32 s77, s23, 59392
    buffer_load_dwordx4 v2, s[60:63], s77 offen offset:2048 lds
    s_add_u32 s77, s23, 68608
    buffer_load_dwordx4 v2, s[60:63], s77 offen offset:3072 lds
    s_mov_b32 m0, 69632
    s_add_u32 s77, s23, 81920
    buffer_load_dwordx4 v2, s[60:63], s77 offen offset:0 lds
    s_add_u32 s77, s23, 91136
    buffer_load_dwordx4 v2, s[60:63], s77 offen offset:1024 lds
    s_add_u32 s77, s23, 100352
    buffer_load_dwordx4 v2, s[60:63], s77 offen offset:2048 lds
    s_add_u32 s77, s23, 109568
    buffer_load_dwordx4 v2, s[60:63], s77 offen offset:3072 lds
    s_mov_b32 m0, 73728
    s_add_u32 s77, s23, 122880
    buffer_load_dwordx4 v2, s[60:63], s77 offen offset:0 lds
    s_add_u32 s77, s23, 132096
    buffer_load_dwordx4 v2, s[60:63], s77 offen offset:1024 lds
    s_add_u32 s77, s23, 141312
    buffer_load_dwordx4 v2, s[60:63], s77 offen offset:2048 lds
    s_add_u32 s77, s23, 150528
    buffer_load_dwordx4 v2, s[60:63], s77 offen offset:3072 lds
    s_waitcnt vmcnt(59)
    s_mov_b32 m0, 77824
    s_add_u32 s77, s23, 163840
    buffer_load_dwordx4 v2, s[60:63], s77 offen offset:0 lds
    s_add_u32 s77, s23, 173056
    buffer_load_dwordx4 v2, s[60:63], s77 offen offset:1024 lds
    s_add_u32 s77, s23, 182272
    buffer_load_dwordx4 v2, s[60:63], s77 offen offset:2048 lds
    s_add_u32 s77, s23, 191488
    buffer_load_dwordx4 v2, s[60:63], s77 offen offset:3072 lds
    s_waitcnt vmcnt(48)
    s_barrier
    s_mov_b32 m0, 16384
    s_add_u32 s77, s20, 163840
    buffer_load_dwordx4 v2, s[60:63], s77 offen offset:0 lds
    s_add_u32 s77, s20, 173056
    buffer_load_dwordx4 v2, s[60:63], s77 offen offset:1024 lds
    s_add_u32 s77, s20, 182272
    buffer_load_dwordx4 v2, s[60:63], s77 offen offset:2048 lds
    s_add_u32 s77, s20, 191488
    buffer_load_dwordx4 v2, s[60:63], s77 offen offset:3072 lds
    s_mov_b32 m0, 20480
    s_add_u32 s77, s21, 0
    buffer_load_dwordx4 v2, s[60:63], s77 offen offset:0 lds
    s_add_u32 s77, s21, 9216
    buffer_load_dwordx4 v2, s[60:63], s77 offen offset:1024 lds
    s_add_u32 s77, s21, 18432
    buffer_load_dwordx4 v2, s[60:63], s77 offen offset:2048 lds
    s_add_u32 s77, s21, 27648
    buffer_load_dwordx4 v2, s[60:63], s77 offen offset:3072 lds
    s_mov_b32 m0, 40960
    s_add_u32 s77, s22, 0
    buffer_load_dwordx4 v2, s[60:63], s77 offen offset:0 lds
    s_add_u32 s77, s22, 9216
    buffer_load_dwordx4 v2, s[60:63], s77 offen offset:1024 lds
    s_add_u32 s77, s22, 18432
    buffer_load_dwordx4 v2, s[60:63], s77 offen offset:2048 lds
    s_add_u32 s77, s22, 27648
    buffer_load_dwordx4 v2, s[60:63], s77 offen offset:3072 lds
    s_waitcnt vmcnt(59)
    s_mov_b32 m0, 45056
    s_add_u32 s77, s22, 40960
    buffer_load_dwordx4 v2, s[60:63], s77 offen offset:0 lds
    s_add_u32 s77, s22, 50176
    buffer_load_dwordx4 v2, s[60:63], s77 offen offset:1024 lds
    s_add_u32 s77, s22, 59392
    buffer_load_dwordx4 v2, s[60:63], s77 offen offset:2048 lds
    s_add_u32 s77, s22, 68608
    buffer_load_dwordx4 v2, s[60:63], s77 offen offset:3072 lds
    s_waitcnt vmcnt(56)
    s_barrier
    s_mov_b32 m0, 24576
    s_add_u32 s77, s21, 40960
    buffer_load_dwordx4 v2, s[60:63], s77 offen offset:0 lds
    s_add_u32 s77, s21, 50176
    buffer_load_dwordx4 v2, s[60:63], s77 offen offset:1024 lds
    s_add_u32 s77, s21, 59392
    buffer_load_dwordx4 v2, s[60:63], s77 offen offset:2048 lds
    s_add_u32 s77, s21, 68608
    buffer_load_dwordx4 v2, s[60:63], s77 offen offset:3072 lds
    s_waitcnt vmcnt(59)
    s_mov_b32 m0, 28672
    s_add_u32 s77, s21, 81920
    buffer_load_dwordx4 v2, s[60:63], s77 offen offset:0 lds
    s_add_u32 s77, s21, 91136
    buffer_load_dwordx4 v2, s[60:63], s77 offen offset:1024 lds
    s_add_u32 s77, s21, 100352
    buffer_load_dwordx4 v2, s[60:63], s77 offen offset:2048 lds
    s_add_u32 s77, s21, 109568
    buffer_load_dwordx4 v2, s[60:63], s77 offen offset:3072 lds
    s_waitcnt vmcnt(59)
    s_mov_b32 m0, 49152
    s_add_u32 s77, s22, 81920
    buffer_load_dwordx4 v2, s[60:63], s77 offen offset:0 lds
    s_add_u32 s77, s22, 91136
    buffer_load_dwordx4 v2, s[60:63], s77 offen offset:1024 lds
    s_add_u32 s77, s22, 100352
    buffer_load_dwordx4 v2, s[60:63], s77 offen offset:2048 lds
    s_add_u32 s77, s22, 109568
    buffer_load_dwordx4 v2, s[60:63], s77 offen offset:3072 lds
    s_waitcnt vmcnt(59)
    s_mov_b32 m0, 53248
    s_add_u32 s77, s22, 122880
    buffer_load_dwordx4 v2, s[60:63], s77 offen offset:0 lds
    s_add_u32 s77, s22, 132096
    buffer_load_dwordx4 v2, s[60:63], s77 offen offset:1024 lds
    s_add_u32 s77, s22, 141312
    buffer_load_dwordx4 v2, s[60:63], s77 offen offset:2048 lds
    s_add_u32 s77, s22, 150528
    buffer_load_dwordx4 v2, s[60:63], s77 offen offset:3072 lds
    s_barrier
    s_waitcnt vmcnt(59)
    s_mov_b32 m0, 57344
    s_add_u32 s77, s22, 163840
    buffer_load_dwordx4 v2, s[60:63], s77 offen offset:0 lds
    s_add_u32 s77, s22, 173056
    buffer_load_dwordx4 v2, s[60:63], s77 offen offset:1024 lds
    s_add_u32 s77, s22, 182272
    buffer_load_dwordx4 v2, s[60:63], s77 offen offset:2048 lds
    s_add_u32 s77, s22, 191488
    buffer_load_dwordx4 v2, s[60:63], s77 offen offset:3072 lds
    s_waitcnt vmcnt(59)
    s_mov_b32 m0, 61440
    s_add_u32 s77, s23, 0
    buffer_load_dwordx4 v2, s[60:63], s77 offen offset:0 lds
    s_add_u32 s77, s23, 9216
    buffer_load_dwordx4 v2, s[60:63], s77 offen offset:1024 lds
    s_add_u32 s77, s23, 18432
    buffer_load_dwordx4 v2, s[60:63], s77 offen offset:2048 lds
    s_add_u32 s77, s23, 27648
    buffer_load_dwordx4 v2, s[60:63], s77 offen offset:3072 lds
    s_cmp_ge_u32 s10, 30
    s_cbranch_scc1 L_end
    s_waitcnt vmcnt(0)
    s_barrier
    ds_read_b64_tr_b16 v[72:73], v3 offset:0
    ds_read_b64_tr_b16 v[74:75], v3 offset:512
    ds_read_b64_tr_b16 v[76:77], v4 offset:0
    ds_read_b64_tr_b16 v[78:79], v4 offset:512
    ds_read_b64_tr_b16 v[80:81], v3 offset:2048
    ds_read_b64_tr_b16 v[82:83], v3 offset:2560
    ds_read_b64_tr_b16 v[84:85], v4 offset:2048
    ds_read_b64_tr_b16 v[86:87], v4 offset:2560
    ds_read_b64_tr_b16 v[88:89], v3 offset:4096
    ds_read_b64_tr_b16 v[90:91], v3 offset:4608
    ds_read_b64_tr_b16 v[92:93], v4 offset:4096
    ds_read_b64_tr_b16 v[94:95], v4 offset:4608
    ds_read_b64_tr_b16 v[96:97], v3 offset:6144
    ds_read_b64_tr_b16 v[98:99], v3 offset:6656
    ds_read_b64_tr_b16 v[100:101], v4 offset:6144
    s_waitcnt lgkmcnt(7)
    ds_read_b64_tr_b16 v[102:103], v4 offset:6656
    ds_read_b64_tr_b16 v[104:105], v3 offset:8192
    ds_read_b64_tr_b16 v[106:107], v3 offset:8704
    ds_read_b64_tr_b16 v[108:109], v4 offset:8192
    ds_read_b64_tr_b16 v[110:111], v4 offset:8704
    ds_read_b64_tr_b16 v[112:113], v3 offset:10240
    ds_read_b64_tr_b16 v[114:115], v3 offset:10752
    ds_read_b64_tr_b16 v[116:117], v4 offset:10240
    s_waitcnt lgkmcnt(7)
    ds_read_b64_tr_b16 v[118:119], v4 offset:10752
    s_waitcnt lgkmcnt(0)
    s_add_u32 m0, s11, 0
    s_add_u32 s77, s85, 204800
    buffer_load_dwordx4 v2, s[60:63], s77 offen offset:0 lds
    s_add_u32 s77, s85, 214016
    buffer_load_dwordx4 v2, s[60:63], s77 offen offset:1024 lds
    s_add_u32 s77, s85, 223232
    buffer_load_dwordx4 v2, s[60:63], s77 offen offset:2048 lds
    s_add_u32 s77, s85, 232448
    buffer_load_dwordx4 v2, s[60:63], s77 offen offset:3072 lds
    s_add_u32 m0, s11, 4096
    s_add_u32 s77, s85, 245760
    buffer_load_dwordx4 v2, s[60:63], s77 offen offset:0 lds
    s_add_u32 s77, s85, 254976
    buffer_load_dwordx4 v2, s[60:63], s77 offen offset:1024 lds
    s_add_u32 s77, s85, 264192
    buffer_load_dwordx4 v2, s[60:63], s77 offen offset:2048 lds
    s_add_u32 s77, s85, 273408
    buffer_load_dwordx4 v2, s[60:63], s77 offen offset:3072 lds
    s_add_u32 m0, s11, 8192
    s_add_u32 s77, s85, 286720
    buffer_load_dwordx4 v2, s[60:63], s77 offen offset:0 lds
    s_add_u32 s77, s85, 295936
    buffer_load_dwordx4 v2, s[60:63], s77 offen offset:1024 lds
    s_add_u32 s77, s85, 305152
    buffer_load_dwordx4 v2, s[60:63], s77 offen offset:2048 lds
    s_add_u32 s77, s85, 314368
    buffer_load_dwordx4 v2, s[60:63], s77 offen offset:3072 lds
L_tail:
    s_setprio 0
    s_mov_b64 exec, 15
    s_mov_b32 s90, 200000
L_poll5:
    buffer_load_dword v6, v5, s[64:67], 0 offen sc1
    s_sub_u32 s90, s90, 1
    s_waitcnt vmcnt(0)
    v_cmp_ne_u32 vcc, s76, v6
    s_cbranch_vccz L_pd5
    s_cmp_lg_u32 s90, 0
    s_cbranch_scc1 L_poll5
L_pd5:
    s_mov_b64 exec, -1
    s_setprio 2
    s_add_u32 s77, s84, 0
    buffer_load_dwordx4 v[120:123], v1, s[64:67], s77 offen offset:0 sc1
    buffer_load_dwordx4 v[124:127], v1, s[64:67], s77 offen offset:1024 sc1
    s_add_u32 s77, s84, 262144
    buffer_load_dwordx4 v[128:131], v1, s[64:67], s77 offen offset:0 sc1
    buffer_load_dwordx4 v[132:135], v1, s[64:67], s77 offen offset:1024 sc1
    s_add_u32 s77, s84, 2048
    buffer_load_dwordx4 v[136:139], v1, s[64:67], s77 offen offset:0 sc1
    buffer_load_dwordx4 v[140:143], v1, s[64:67], s77 offen offset:1024 sc1
    s_add_u32 s77, s84, 264192
    buffer_load_dwordx4 v[144:147], v1, s[64:67], s77 offen offset:0 sc1
    buffer_load_dwordx4 v[148:151], v1, s[64:67], s77 offen offset:1024 sc1
    s_add_u32 s77, s84, 4096
    buffer_load_dwordx4 v[152:155], v1, s[64:67], s77 offen offset:0 sc1
    buffer_load_dwordx4 v[156:159], v1, s[64:67], s77 offen offset:1024 sc1
    s_add_u32 s77, s84, 266240
    buffer_load_dwordx4 v[160:163], v1, s[64:67], s77 offen offset:0 sc1
    buffer_load_dwordx4 v[164:167], v1, s[64:67], s77 offen offset:1024 sc1
    s_add_u32 s77, s84, 6144
    buffer_load_dwordx4 v[168:171], v1, s[64:67], s77 offen offset:0 sc1
    buffer_load_dwordx4 v[172:175], v1, s[64:67], s77 offen offset:1024 sc1
    s_add_u32 s77, s84, 268288
    buffer_load_dwordx4 v[176:179], v1, s[64:67], s77 offen offset:0 sc1
    buffer_load_dwordx4 v[180:183], v1, s[64:67], s77 offen offset:1024 sc1
    s_add_u32 s77, s84, 8192
    buffer_load_dwordx4 v[184:187], v1, s[64:67], s77 offen offset:0 sc1
    buffer_load_dwordx4 v[188:191], v1, s[64:67], s77 offen offset:1024 sc1
    s_add_u32 s77, s84, 270336
    buffer_load_dwordx4 v[192:195], v1, s[64:67], s77 offen offset:0 sc1
    buffer_load_dwordx4 v[196:199], v1, s[64:67], s77 offen offset:1024 sc1
    s_add_u32 s77, s84, 10240
    buffer_load_dwordx4 v[200:203], v1, s[64:67], s77 offen offset:0 sc1
    buffer_load_dwordx4 v[204:207], v1, s[64:67], s77 offen offset:1024 sc1
    s_add_u32 s77, s84, 272384
    buffer_load_dwordx4 v[208:211], v1, s[64:67], s77 offen offset:0 sc1
    buffer_load_dwordx4 v[212:215], v1, s[64:67], s77 offen offset:1024 sc1
    s_add_u32 s77, s84, 12288
    buffer_load_dwordx4 v[216:219], v1, s[64:67], s77 offen offset:0 sc1
    buffer_load_dwordx4 v[220:223], v1, s[64:67], s77 offen offset:1024 sc1
    s_add_u32 s77, s84, 274432
    buffer_load_dwordx4 v[224:227], v1, s[64:67], s77 offen offset:0 sc1
    buffer_load_dwordx4 v[228:231], v1, s[64:67], s77 offen offset:1024 sc1
    s_add_u32 s77, s84, 14336
    buffer_load_dwordx4 v[232:235], v1, s[64:67], s77 offen offset:0 sc1
    buffer_load_dwordx4 v[236:239], v1, s[64:67], s77 offen offset:1024 sc1
    s_add_u32 s77, s84, 276480
    buffer_load_dwordx4 v[240:243], v1, s[64:67], s77 offen offset:0 sc1
    buffer_load_dwordx4 v[244:247], v1, s[64:67], s77 offen offset:1024 sc1
L_tail2:
    s_waitcnt vmcnt(28)
    v_mfma_f32_32x32x16_bf16 v[8:23], v[72:75], v[120:123], v[8:23]
    v_mfma_f32_32x32x16_bf16 v[24:39], v[76:79], v[120:123], v[24:39]
    v_mfma_f32_32x32x16_bf16 v[40:55], v[72:75], v[128:131], v[40:55]
    v_mfma_f32_32x32x16_bf16 v[56:71], v[76:79], v[128:131], v[56:71]
    v_mfma_f32_32x32x16_bf16 v[8:23], v[80:83], v[124:127], v[8:23]
    v_mfma_f32_32x32x16_bf16 v[24:39], v[84:87], v[124:127], v[24:39]
    v_mfma_f32_32x32x16_bf16 v[40:55], v[80:83], v[132:135], v[40:55]
    v_mfma_f32_32x32x16_bf16 v[56:71], v[84:87], v[132:135], v[56:71]
    ds_read_b64_tr_b16 v[72:73], v3 offset:12288
    ds_read_b64_tr_b16 v[74:75], v3 offset:12800
    ds_read_b64_tr_b16 v[76:77], v4 offset:12288
    ds_read_b64_tr_b16 v[78:79], v4 offset:12800
    ds_read_b64_tr_b16 v[80:81], v3 offset:14336
    ds_read_b64_tr_b16 v[82:83], v3 offset:14848
    ds_read_b64_tr_b16 v[84:85], v4 offset:14336
    ds_read_b64_tr_b16 v[86:87], v4 offset:14848
    s_waitcnt vmcnt(24)
    v_mfma_f32_32x32x16_bf16 v[8:23], v[88:91], v[136:139], v[8:23]
    v_mfma_f32_32x32x16_bf16 v[24:39], v[92:95], v[136:139], v[24:39]
    v_mfma_f32_32x32x16_bf16 v[40:55], v[88:91], v[144:147], v[40:55]
    v_mfma_f32_32x32x16_bf16 v[56:71], v[92:95], v[144:147], v[56:71]
    v_mfma_f32_32x32x16_bf16 v[8:23], v[96:99], v[140:143], v[8:23]
    v_mfma_f32_32x32x16_bf16 v[24:39], v[100:103], v[140:143], v[24:39]
    v_mfma_f32_32x32x16_bf16 v[40:55], v[96:99], v[148:151], v[40:55]
    v_mfma_f32_32x32x16_bf16 v[56:71], v[100:103], v[148:151], v[56:71]
    ds_read_b64_tr_b16 v[88:89], v3 offset:16384
    ds_read_b64_tr_b16 v[90:91], v3 offset:16896
    ds_read_b64_tr_b16 v[92:93], v4 offset:16384
    ds_read_b64_tr_b16 v[94:95], v4 offset:16896
    ds_read_b64_tr_b16 v[96:97], v3 offset:18432
    ds_read_b64_tr_b16 v[98:99], v3 offset:18944
    ds_read_b64_tr_b16 v[100:101], v4 offset:18432
    ds_read_b64_tr_b16 v[102:103], v4 offset:18944
    s_waitcnt vmcnt(20)
    v_mfma_f32_32x32x16_bf16 v[8:23], v[104:107], v[152:155], v[8:23]
    v_mfma_f32_32x32x16_bf16 v[24:39], v[108:111], v[152:155], v[24:39]
    v_mfma_f32_32x32x16_bf16 v[40:55], v[104:107], v[160:163], v[40:55]
    v_mfma_f32_32x32x16_bf16 v[56:71], v[108:111], v[160:163], v[56:71]
    v_mfma_f32_32x32x16_bf16 v[8:23], v[112:115], v[156:159], v[8:23]
    v_mfma_f32_32x32x16_bf16 v[24:39], v[116:119], v[156:159], v[24:39]
    v_mfma_f32_32x32x16_bf16 v[40:55], v[112:115], v[164:167], v[40:55]
    v_mfma_f32_32x32x16_bf16 v[56:71], v[116:119], v[164:167], v[56:71]
    ds_read_b64_tr_b16 v[104:105], v3 offset:0
    ds_read_b64_tr_b16 v[106:107], v3 offset:512
    ds_read_b64_tr_b16 v[108:109], v4 offset:0
    ds_read_b64_tr_b16 v[110:111], v4 offset:512
    ds_read_b64_tr_b16 v[112:113], v3 offset:2048
    ds_read_b64_tr_b16 v[114:115], v3 offset:2560
    ds_read_b64_tr_b16 v[116:117], v4 offset:2048
    ds_read_b64_tr_b16 v[118:119], v4 offset:2560
    s_waitcnt vmcnt(16)
    s_waitcnt lgkmcnt(8)
    v_mfma_f32_32x32x16_bf16 v[8:23], v[72:75], v[168:171], v[8:23]
    v_mfma_f32_32x32x16_bf16 v[24:39], v[76:79], v[168:171], v[24:39]
    v_mfma_f32_32x32x16_bf16 v[40:55], v[72:75], v[176:179], v[40:55]
    v_mfma_f32_32x32x16_bf16 v[56:71], v[76:79], v[176:179], v[56:71]
    v_mfma_f32_32x32x16_bf16 v[8:23], v[80:83], v[172:175], v[8:23]
    v_mfma_f32_32x32x16_bf16 v[24:39], v[84:87], v[172:175], v[24:39]
    v_mfma_f32_32x32x16_bf16 v[40:55], v[80:83], v[180:183], v[40:55]
    v_mfma_f32_32x32x16_bf16 v[56:71], v[84:87], v[180:183], v[56:71]
    ds_read_b64_tr_b16 v[72:73], v3 offset:4096
    ds_read_b64_tr_b16 v[74:75], v3 offset:4608
    ds_read_b64_tr_b16 v[76:77], v4 offset:4096
    ds_read_b64_tr_b16 v[78:79], v4 offset:4608
    ds_read_b64_tr_b16 v[80:81], v3 offset:6144
    ds_read_b64_tr_b16 v[82:83], v3 offset:6656
    ds_read_b64_tr_b16 v[84:85], v4 offset:6144
    ds_read_b64_tr_b16 v[86:87], v4 offset:6656
    s_waitcnt vmcnt(12)
    s_waitcnt lgkmcnt(8)
    v_mfma_f32_32x32x16_bf16 v[8:23], v[88:91], v[184:187], v[8:23]
    v_mfma_f32_32x32x16_bf16 v[24:39], v[92:95], v[184:187], v[24:39]
    v_mfma_f32_32x32x16_bf16 v[40:55], v[88:91], v[192:195], v[40:55]
    v_mfma_f32_32x32x16_bf16 v[56:71], v[92:95], v[192:195], v[56:71]
    v_mfma_f32_32x32x16_bf16 v[8:23], v[96:99], v[188:191], v[8:23]
    v_mfma_f32_32x32x16_bf16 v[24:39], v[100:103], v[188:191], v[24:39]
    v_mfma_f32_32x32x16_bf16 v[40:55], v[96:99], v[196:199], v[40:55]
    v_mfma_f32_32x32x16_bf16 v[56:71], v[100:103], v[196:199], v[56:71]
    ds_read_b64_tr_b16 v[88:89], v3 offset:8192
    ds_read_b64_tr_b16 v[90:91], v3 offset:8704
    ds_read_b64_tr_b16 v[92:93], v4 offset:8192
    ds_read_b64_tr_b16 v[94:95], v4 offset:8704
    ds_read_b64_tr_b16 v[96:97], v3 offset:10240
    ds_read_b64_tr_b16 v[98:99], v3 offset:10752
    ds_read_b64_tr_b16 v[100:101], v4 offset:10240
    ds_read_b64_tr_b16 v[102:103], v4 offset:10752
    s_waitcnt vmcnt(8)
    s_waitcnt lgkmcnt(8)
    v_mfma_f32_32x32x16_bf16 v[8:23], v[104:107], v[200:203], v[8:23]
    v_mfma_f32_32x32x16_bf16 v[24:39], v[108:111], v[200:203], v[24:39]
    v_mfma_f32_32x32x16_bf16 v[40:55], v[104:107], v[208:211], v[40:55]
    v_mfma_f32_32x32x16_bf16 v[56:71], v[108:111], v[208:211], v[56:71]
    v_mfma_f32_32x32x16_bf16 v[8:23], v[112:115], v[204:207], v[8:23]
    v_mfma_f32_32x32x16_bf16 v[24:39], v[116:119], v[204:207], v[24:39]
    v_mfma_f32_32x32x16_bf16 v[40:55], v[112:115], v[212:215], v[40:55]
    v_mfma_f32_32x32x16_bf16 v[56:71], v[116:119], v[212:215], v[56:71]
    s_waitcnt vmcnt(4)
    s_waitcnt lgkmcnt(8)
    v_mfma_f32_32x32x16_bf16 v[8:23], v[72:75], v[216:219], v[8:23]
    v_mfma_f32_32x32x16_bf16 v[24:39], v[76:79], v[216:219], v[24:39]
    v_mfma_f32_32x32x16_bf16 v[40:55], v[72:75], v[224:227], v[40:55]
    v_mfma_f32_32x32x16_bf16 v[56:71], v[76:79], v[224:227], v[56:71]
    v_mfma_f32_32x32x16_bf16 v[8:23], v[80:83], v[220:223], v[8:23]
    v_mfma_f32_32x32x16_bf16 v[24:39], v[84:87], v[220:223], v[24:39]
    v_mfma_f32_32x32x16_bf16 v[40:55], v[80:83], v[228:231], v[40:55]
    v_mfma_f32_32x32x16_bf16 v[56:71], v[84:87], v[228:231], v[56:71]
    s_waitcnt vmcnt(0)
    s_waitcnt lgkmcnt(0)
    v_mfma_f32_32x32x16_bf16 v[8:23], v[88:91], v[232:235], v[8:23]
    v_mfma_f32_32x32x16_bf16 v[24:39], v[92:95], v[232:235], v[24:39]
    v_mfma_f32_32x32x16_bf16 v[40:55], v[88:91], v[240:243], v[40:55]
    v_mfma_f32_32x32x16_bf16 v[56:71], v[92:95], v[240:243], v[56:71]
    v_mfma_f32_32x32x16_bf16 v[8:23], v[96:99], v[236:239], v[8:23]
    v_mfma_f32_32x32x16_bf16 v[24:39], v[100:103], v[236:239], v[24:39]
    v_mfma_f32_32x32x16_bf16 v[40:55], v[96:99], v[244:247], v[40:55]
    v_mfma_f32_32x32x16_bf16 v[56:71], v[100:103], v[244:247], v[56:71]
L_red:
    v_add_u32 v6, s11, v1
    s_nop 7
    s_nop 2
    ds_write_b128 v6, v[8:11] offset:0
    ds_write_b128 v6, v[12:15] offset:1024
    ds_write_b128 v6, v[16:19] offset:2048
    ds_write_b128 v6, v[20:23] offset:3072
    ds_write_b128 v6, v[24:27] offset:4096
    ds_write_b128 v6, v[28:31] offset:5120
    ds_write_b128 v6, v[32:35] offset:6144
    ds_write_b128 v6, v[36:39] offset:7168
    ds_write_b128 v6, v[40:43] offset:8192
    ds_write_b128 v6, v[44:47] offset:9216
    ds_write_b128 v6, v[48:51] offset:10240
    ds_write_b128 v6, v[52:55] offset:11264
    ds_write_b128 v6, v[56:59] offset:12288
    ds_write_b128 v6, v[60:63] offset:13312
    ds_write_b128 v6, v[64:67] offset:14336
    ds_write_b128 v6, v[68:71] offset:15360
    s_lshl_b32 s77, s4, 11
    v_add_u32 v2, s77, v1
    v_add_u32 v3, 61440, v2
    v_add_u32 v4, 122880, v2
    s_lshl_b32 s77, s8, 1
    s_lshr_b32 s78, s4, 2
    s_add_u32 s77, s77, s78
    s_mul_i32 s77, s77, 81920
    s_mul_i32 s78, s5, 1280
    s_add_u32 s77, s77, s78
    s_add_u32 s77, s77, s88
    s_and_b32 s78, s4, 3
    s_lshl_b32 s78, s78, 5
    s_add_u32 s77, s77, s78
    v_and_b32 v6, 31, v0
    v_mul_u32_u24 v6, 2560, v6
    v_lshrrev_b32 v7, 5, v0
    v_lshl_add_u32 v5, v7, 4, v6
    s_waitcnt lgkmcnt(0)
    s_barrier
    ds_read_b128 v[120:123], v2 offset:0
    ds_read_b128 v[124:127], v2 offset:1024
    ds_read_b128 v[128:131], v2 offset:20480
    ds_read_b128 v[132:135], v2 offset:21504
    ds_read_b128 v[136:139], v2 offset:40960
    ds_read_b128 v[140:143], v2 offset:41984
    ds_read_b128 v[144:147], v3 offset:0
    ds_read_b128 v[148:151], v3 offset:1024
    ds_read_b128 v[152:155], v3 offset:20480
    ds_read_b128 v[156:159], v3 offset:21504
    ds_read_b128 v[160:163], v3 offset:40960
    ds_read_b128 v[164:167], v3 offset:41984
    ds_read_b128 v[168:171], v4 offset:0
    ds_read_b128 v[172:175], v4 offset:1024
    ds_read_b128 v[176:179], v4 offset:20480
    s_waitcnt lgkmcnt(14)
    ds_read_b128 v[180:183], v4 offset:21504
    s_waitcnt lgkmcnt(12)
    v_add_f32 v120, v120, v128
    v_add_f32 v121, v121, v129
    v_add_f32 v122, v122, v130
    v_add_f32 v123, v123, v131
    v_add_f32 v124, v124, v132
    v_add_f32 v125, v125, v133
    v_add_f32 v126, v126, v134
    v_add_f32 v127, v127, v135
    s_waitcnt lgkmcnt(10)
    v_add_f32 v120, v120, v136
    v_add_f32 v121, v121, v137
    v_add_f32 v122, v122, v138
    v_add_f32 v123, v123, v139
    v_add_f32 v124, v124, v140
    v_add_f32 v125, v125, v141
    v_add_f32 v126, v126, v142
    v_add_f32 v127, v127, v143
    s_waitcnt lgkmcnt(8)
    v_add_f32 v120, v120, v144
    v_add_f32 v121, v121, v145
    v_add_f32 v122, v122, v146
    v_add_f32 v123, v123, v147
    v_add_f32 v124, v124, v148
    v_add_f32 v125, v125, v149
    v_add_f32 v126, v126, v150
    v_add_f32 v127, v127, v151
    s_waitcnt lgkmcnt(6)
    v_add_f32 v120, v120, v152
    v_add_f32 v121, v121, v153
    v_add_f32 v122, v122, v154
    v_add_f32 v123, v123, v155
    v_add_f32 v124, v124, v156
    v_add_f32 v125, v125, v157
    v_add_f32 v126, v126, v158
    v_add_f32 v127, v127, v159
    s_waitcnt lgkmcnt(4)
    v_add_f32 v120, v120, v160
    v_add_f32 v121, v121, v161
    v_add_f32 v122, v122, v162
    v_add_f32 v123, v123, v163
    v_add_f32 v124, v124, v164
    v_add_f32 v125, v125, v165
    v_add_f32 v126, v126, v166
    v_add_f32 v127, v127, v167
    s_waitcnt lgkmcnt(2)
    v_add_f32 v120, v120, v168
    v_add_f32 v121, v121, v169
    v_add_f32 v122, v122, v170
    v_add_f32 v123, v123, v171
    v_add_f32 v124, v124, v172
    v_add_f32 v125, v125, v173
    v_add_f32 v126, v126, v174
    v_add_f32 v127, v127, v175
    s_waitcnt lgkmcnt(0)
    v_add_f32 v120, v120, v176
    v_add_f32 v121, v121, v177
    v_add_f32 v122, v122, v178
    v_add_f32 v123, v123, v179
    v_add_f32 v124, v124, v180
    v_add_f32 v125, v125, v181
    v_add_f32 v126, v126, v182
    v_add_f32 v127, v127, v183
    v_cvt_pk_bf16_f32 v8, v120, v121
    v_cvt_pk_bf16_f32 v9, v122, v123
    v_cvt_pk_bf16_f32 v10, v124, v125
    v_cvt_pk_bf16_f32 v11, v126, v127
    buffer_store_dwordx4 v[8:11], v5, s[68:71], s77 offen
L_end:
    s_endpgm
.section .rodata,"a"
.p2align 6
.amdhsa_kernel concat_heads__gqa_block_cached__mha_block_cached__near_ridge_kernel
  .amdhsa_next_free_vgpr 256
  .amdhsa_next_free_sgpr 96
  .amdhsa_accum_offset 256
  .amdhsa_group_segment_fixed_size 0
  .amdhsa_kernarg_size 104
  .amdhsa_user_sgpr_count 2
  .amdhsa_user_sgpr_kernarg_segment_ptr 1
  .amdhsa_system_sgpr_workgroup_id_x 1
.end_amdhsa_kernel
```
